```python
import torch

def _softmax(x, axis=-1):
    return torch.softmax(x, dim=axis)
def _gelu(x):
    return torch.nn.functional.gelu(x, approximate="tanh")
def _silu(x):
    return torch.nn.functional.silu(x)
def _sigmoid(x):
    return torch.sigmoid(x)
def _layernorm(x, axis=-1, eps=1e-5):
    m = x.mean(dim=axis, keepdim=True)
    v = x.var(dim=axis, keepdim=True, unbiased=False)
    return (x - m) / torch.sqrt(v + eps)
def _scatter_add(tgt, idx, src, axis=0):
    return tgt.clone().index_add_(axis, idx, src)
def _segment_sum(src, seg, n):
    out = torch.zeros((n,) + src.shape[1:], dtype=src.dtype)
    return out.index_add_(0, seg, src)
def _pad(x, pw):
    flat = tuple(v for pair in reversed(pw) for v in pair)
    return torch.nn.functional.pad(x, flat)

kernel_name = 'concat_heads__mha_block_cached__gqa_block_cached__near_ridge'

def setup_inputs():

    _w = (lambda a: (lambda t: t.to(torch.bfloat16) if t.is_floating_point() else t)(torch.as_tensor(a)))
    def _A_setup():
        B, Sq, D = 16, 144, 512
        H, Sk, Dh = 32, 512, 128
        return {
            "x": _w((lambda *s: torch.randn(*s, dtype=torch.bfloat16) * 0.8)(B, Sq, D)),
            "k_cache": _w((lambda *s: torch.randn(*s, dtype=torch.bfloat16) * 0.8)(B, H, Sk, Dh)),
            "v_cache": _w((lambda *s: torch.randn(*s, dtype=torch.bfloat16) * 0.05)(B, H, Sk, Dh)),
            "wq": _w((lambda *s: torch.randn(*s, dtype=torch.bfloat16) * 0.8)(D, H * Dh) * (D ** -0.5)),
            "wo": _w((lambda *s: torch.randn(*s, dtype=torch.bfloat16) * 0.05)(H * Dh, D) * ((H * Dh) ** -0.5)),
        }
    _A_in = _A_setup()

    def _B_setup():
        B, Sq, D = 16, 144, 512
        Hq, Hkv, Sk, Dh = 32, 32, 512, 128
        assert Hq % Hkv == 0, (Hq, Hkv)
        return {
            "x": _w((lambda *s: torch.randn(*s, dtype=torch.bfloat16) * 0.8)(B, Sq, D)),
            "k_cache": _w((lambda *s: torch.randn(*s, dtype=torch.bfloat16) * 0.8)(B, Hkv, Sk, Dh)),
            "v_cache": _w((lambda *s: torch.randn(*s, dtype=torch.bfloat16) * 0.05)(B, Hkv, Sk, Dh)),
            "wq": _w((lambda *s: torch.randn(*s, dtype=torch.bfloat16) * 0.8)(D, Hq * Dh) * (D ** -0.5)),
            "wo": _w((lambda *s: torch.randn(*s, dtype=torch.bfloat16) * 0.05)(Hq * Dh, D) * ((Hq * Dh) ** -0.5)),
        }
    _B_in = _B_setup()

    return {
        "A_x": _A_in["x"],
        "A_k_cache": _A_in["k_cache"],
        "A_v_cache": _A_in["v_cache"],
        "A_wq": _A_in["wq"],
        "A_wo": _A_in["wo"],
        "B_x": _B_in["x"],
        "B_k_cache": _B_in["k_cache"],
        "B_v_cache": _B_in["v_cache"],
        "B_wq": _B_in["wq"],
        "B_wo": _B_in["wo"],
    }

def reference(A_x, A_k_cache, A_v_cache, A_wq, A_wo, B_x, B_k_cache, B_v_cache, B_wq, B_wo):
    def _A_ref(x, k_cache, v_cache, wq, wo):
        B, Sq, D = x.shape
        H, Dh = 32, 128
        q = (lambda x, *d: x.permute(*d))((x @ wq).reshape(B, Sq, H, Dh), 0, 2, 1, 3)
        scores = torch.einsum("bhqd,bhkd->bhqk", q, k_cache) * (Dh ** -0.5)
        p = _softmax(scores, axis=-1)
        o = torch.einsum("bhqk,bhkd->bhqd", p, v_cache)
        return (lambda x, *d: x.permute(*d))(o, 0, 2, 1, 3).reshape(B, Sq, H * Dh) @ wo

    def _B_ref(x, k_cache, v_cache, wq, wo):
        B, Sq, D = x.shape
        Hq, Dh = 32, 128
        Hkv = k_cache.shape[1]
        rep = Hq // Hkv
        q = (lambda x, *d: x.permute(*d))((x @ wq).reshape(B, Sq, Hq, Dh), 0, 2, 1, 3)
        k = (lambda x, n, axis: torch.repeat_interleave(x, n, dim=axis))(k_cache, rep, axis=1)
        v = (lambda x, n, axis: torch.repeat_interleave(x, n, dim=axis))(v_cache, rep, axis=1)
        scores = torch.einsum("bhqd,bhkd->bhqk", q, k) * (Dh ** -0.5)
        p = _softmax(scores, axis=-1)
        o = torch.einsum("bhqk,bhkd->bhqd", p, v)
        return (lambda x, *d: x.permute(*d))(o, 0, 2, 1, 3).reshape(B, Sq, Hq * Dh) @ wo

    a = _A_ref(A_x, A_k_cache, A_v_cache, A_wq, A_wo)
    b = _B_ref(B_x, B_k_cache, B_v_cache, B_wq, B_wo)
    return torch.concatenate([a, b], axis=-1)
```

```asm
; @launch grid=(256,1,1) block=(256,1,1) lds=163840
.amdgcn_target "amdgcn-amd-amdhsa--gfx950"
.text
.macro M d,a,b,c
v_mfma_f32_16x16x32_bf16 \d,\a,\b,\c
.endm
.macro T d,a,o
ds_read_b64_tr_b16 \d,\a offset:\o
.endm
.macro R d,a,o
ds_read_b128 \d,\a offset:\o
.endm
.macro E d
v_exp_f32_e32 \d,\d
.endm
.macro C d,a,b
v_cvt_pk_bf16_f32 \d,\a,\b
.endm
.macro D v,r,o
buffer_load_dwordx4 \v,\r,0 offen offset:\o lds
.endm
.macro Dn v,r,o
buffer_load_dwordx4 \v,\r,0 offen offset:\o nt lds
.endm
.globl concat_heads__mha_block_cached__gqa_block_cached__near_ridge_kernel
.p2align 8
.type concat_heads__mha_block_cached__gqa_block_cached__near_ridge_kernel,@function
concat_heads__mha_block_cached__gqa_block_cached__near_ridge_kernel:
s_mov_b32 s59,0
s_cmp_ge_u32 s2,256
s_cbranch_scc0 L_go
s_endpgm
L_go:
s_load_dwordx16 s[64:79],s[0:1],0
s_load_dwordx8 s[80:87],s[0:1],64
s_load_dwordx2 s[88:89],s[0:1],96
s_getpc_b64 s[48:49]
L_pc:
s_bfe_u32 s3,s2,0x40003
s_lshl_b32 s3,s3,13
v_lshl_add_u32 v1,v0,5,s3
v_min_u32 v1,L_last-L_pc,v1
global_load_dword v208,v1,s[48:49]
v_lshrrev_b32 v1,6,v0
v_bfe_u32 v4,v0,3,3
s_lshr_b32 s6,s2,4
v_readfirstlane_b32 s44,v1
v_and_b32 v5,7,v0
v_and_b32 v6,6,v4
v_xor_b32 v5,v5,v6
v_lshlrev_b32 v5,4,v5
s_bfe_u32 s7,s2,0x10003
s_xor_b32 s3,s6,s7
s_and_b32 s3,s3,7
s_lshl_b32 s92,s3,7
s_lshl_b32 s36,s3,19
v_lshl_add_u32 v5,v4,10,v5
v_lshl_add_u32 v247,v1,15,v5
s_lshl_b32 s45,s44,12
s_mov_b32 s23,0x20000
s_mul_i32 s3,s6,147456
s_and_b32 s4,s2,1
s_waitcnt lgkmcnt(0)
s_cselect_b64 s[20:21],s[74:75],s[64:65]
s_add_u32 s20,s20,s3
s_addc_u32 s21,s21,0
s_and_b32 s54,s20,0x7fff
v_add_u32 v247,s54,v247
s_add_u32 s22,s54,146688
s_sub_u32 s20,s20,s54
s_add_u32 s92,s92,s20
s_add_u32 m0,s45,49152
s_add_u32 s20,s92,0
D v247,s[20:23],0
s_add_u32 s20,s92,7168
D v247,s[20:23],1024
s_add_u32 s20,s92,14336
D v247,s[20:23],2048
s_add_u32 s20,s92,21504
D v247,s[20:23],3072
s_and_b32 s3,s2,6
s_or_b32 s5,s7,s3
v_and_b32 v2,15,v0
v_bfe_u32 v3,v0,4,2
v_and_b32 v6,1,v1
v_lshrrev_b32 v7,1,v1
v_lshlrev_b32 v8,1,v3
v_xor_b32 v8,v2,v8
v_and_b32 v9,12,v8
v_bfe_u32 v10,v8,1,1
v_or_b32 v9,v9,v10
v_and_b32 v10,1,v8
v_lshl_or_b32 v9,v10,1,v9
v_lshlrev_b32 v9,4,v9
s_lshl_b32 s7,s5,10
s_cmp_eq_u32 s4,0
s_cselect_b64 s[16:17],s[70:71],s[80:81]
s_add_u32 s16,s16,s7
s_addc_u32 s17,s17,0
s_and_b32 s7,s16,0x3fffff
v_lshl_add_u32 v10,v6,2,v3
v_lshl_add_u32 v10,v7,5,v10
v_lshl_add_u32 v9,v10,13,v9
s_add_u32 s3,s7,64512
v_add_u32 v230,s7,v9
v_xor_b32 v9,128,v9
v_add_u32 v231,s3,v9
s_add_u32 s18,s7,387328
s_mov_b32 s19,0x20000
s_sub_u32 s16,s16,s7
s_add_u32 s36,s36,s16
s_add_u32 m0,s45,0
s_add_u32 s16,s36,0
D v230,s[16:19],0
D v231,s[16:19],1024
s_add_u32 s16,s36,129024
D v230,s[16:19],2048
D v231,s[16:19],3072
s_bfe_u32 s3,s92,0x10007
s_lshl_b32 s46,s44,10
v_xor_b32 v11,s3,v7
s_add_u32 s3,s54,131072
v_lshl_add_u32 v5,v6,13,v5
v_lshl_add_u32 v5,v11,7,v5
v_add_u32 v240,s3,v5
s_add_u32 m0,s46,151552
s_and_b32 s20,s92,0xffffff7f
D v240,s[20:23],0
s_mov_b32 s47,0
v_and_b32 v0,63,v0
v_lshlrev_b32 v9,4,v8
v_lshl_add_u32 v9,v3,8,v9
v_lshl_add_u32 v245,v1,15,v9
v_xor_b32 v246,128,v245
s_xor_b32 s93,s92,128
s_xor_b32 s37,s36,524288
s_xor_b32 s94,s92,256
s_xor_b32 s38,s36,1048576
s_xor_b32 s95,s92,384
s_xor_b32 s39,s36,1572864
s_xor_b32 s96,s92,512
s_xor_b32 s40,s36,2097152
s_xor_b32 s97,s92,640
s_xor_b32 s41,s36,2621440
s_xor_b32 s98,s92,768
s_xor_b32 s42,s36,3145728
s_xor_b32 s99,s92,896
s_xor_b32 s43,s36,3670016
s_mov_b32 s58,0x3e0293ee
s_cmp_eq_u32 s4,0
s_cselect_b64 s[8:9],s[66:67],s[76:77]
s_cselect_b64 s[12:13],s[68:69],s[78:79]
s_cselect_b64 s[24:25],s[72:73],s[82:83]
s_lshl_b32 s7,s6,3
s_add_u32 s7,s7,s5
s_lshl_b32 s7,s7,19
s_add_u32 s8,s8,s7
s_addc_u32 s9,s9,0
s_add_u32 s12,s12,s7
s_addc_u32 s13,s13,0
s_lshl_b32 s7,s5,19
s_add_u32 s24,s24,s7
s_addc_u32 s25,s25,0
s_mov_b32 s11,0x20000
s_mov_b32 s15,0x20000
s_mov_b32 s27,0x20000
s_and_b32 s3,s8,0x7ffff
s_and_b32 s7,s12,0x7ffff
s_and_b32 s53,s24,0x7ffff
v_add_u32 v254,s7,v245
v_add_u32 v255,s7,v246
v_add_u32 v245,s3,v245
v_add_u32 v246,s3,v246
s_add_u32 s10,s3,102400
s_add_u32 s14,s7,102400
s_add_u32 s26,s53,108672
s_sub_u32 s50,s8,s3
s_sub_u32 s7,s12,s7
s_sub_u32 s51,s7,s50
s_sub_u32 s52,s24,s53
s_sub_u32 s54,s53,s54
s_lshl_b32 s3,s4,4
s_add_u32 s3,s3,s6
s_mul_i32 s7,s3,1179648
s_add_u32 s28,s88,s7
s_addc_u32 s29,s89,0
s_mov_b32 s30,1179648
s_mov_b32 s31,0x20000
s_lshl_b32 s7,s3,15
s_add_u32 s7,s7,41943040
s_add_u32 s80,s88,s7
s_addc_u32 s81,s89,0
s_mov_b32 s82,32768
s_mov_b32 s83,0x20000
s_mul_i32 s7,s6,294912
s_lshl_b32 s100,s4,10
s_add_u32 s7,s7,s100
s_and_b32 s100,s6,0
s_add_u32 s100,s5,s100
s_and_b32 s100,s100,7
s_lshl_b32 s100,s100,7
s_add_u32 s7,s7,s100
s_add_u32 s32,s84,s7
s_addc_u32 s33,s85,0
s_mov_b32 s34,292992
s_mov_b32 s35,0x20000
s_lshl_b32 s7,s3,3
s_add_u32 s84,s86,s7
s_addc_u32 s85,s87,0
s_mov_b32 s86,16
s_mov_b32 s87,0x20000
s_mul_i32 s48,s5,18432
s_mul_i32 s49,s5,147456
s_lshl_b32 s101,s5,12
s_add_u32 s101,s101,s46
s_mov_b32 s47,1
s_cmp_eq_u32 s44,0
s_cbranch_scc1 L_pg0
s_cmp_eq_u32 s44,1
s_cbranch_scc1 L_pg1
s_cmp_eq_u32 s44,2
s_cbranch_scc1 L_pg2
s_cmp_eq_u32 s44,3
s_cbranch_scc1 L_pg3
L_bkT0_0:
s_cmp_eq_u32 s44,0
s_cbranch_scc1 L_pg4
s_cmp_eq_u32 s44,1
s_cbranch_scc1 L_pg5
s_cmp_eq_u32 s44,2
s_cbranch_scc1 L_pg6
s_cmp_eq_u32 s44,3
s_cbranch_scc1 L_pg7
L_bkT0_1:
s_cmp_eq_u32 s44,0
s_cbranch_scc1 L_pg8
s_cmp_eq_u32 s44,1
s_cbranch_scc1 L_pg9
s_cmp_eq_u32 s44,2
s_cbranch_scc1 L_pg10
s_cmp_eq_u32 s44,3
s_cbranch_scc1 L_pg11
L_bkT0_2:
s_mov_b32 s47,0
v_lshrrev_b32 v9,2,v0
v_bfe_u32 v10,v0,1,1
v_and_b32 v11,7,v9
v_lshl_add_u32 v10,v1,2,v10
v_lshlrev_b32 v11,1,v11
v_and_b32 v8,6,v2
v_xor_b32 v10,v10,v11
v_and_b32 v13,7,v2
v_xor_b32 v8,v3,v8
v_lshlrev_b32 v10,4,v10
v_lshl_add_u32 v12,v1,2,v3
v_lshlrev_b32 v13,1,v13
v_lshlrev_b32 v8,4,v8
v_lshl_add_u32 v10,v9,8,v10
v_and_b32 v11,1,v0
v_xor_b32 v12,v12,v13
v_lshlrev_b32 v14,4,v0
v_lshl_add_u32 v8,v2,7,v8
v_lshl_add_u32 v10,v11,3,v10
v_lshlrev_b32 v12,4,v12
v_add_u32 v243,159744,v14
v_add_u32 v228,151552,v8
v_lshl_add_u32 v8,v1,12,v8
v_add_u32 v218,81920,v10
v_lshl_add_u32 v210,v2,8,v12
v_lshl_add_u32 v15,v7,10,v243
v_subrev_u32 v148,159744,v243
v_mov_b32 v144,0
v_mov_b32 v145,0
v_mov_b32 v146,0
v_mov_b32 v147,0
v_add_u32 v226,32768,v8
v_xor_b32 v219,32,v218
v_xor_b32 v220,64,v218
v_xor_b32 v221,96,v218
v_xor_b32 v222,128,v218
v_xor_b32 v223,160,v218
v_xor_b32 v224,192,v218
v_xor_b32 v225,224,v218
v_lshl_add_u32 v214,v1,12,v210
v_lshl_add_u32 v242,v6,3,v15
v_lshl_add_u32 v14,v1,10,v14
v_mov_b32 v15,0x3f803f80
v_xor_b32 v229,64,v228
v_xor_b32 v227,64,v226
v_xor_b32 v211,64,v210
v_xor_b32 v215,64,v214
v_xor_b32 v212,128,v210
v_xor_b32 v216,128,v214
v_xor_b32 v213,192,v210
v_xor_b32 v217,192,v214
v_add_u32 v244,147456,v14
v_accvgpr_write_b32 a192,v15
v_accvgpr_write_b32 a193,v15
v_accvgpr_write_b32 a194,v15
v_accvgpr_write_b32 a195,v15
v_subrev_u32 v200,81920,v218
v_subrev_u32 v201,81920,v219
v_subrev_u32 v202,81920,v220
v_subrev_u32 v203,81920,v221
v_subrev_u32 v204,81920,v222
v_subrev_u32 v205,81920,v223
v_subrev_u32 v206,81920,v224
v_subrev_u32 v207,81920,v225
buffer_store_dwordx4 v[144:147],v148,s[80:83],s101 offen sc1
s_add_u32 m0,s45,16384
s_add_u32 s16,s36,256
D v230,s[16:19],0
D v231,s[16:19],1024
s_add_u32 s16,s36,129280
D v230,s[16:19],2048
D v231,s[16:19],3072
s_add_u32 m0,s45,65536
s_add_u32 s20,s93,0
D v247,s[20:23],0
s_add_u32 s20,s93,7168
D v247,s[20:23],1024
s_add_u32 s20,s93,14336
D v247,s[20:23],2048
s_add_u32 s20,s93,21504
D v247,s[20:23],3072
s_waitcnt vmcnt(9)
s_barrier
R a[96:99],v226,16384
T a[216:217],v200,0
T a[218:219],v200,4096
s_waitcnt lgkmcnt(0)
M v[0:3],a[216:219],a[96:99],0
s_add_u32 m0,s45,81920
R a[100:103],v227,16384
T a[220:221],v200,8192
T a[222:223],v200,12288
R a[108:111],v227,18432
R a[104:107],v226,18432
R a[112:115],v228,0
R a[116:119],v229,0
T a[224:225],v201,0
T a[226:227],v201,4096
T a[228:229],v201,8192
T a[230:231],v201,12288
s_waitcnt lgkmcnt(8)
M v[0:3],a[220:223],a[100:103],v[0:3]
s_waitcnt lgkmcnt(7)
T a[232:233],v202,0
T a[234:235],v202,4096
M v[32:35],a[220:223],a[108:111],0
s_waitcnt lgkmcnt(8)
T a[236:237],v202,8192
v_xor_b32 v251,1024,v244
M v[32:35],a[216:219],a[104:107],v[32:35]
s_waitcnt lgkmcnt(8)
T a[238:239],v202,12288
T a[240:241],v203,0
M v[64:67],a[216:219],a[112:115],0
s_waitcnt lgkmcnt(8)
T a[242:243],v203,4096
v_xor_b32 v252,2048,v244
M v[64:67],a[220:223],a[116:119],v[64:67]
s_waitcnt lgkmcnt(6)
T a[244:245],v203,8192
T a[246:247],v203,12288
M v[4:7],a[224:227],a[96:99],0
s_add_u32 s16,s37,0
T a[248:249],v204,0
v_xor_b32 v253,3072,v244
M v[4:7],a[228:231],a[100:103],v[4:7]
T a[250:251],v204,4096
D v230,s[16:19],0
M v[36:39],a[228:231],a[108:111],0
T a[252:253],v204,8192
T a[254:255],v204,12288
M v[36:39],a[224:227],a[104:107],v[36:39]
T v[144:145],v205,0
v_mov_b32 v239,1
M v[68:71],a[224:227],a[112:115],0
T v[146:147],v205,4096
T v[148:149],v205,8192
M v[68:71],a[228:231],a[116:119],v[68:71]
s_waitcnt lgkmcnt(12)
T v[150:151],v205,12288
D v231,s[16:19],1024
M v[8:11],a[232:235],a[96:99],0
s_waitcnt lgkmcnt(11)
T v[152:153],v206,0
T v[154:155],v206,4096
M v[8:11],a[236:239],a[100:103],v[8:11]
s_add_u32 s16,s37,129024
T v[156:157],v206,8192
v_mov_b32 v237,s45
M v[40:43],a[236:239],a[108:111],0
s_waitcnt vmcnt(6) lgkmcnt(7)
s_barrier
T v[158:159],v206,12288
D v230,s[16:19],2048
M v[40:43],a[232:235],a[104:107],v[40:43]
T v[160:161],v207,0
T v[162:163],v207,4096
M v[44:47],a[240:243],a[104:107],0
T v[164:165],v207,8192
M v[44:47],a[244:247],a[108:111],v[44:47]
T v[166:167],v207,12288
M v[12:15],a[244:247],a[100:103],0
T v[168:169],v200,16384
D v231,s[16:19],3072
M v[12:15],a[240:243],a[96:99],v[12:15]
s_add_u32 m0,s45,98304
T v[170:171],v200,20480
M v[16:19],a[248:251],a[96:99],0
s_add_u32 s16,s37,256
T v[172:173],v200,24576
T v[174:175],v200,28672
M v[16:19],a[252:255],a[100:103],v[16:19]
T v[176:177],v201,16384
M v[48:51],a[252:255],a[108:111],0
T v[178:179],v201,20480
D v230,s[16:19],0
M v[48:51],a[248:251],a[104:107],v[48:51]
s_waitcnt vmcnt(1) lgkmcnt(6)
s_barrier
T v[180:181],v201,24576
M v[52:55],v[144:147],a[104:107],0
T v[182:183],v201,28672
M v[52:55],v[148:151],a[108:111],v[52:55]
T v[184:185],v202,16384
D v231,s[16:19],1024
M v[20:23],v[148:151],a[100:103],0
s_add_u32 s16,s37,129280
T v[186:187],v202,20480
M v[20:23],v[144:147],a[96:99],v[20:23]
T v[188:189],v202,24576
M v[24:27],v[152:155],a[96:99],0
T v[190:191],v202,28672
M v[24:27],v[156:159],a[100:103],v[24:27]
T v[192:193],v203,16384
D v230,s[16:19],2048
M v[56:59],v[156:159],a[108:111],0
T v[194:195],v203,20480
M v[56:59],v[152:155],a[104:107],v[56:59]
T v[196:197],v203,24576
M v[60:63],v[160:163],a[104:107],0
T v[198:199],v203,28672
M v[60:63],v[164:167],a[108:111],v[60:63]
T a[216:217],v204,16384
D v231,s[16:19],3072
M v[28:31],v[164:167],a[100:103],0
s_add_u32 m0,s46,155648
T a[218:219],v204,20480
M v[28:31],v[160:163],a[96:99],v[28:31]
s_waitcnt lgkmcnt(8)
s_and_b32 s20,s94,0xffffff7f
T a[220:221],v204,24576
M v[72:75],v[168:171],a[96:99],0
T a[222:223],v204,28672
M v[72:75],v[172:175],a[100:103],v[72:75]
T a[224:225],v205,16384
D v240,s[20:23],0
M v[104:107],v[172:175],a[108:111],0
s_add_u32 m0,s45,32768
T a[226:227],v205,20480
M v[104:107],v[168:171],a[104:107],v[104:107]
s_add_u32 s20,s94,0
T a[228:229],v205,24576
M v[136:139],v[168:171],a[112:115],0
T a[230:231],v205,28672
M v[136:139],v[172:175],a[116:119],v[136:139]
T a[232:233],v206,16384
D v247,s[20:23],0
M v[76:79],v[176:179],a[96:99],0
s_add_u32 s20,s94,7168
T a[234:235],v206,20480
M v[76:79],v[180:183],a[100:103],v[76:79]
T a[236:237],v206,24576
M v[108:111],v[180:183],a[108:111],0
T a[238:239],v206,28672
M v[108:111],v[176:179],a[104:107],v[108:111]
T a[240:241],v207,16384
D v247,s[20:23],1024
M v[140:143],v[176:179],a[112:115],0
s_add_u32 s20,s94,14336
T a[242:243],v207,20480
M v[140:143],v[180:183],a[116:119],v[140:143]
T a[244:245],v207,24576
M v[80:83],v[184:187],a[96:99],0
s_waitcnt lgkmcnt(8)
T a[246:247],v207,28672
M v[80:83],v[188:191],a[100:103],v[80:83]
R a[120:123],v226,32768
D v247,s[20:23],2048
M v[112:115],v[188:191],a[108:111],0
s_add_u32 s20,s94,21504
T a[248:249],v218,0
M v[112:115],v[184:187],a[104:107],v[112:115]
T a[250:251],v218,4096
M v[116:119],v[192:195],a[104:107],0
R a[124:127],v227,32768
M v[116:119],v[196:199],a[108:111],v[116:119]
T a[252:253],v218,8192
D v247,s[20:23],3072
M v[84:87],v[196:199],a[100:103],0
s_waitcnt vmcnt(5) lgkmcnt(5)
s_barrier
s_add_u32 m0,s45,114688
T a[254:255],v218,12288
M v[84:87],v[192:195],a[96:99],v[84:87]
s_add_u32 s16,s38,0
R a[132:135],v227,34816
M v[88:91],a[216:219],a[96:99],0
R a[128:131],v226,34816
D v230,s[16:19],0
M v[88:91],a[220:223],a[100:103],v[88:91]
R a[136:139],v228,2048
M v[120:123],a[220:223],a[108:111],0
R a[140:143],v229,2048
M v[120:123],a[216:219],a[104:107],v[120:123]
T v[144:145],v219,0
M v[124:127],a[224:227],a[104:107],0
s_branch L_main
.p2align 12
L_pg0:
s_branch L_bkT0_0
L_main:
T v[146:147],v219,4096
D v231,s[16:19],1024
M v[124:127],a[228:231],a[108:111],v[124:127]
s_add_u32 s16,s38,129024
T v[148:149],v219,8192
M v[92:95],a[228:231],a[100:103],0
T v[150:151],v219,12288
M v[92:95],a[224:227],a[96:99],v[92:95]
T v[152:153],v220,0
M v[96:99],a[232:235],a[96:99],0
T v[154:155],v220,4096
D v230,s[16:19],2048
M v[96:99],a[236:239],a[100:103],v[96:99]
T v[156:157],v220,8192
M v[128:131],a[236:239],a[108:111],0
T v[158:159],v220,12288
M v[128:131],a[232:235],a[104:107],v[128:131]
T v[160:161],v221,0
M v[132:135],a[240:243],a[104:107],0
T v[162:163],v221,4096
D v231,s[16:19],3072
M v[132:135],a[244:247],a[108:111],v[132:135]
s_add_u32 m0,s45,131072
T v[164:165],v221,8192
M v[100:103],a[244:247],a[100:103],0
s_add_u32 s16,s38,256
T v[166:167],v221,12288
M v[100:103],a[240:243],a[96:99],v[100:103]
s_waitcnt lgkmcnt(8)
T v[168:169],v222,0
M v[0:3],a[248:251],a[120:123],v[0:3]
T v[170:171],v222,4096
D v230,s[16:19],0
M v[0:3],a[252:255],a[124:127],v[0:3]
T v[172:173],v222,8192
M v[32:35],a[252:255],a[132:135],v[32:35]
T v[174:175],v222,12288
M v[32:35],a[248:251],a[128:131],v[32:35]
T v[176:177],v223,0
M v[64:67],a[248:251],a[136:139],v[64:67]
T v[178:179],v223,4096
D v231,s[16:19],1024
M v[64:67],a[252:255],a[140:143],v[64:67]
s_add_u32 s16,s38,129280
T v[180:181],v223,8192
M v[4:7],v[144:147],a[120:123],v[4:7]
T v[182:183],v223,12288
M v[4:7],v[148:151],a[124:127],v[4:7]
T v[184:185],v224,0
M v[36:39],v[148:151],a[132:135],v[36:39]
T v[186:187],v224,4096
D v230,s[16:19],2048
M v[36:39],v[144:147],a[128:131],v[36:39]
T v[188:189],v224,8192
M v[68:71],v[144:147],a[136:139],v[68:71]
T v[190:191],v224,12288
M v[68:71],v[148:151],a[140:143],v[68:71]
s_waitcnt lgkmcnt(8)
T v[192:193],v225,0
M v[8:11],v[152:155],a[120:123],v[8:11]
T v[194:195],v225,4096
D v231,s[16:19],3072
M v[8:11],v[156:159],a[124:127],v[8:11]
s_add_u32 m0,s45,49152
T v[196:197],v225,8192
M v[40:43],v[156:159],a[132:135],v[40:43]
s_add_u32 s20,s95,0
T v[198:199],v225,12288
M v[40:43],v[152:155],a[128:131],v[40:43]
T a[216:217],v218,16384
M v[44:47],v[160:163],a[128:131],v[44:47]
T a[218:219],v218,20480
D v247,s[20:23],0
M v[44:47],v[164:167],a[132:135],v[44:47]
s_add_u32 s20,s95,7168
T a[220:221],v218,24576
M v[12:15],v[164:167],a[124:127],v[12:15]
T a[222:223],v218,28672
M v[12:15],v[160:163],a[120:123],v[12:15]
T a[224:225],v219,16384
M v[16:19],v[168:171],a[120:123],v[16:19]
s_waitcnt vmcnt(5) lgkmcnt(5)
s_barrier
T a[226:227],v219,20480
D v247,s[20:23],1024
M v[16:19],v[172:175],a[124:127],v[16:19]
s_add_u32 s20,s95,14336
T a[228:229],v219,24576
M v[48:51],v[172:175],a[132:135],v[48:51]
T a[230:231],v219,28672
M v[48:51],v[168:171],a[128:131],v[48:51]
T a[232:233],v220,16384
M v[52:55],v[176:179],a[128:131],v[52:55]
T a[234:235],v220,20480
D v247,s[20:23],2048
M v[52:55],v[180:183],a[132:135],v[52:55]
s_add_u32 s20,s95,21504
T a[236:237],v220,24576
M v[20:23],v[180:183],a[124:127],v[20:23]
T a[238:239],v220,28672
M v[20:23],v[176:179],a[120:123],v[20:23]
T a[240:241],v221,16384
M v[24:27],v[184:187],a[120:123],v[24:27]
T a[242:243],v221,20480
D v247,s[20:23],3072
M v[24:27],v[188:191],a[124:127],v[24:27]
s_add_u32 m0,s45,0
T a[244:245],v221,24576
M v[56:59],v[188:191],a[132:135],v[56:59]
s_add_u32 s16,s39,0
T a[246:247],v221,28672
M v[56:59],v[184:187],a[128:131],v[56:59]
T a[248:249],v222,16384
M v[60:63],v[192:195],a[128:131],v[60:63]
T a[250:251],v222,20480
D v230,s[16:19],0
M v[60:63],v[196:199],a[132:135],v[60:63]
T a[252:253],v222,24576
M v[28:31],v[196:199],a[124:127],v[28:31]
T a[254:255],v222,28672
M v[28:31],v[192:195],a[120:123],v[28:31]
s_waitcnt lgkmcnt(8)
T v[144:145],v223,16384
M v[72:75],a[216:219],a[120:123],v[72:75]
T v[146:147],v223,20480
D v231,s[16:19],1024
M v[72:75],a[220:223],a[124:127],v[72:75]
s_add_u32 s16,s39,129024
T v[148:149],v223,24576
M v[104:107],a[220:223],a[132:135],v[104:107]
T v[150:151],v223,28672
M v[104:107],a[216:219],a[128:131],v[104:107]
T v[152:153],v224,16384
M v[136:139],a[216:219],a[136:139],v[136:139]
T v[154:155],v224,20480
D v230,s[16:19],2048
M v[136:139],a[220:223],a[140:143],v[136:139]
T v[156:157],v224,24576
M v[76:79],a[224:227],a[120:123],v[76:79]
T v[158:159],v224,28672
M v[76:79],a[228:231],a[124:127],v[76:79]
T v[160:161],v225,16384
M v[108:111],a[228:231],a[132:135],v[108:111]
T v[162:163],v225,20480
D v231,s[16:19],3072
M v[108:111],a[224:227],a[128:131],v[108:111]
s_add_u32 m0,s45,16384
T v[164:165],v225,24576
M v[140:143],a[224:227],a[136:139],v[140:143]
s_add_u32 s16,s40,0
T v[166:167],v225,28672
M v[140:143],a[228:231],a[140:143],v[140:143]
R a[144:147],v226,0
M v[80:83],a[232:235],a[120:123],v[80:83]
T v[168:169],v218,32768
D v230,s[16:19],0
M v[80:83],a[236:239],a[124:127],v[80:83]
T v[170:171],v218,36864
M v[112:115],a[236:239],a[132:135],v[112:115]
R a[148:151],v227,0
M v[112:115],a[232:235],a[128:131],v[112:115]
s_waitcnt lgkmcnt(8)
T v[172:173],v218,40960
M v[116:119],a[240:243],a[128:131],v[116:119]
s_waitcnt vmcnt(9) lgkmcnt(5)
s_barrier
T v[174:175],v218,45056
D v231,s[16:19],1024
M v[116:119],a[244:247],a[132:135],v[116:119]
s_add_u32 s16,s40,129024
R a[156:159],v227,2048
M v[84:87],a[244:247],a[124:127],v[84:87]
R a[152:155],v226,2048
M v[84:87],a[240:243],a[120:123],v[84:87]
R a[160:163],v228,4096
M v[88:91],a[248:251],a[120:123],v[88:91]
R a[164:167],v229,4096
D v230,s[16:19],2048
M v[88:91],a[252:255],a[124:127],v[88:91]
T v[176:177],v219,32768
M v[120:123],a[252:255],a[132:135],v[120:123]
T v[178:179],v219,36864
M v[120:123],a[248:251],a[128:131],v[120:123]
T v[180:181],v219,40960
M v[124:127],v[144:147],a[128:131],v[124:127]
T v[182:183],v219,45056
D v231,s[16:19],3072
M v[124:127],v[148:151],a[132:135],v[124:127]
s_add_u32 m0,s46,151552
T v[184:185],v220,32768
M v[92:95],v[148:151],a[124:127],v[92:95]
s_and_b32 s20,s96,0xffffff7f
T v[186:187],v220,36864
M v[92:95],v[144:147],a[120:123],v[92:95]
T v[188:189],v220,40960
M v[96:99],v[152:155],a[120:123],v[96:99]
T v[190:191],v220,45056
D v240,s[20:23],0
M v[96:99],v[156:159],a[124:127],v[96:99]
s_add_u32 m0,s45,81920
T v[192:193],v221,32768
M v[128:131],v[156:159],a[132:135],v[128:131]
s_add_u32 s16,s39,256
T v[194:195],v221,36864
M v[128:131],v[152:155],a[128:131],v[128:131]
T v[196:197],v221,40960
M v[132:135],v[160:163],a[128:131],v[132:135]
T v[198:199],v221,45056
D v230,s[16:19],0
M v[132:135],v[164:167],a[132:135],v[132:135]
T a[216:217],v222,32768
M v[100:103],v[164:167],a[124:127],v[100:103]
T a[218:219],v222,36864
M v[100:103],v[160:163],a[120:123],v[100:103]
s_waitcnt lgkmcnt(8)
T a[220:221],v222,40960
M v[0:3],v[168:171],a[144:147],v[0:3]
T a[222:223],v222,45056
D v231,s[16:19],1024
M v[0:3],v[172:175],a[148:151],v[0:3]
s_add_u32 s16,s39,129280
T a[224:225],v223,32768
M v[32:35],v[172:175],a[156:159],v[32:35]
T a[226:227],v223,36864
M v[32:35],v[168:171],a[152:155],v[32:35]
T a[228:229],v223,40960
M v[64:67],v[168:171],a[160:163],v[64:67]
T a[230:231],v223,45056
D v230,s[16:19],2048
M v[64:67],v[172:175],a[164:167],v[64:67]
T a[232:233],v224,32768
M v[4:7],v[176:179],a[144:147],v[4:7]
T a[234:235],v224,36864
M v[4:7],v[180:183],a[148:151],v[4:7]
T a[236:237],v224,40960
M v[36:39],v[180:183],a[156:159],v[36:39]
T a[238:239],v224,45056
D v231,s[16:19],3072
M v[36:39],v[176:179],a[152:155],v[36:39]
s_add_u32 m0,s45,65536
T a[240:241],v225,32768
M v[68:71],v[176:179],a[160:163],v[68:71]
s_add_u32 s20,s96,0
T a[242:243],v225,36864
M v[68:71],v[180:183],a[164:167],v[68:71]
T a[244:245],v225,40960
M v[8:11],v[184:187],a[144:147],v[8:11]
s_waitcnt lgkmcnt(8)
T a[246:247],v225,45056
D v247,s[20:23],0
M v[8:11],v[188:191],a[148:151],v[8:11]
s_add_u32 s20,s96,7168
T a[248:249],v218,49152
M v[40:43],v[188:191],a[156:159],v[40:43]
T a[250:251],v218,53248
M v[40:43],v[184:187],a[152:155],v[40:43]
T a[252:253],v218,57344
M v[44:47],v[192:195],a[152:155],v[44:47]
T a[254:255],v218,61440
D v247,s[20:23],1024
M v[44:47],v[196:199],a[156:159],v[44:47]
s_add_u32 s20,s96,14336
T v[144:145],v219,49152
M v[12:15],v[196:199],a[148:151],v[12:15]
s_waitcnt vmcnt(11) lgkmcnt(5)
s_barrier
T v[146:147],v219,53248
M v[12:15],v[192:195],a[144:147],v[12:15]
T v[148:149],v219,57344
D v247,s[20:23],2048
M v[16:19],a[216:219],a[144:147],v[16:19]
s_add_u32 s20,s96,21504
T v[150:151],v219,61440
M v[16:19],a[220:223],a[148:151],v[16:19]
T v[152:153],v220,49152
M v[48:51],a[220:223],a[156:159],v[48:51]
T v[154:155],v220,53248
M v[48:51],a[216:219],a[152:155],v[48:51]
T v[156:157],v220,57344
D v247,s[20:23],3072
M v[52:55],a[224:227],a[152:155],v[52:55]
s_add_u32 m0,s45,32768
T v[158:159],v220,61440
M v[52:55],a[228:231],a[156:159],v[52:55]
s_add_u32 s20,s97,0
T v[160:161],v221,49152
M v[20:23],a[228:231],a[148:151],v[20:23]
T v[162:163],v221,53248
M v[20:23],a[224:227],a[144:147],v[20:23]
T v[164:165],v221,57344
D v247,s[20:23],0
M v[24:27],a[232:235],a[144:147],v[24:27]
s_add_u32 s20,s97,7168
T v[166:167],v221,61440
M v[24:27],a[236:239],a[148:151],v[24:27]
T v[168:169],v222,49152
M v[56:59],a[236:239],a[156:159],v[56:59]
T v[170:171],v222,53248
M v[56:59],a[232:235],a[152:155],v[56:59]
T v[172:173],v222,57344
D v247,s[20:23],1024
M v[60:63],a[240:243],a[152:155],v[60:63]
s_add_u32 s20,s97,14336
T v[174:175],v222,61440
M v[60:63],a[244:247],a[156:159],v[60:63]
T v[176:177],v223,49152
M v[28:31],a[244:247],a[148:151],v[28:31]
T v[178:179],v223,53248
M v[28:31],a[240:243],a[144:147],v[28:31]
s_waitcnt lgkmcnt(8)
T v[180:181],v223,57344
D v247,s[20:23],2048
M v[72:75],a[248:251],a[144:147],v[72:75]
s_add_u32 s20,s97,21504
T v[182:183],v223,61440
M v[72:75],a[252:255],a[148:151],v[72:75]
T v[184:185],v224,49152
M v[104:107],a[252:255],a[156:159],v[104:107]
T v[186:187],v224,53248
M v[104:107],a[248:251],a[152:155],v[104:107]
T v[188:189],v224,57344
D v247,s[20:23],3072
M v[136:139],a[248:251],a[160:163],v[136:139]
s_add_u32 m0,s45,98304
T v[190:191],v224,61440
M v[136:139],a[252:255],a[164:167],v[136:139]
s_add_u32 s16,s41,0
T v[192:193],v225,49152
M v[76:79],v[144:147],a[144:147],v[76:79]
T v[194:195],v225,53248
M v[76:79],v[148:151],a[148:151],v[76:79]
T v[196:197],v225,57344
D v230,s[16:19],0
M v[108:111],v[148:151],a[156:159],v[108:111]
T v[198:199],v225,61440
M v[108:111],v[144:147],a[152:155],v[108:111]
R a[168:171],v226,16384
M v[140:143],v[144:147],a[160:163],v[140:143]
T a[216:217],v200,0
M v[140:143],v[148:151],a[164:167],v[140:143]
T a[218:219],v200,4096
D v231,s[16:19],1024
M v[80:83],v[152:155],a[144:147],v[80:83]
s_add_u32 s16,s41,129024
R a[172:175],v227,16384
M v[80:83],v[156:159],a[148:151],v[80:83]
s_mul_i32 s3,s2,0x04000000
T a[220:221],v200,8192
M v[112:115],v[156:159],a[156:159],v[112:115]
s_waitcnt vmcnt(14) lgkmcnt(5)
s_barrier
T a[222:223],v200,12288
D v230,s[16:19],2048
M v[112:115],v[152:155],a[152:155],v[112:115]
s_lshr_b32 s3,s3,29
R a[180:183],v227,18432
M v[116:119],v[160:163],a[152:155],v[116:119]
s_add_u32 s7,s3,0
R a[176:179],v226,18432
M v[116:119],v[164:167],a[156:159],v[116:119]
s_and_b32 s7,s7,7
R a[184:187],v228,6144
M v[84:87],v[164:167],a[148:151],v[84:87]
s_lshl_b32 s7,s7,12
R a[188:191],v229,6144
D v231,s[16:19],3072
M v[84:87],v[160:163],a[144:147],v[84:87]
s_add_u32 s64,s7,s50
T a[224:225],v201,0
M v[88:91],v[168:171],a[144:147],v[88:91]
s_add_u32 s7,s3,1
T a[226:227],v201,4096
M v[88:91],v[172:175],a[148:151],v[88:91]
s_and_b32 s7,s7,7
T a[228:229],v201,8192
M v[120:123],v[172:175],a[156:159],v[120:123]
s_lshl_b32 s7,s7,12
T a[230:231],v201,12288
M v[120:123],v[168:171],a[152:155],v[120:123]
s_add_u32 s65,s7,s50
T a[232:233],v202,0
M v[124:127],v[176:179],a[152:155],v[124:127]
s_add_u32 s7,s3,2
T a[234:235],v202,4096
M v[124:127],v[180:183],a[156:159],v[124:127]
s_and_b32 s7,s7,7
T a[236:237],v202,8192
M v[92:95],v[180:183],a[148:151],v[92:95]
s_lshl_b32 s7,s7,12
T a[238:239],v202,12288
M v[92:95],v[176:179],a[144:147],v[92:95]
s_add_u32 s66,s7,s50
T a[240:241],v203,0
M v[96:99],v[184:187],a[144:147],v[96:99]
s_add_u32 s7,s3,3
T a[242:243],v203,4096
M v[96:99],v[188:191],a[148:151],v[96:99]
s_and_b32 s7,s7,7
T a[244:245],v203,8192
M v[128:131],v[188:191],a[156:159],v[128:131]
s_lshl_b32 s7,s7,12
T a[246:247],v203,12288
M v[128:131],v[184:187],a[152:155],v[128:131]
s_add_u32 s67,s7,s50
T a[248:249],v204,0
M v[132:135],v[192:195],a[152:155],v[132:135]
s_add_u32 s7,s3,4
T a[250:251],v204,4096
M v[132:135],v[196:199],a[156:159],v[132:135]
s_and_b32 s7,s7,7
T a[252:253],v204,8192
M v[100:103],v[196:199],a[148:151],v[100:103]
s_lshl_b32 s7,s7,12
T a[254:255],v204,12288
M v[100:103],v[192:195],a[144:147],v[100:103]
s_waitcnt lgkmcnt(8)
s_add_u32 s68,s7,s50
T v[144:145],v205,0
M v[0:3],a[216:219],a[168:171],v[0:3]
s_add_u32 s7,s3,5
T v[146:147],v205,4096
M v[0:3],a[220:223],a[172:175],v[0:3]
s_and_b32 s7,s7,7
T v[148:149],v205,8192
M v[32:35],a[220:223],a[180:183],v[32:35]
s_lshl_b32 s7,s7,12
T v[150:151],v205,12288
M v[32:35],a[216:219],a[176:179],v[32:35]
s_add_u32 s69,s7,s50
T v[152:153],v206,0
M v[64:67],a[216:219],a[184:187],v[64:67]
s_add_u32 s7,s3,6
T v[154:155],v206,4096
M v[64:67],a[220:223],a[188:191],v[64:67]
s_and_b32 s7,s7,7
T v[156:157],v206,8192
M v[4:7],a[224:227],a[168:171],v[4:7]
s_lshl_b32 s7,s7,12
T v[158:159],v206,12288
M v[4:7],a[228:231],a[172:175],v[4:7]
s_add_u32 s70,s7,s50
T v[160:161],v207,0
M v[36:39],a[228:231],a[180:183],v[36:39]
s_add_u32 s7,s3,7
T v[162:163],v207,4096
M v[36:39],a[224:227],a[176:179],v[36:39]
s_and_b32 s7,s7,7
T v[164:165],v207,8192
M v[68:71],a[224:227],a[184:187],v[68:71]
s_lshl_b32 s7,s7,12
T v[166:167],v207,12288
M v[68:71],a[228:231],a[188:191],v[68:71]
s_waitcnt vmcnt(10)
s_add_u32 s71,s7,s50
R a[48:51],v226,32768
M v[8:11],a[232:235],a[168:171],v[8:11]
s_add_u32 m0,s45,114688
T v[168:169],v200,16384
M v[8:11],a[236:239],a[172:175],v[8:11]
s_add_u32 s16,s42,0
T v[170:171],v200,20480
M v[40:43],a[236:239],a[180:183],v[40:43]
R a[52:55],v227,32768
D v230,s[16:19],0
M v[40:43],a[232:235],a[176:179],v[40:43]
s_waitcnt lgkmcnt(8)
T v[172:173],v200,24576
M v[44:47],a[240:243],a[176:179],v[44:47]
s_waitcnt lgkmcnt(5)
s_barrier
T v[174:175],v200,28672
M v[44:47],a[244:247],a[180:183],v[44:47]
s_waitcnt vmcnt(9)
R a[60:63],v227,34816
D v231,s[16:19],1024
M v[12:15],a[244:247],a[172:175],v[12:15]
s_add_u32 s16,s42,129024
R a[56:59],v226,34816
M v[12:15],a[240:243],a[168:171],v[12:15]
R a[64:67],v228,0
M v[16:19],a[248:251],a[168:171],v[16:19]
R a[68:71],v229,0
M v[16:19],a[252:255],a[172:175],v[16:19]
T v[176:177],v201,16384
D v230,s[16:19],2048
M v[48:51],a[252:255],a[180:183],v[48:51]
T v[178:179],v201,20480
M v[48:51],a[248:251],a[176:179],v[48:51]
T v[180:181],v201,24576
M v[52:55],v[144:147],a[176:179],v[52:55]
T v[182:183],v201,28672
M v[52:55],v[148:151],a[180:183],v[52:55]
T v[184:185],v202,16384
D v231,s[16:19],3072
M v[20:23],v[148:151],a[172:175],v[20:23]
s_add_u32 m0,s45,131072
T v[186:187],v202,20480
M v[20:23],v[144:147],a[168:171],v[20:23]
s_add_u32 s16,s43,0
T v[188:189],v202,24576
M v[24:27],v[152:155],a[168:171],v[24:27]
T v[190:191],v202,28672
M v[24:27],v[156:159],a[172:175],v[24:27]
T v[192:193],v203,16384
D v230,s[16:19],0
M v[56:59],v[156:159],a[180:183],v[56:59]
T v[194:195],v203,20480
M v[56:59],v[152:155],a[176:179],v[56:59]
T v[196:197],v203,24576
M v[60:63],v[160:163],a[176:179],v[60:63]
T v[198:199],v203,28672
M v[60:63],v[164:167],a[180:183],v[60:63]
T a[216:217],v204,16384
D v231,s[16:19],1024
M v[28:31],v[164:167],a[172:175],v[28:31]
s_add_u32 s16,s43,129024
T a[218:219],v204,20480
M v[28:31],v[160:163],a[168:171],v[28:31]
s_waitcnt lgkmcnt(8)
T a[220:221],v204,24576
M v[0:3],v[168:171],a[48:51],v[0:3]
T a[222:223],v204,28672
M v[0:3],v[172:175],a[52:55],v[0:3]
T a[224:225],v205,16384
D v230,s[16:19],2048
M v[32:35],v[172:175],a[60:63],v[32:35]
T a[226:227],v205,20480
M v[32:35],v[168:171],a[56:59],v[32:35]
T a[228:229],v205,24576
M v[64:67],v[168:171],a[64:67],v[64:67]
T a[230:231],v205,28672
M v[64:67],v[172:175],a[68:71],v[64:67]
T a[232:233],v206,16384
D v231,s[16:19],3072
M v[4:7],v[176:179],a[48:51],v[4:7]
s_add_u32 m0,s45,49152
T a[234:235],v206,20480
M v[4:7],v[180:183],a[52:55],v[4:7]
s_add_u32 s20,s98,0
T a[236:237],v206,24576
M v[36:39],v[180:183],a[60:63],v[36:39]
T a[238:239],v206,28672
M v[36:39],v[176:179],a[56:59],v[36:39]
T a[240:241],v207,16384
D v247,s[20:23],0
M v[68:71],v[176:179],a[64:67],v[68:71]
L_pg1:
s_cmp_eq_u32 s47,1
s_cbranch_scc1 L_bkT0_0
s_add_u32 s20,s98,7168
T a[242:243],v207,20480
M v[68:71],v[180:183],a[68:71],v[68:71]
T a[244:245],v207,24576
M v[8:11],v[184:187],a[48:51],v[8:11]
s_waitcnt lgkmcnt(8)
T a[246:247],v207,28672
M v[8:11],v[188:191],a[52:55],v[8:11]
T a[248:249],v218,0
D v247,s[20:23],1024
M v[40:43],v[188:191],a[60:63],v[40:43]
s_add_u32 s20,s98,14336
T a[250:251],v218,4096
M v[40:43],v[184:187],a[56:59],v[40:43]
T a[252:253],v218,8192
M v[44:47],v[192:195],a[56:59],v[44:47]
T a[254:255],v218,12288
M v[44:47],v[196:199],a[60:63],v[44:47]
T v[144:145],v219,0
D v247,s[20:23],2048
M v[12:15],v[196:199],a[52:55],v[12:15]
s_waitcnt vmcnt(11) lgkmcnt(5)
s_barrier
s_add_u32 s20,s98,21504
T v[146:147],v219,4096
M v[12:15],v[192:195],a[48:51],v[12:15]
T v[148:149],v219,8192
M v[16:19],a[216:219],a[48:51],v[16:19]
T v[150:151],v219,12288
D v247,s[20:23],3072
M v[16:19],a[220:223],a[52:55],v[16:19]
s_add_u32 m0,s46,155648
T v[152:153],v220,0
M v[48:51],a[220:223],a[60:63],v[48:51]
s_and_b32 s20,s98,0xffffff7f
T v[154:155],v220,4096
M v[48:51],a[216:219],a[56:59],v[48:51]
T v[156:157],v220,8192
M v[52:55],a[224:227],a[56:59],v[52:55]
T v[158:159],v220,12288
D v240,s[20:23],0
M v[52:55],a[228:231],a[60:63],v[52:55]
s_add_u32 m0,s45,65536
T v[160:161],v221,0
M v[20:23],a[228:231],a[52:55],v[20:23]
s_add_u32 s20,s99,0
T v[162:163],v221,4096
M v[20:23],a[224:227],a[48:51],v[20:23]
T v[164:165],v221,8192
M v[24:27],a[232:235],a[48:51],v[24:27]
T v[166:167],v221,12288
D v247,s[20:23],0
M v[24:27],a[236:239],a[52:55],v[24:27]
s_add_u32 s20,s99,7168
T v[168:169],v222,0
M v[56:59],a[236:239],a[60:63],v[56:59]
T v[170:171],v222,4096
M v[56:59],a[232:235],a[56:59],v[56:59]
T v[172:173],v222,8192
M v[60:63],a[240:243],a[56:59],v[60:63]
T v[174:175],v222,12288
D v247,s[20:23],1024
M v[60:63],a[244:247],a[60:63],v[60:63]
s_add_u32 s20,s99,14336
T v[176:177],v223,0
M v[28:31],a[244:247],a[52:55],v[28:31]
T v[178:179],v223,4096
M v[28:31],a[240:243],a[48:51],v[28:31]
s_waitcnt lgkmcnt(8)
T v[180:181],v223,8192
M v[72:75],a[248:251],a[168:171],v[72:75]
T v[182:183],v223,12288
D v247,s[20:23],2048
M v[72:75],a[252:255],a[172:175],v[72:75]
s_add_u32 s20,s99,21504
T v[184:185],v224,0
M v[104:107],a[252:255],a[180:183],v[104:107]
T v[186:187],v224,4096
M v[104:107],a[248:251],a[176:179],v[104:107]
T v[188:189],v224,8192
M v[136:139],a[248:251],a[184:187],v[136:139]
T v[190:191],v224,12288
D v247,s[20:23],3072
M v[136:139],a[252:255],a[188:191],v[136:139]
s_add_u32 m0,s45,0
T v[192:193],v225,0
M v[76:79],v[144:147],a[168:171],v[76:79]
s_add_u32 s8,s64,0
T v[194:195],v225,4096
M v[76:79],v[148:151],a[172:175],v[76:79]
T v[196:197],v225,8192
M v[108:111],v[148:151],a[180:183],v[108:111]
T v[198:199],v225,12288
Dn v245,s[8:11],0
M v[108:111],v[144:147],a[176:179],v[108:111]
R a[72:75],v226,0
M v[140:143],v[144:147],a[184:187],v[140:143]
T a[216:217],v218,16384
M v[140:143],v[148:151],a[188:191],v[140:143]
T a[218:219],v218,20480
M v[80:83],v[152:155],a[168:171],v[80:83]
R a[76:79],v227,0
Dn v246,s[8:11],1024
M v[80:83],v[156:159],a[172:175],v[80:83]
T a[220:221],v218,24576
M v[112:115],v[156:159],a[180:183],v[112:115]
s_waitcnt vmcnt(6) lgkmcnt(5)
s_barrier
T a[222:223],v218,28672
M v[112:115],v[152:155],a[176:179],v[112:115]
R a[84:87],v227,2048
Dn v245,s[8:11],2048
M v[116:119],v[160:163],a[176:179],v[116:119]
R a[80:83],v226,2048
M v[116:119],v[164:167],a[180:183],v[116:119]
R a[88:91],v228,2048
M v[84:87],v[164:167],a[172:175],v[84:87]
R a[92:95],v229,2048
M v[84:87],v[160:163],a[168:171],v[84:87]
T a[224:225],v219,16384
Dn v246,s[8:11],3072
M v[88:91],v[168:171],a[168:171],v[88:91]
s_add_u32 m0,s45,81920
T a[226:227],v219,20480
M v[88:91],v[172:175],a[172:175],v[88:91]
s_add_u32 s16,s40,256
T a[228:229],v219,24576
M v[120:123],v[172:175],a[180:183],v[120:123]
T a[230:231],v219,28672
M v[120:123],v[168:171],a[176:179],v[120:123]
T a[232:233],v220,16384
D v230,s[16:19],0
M v[124:127],v[176:179],a[176:179],v[124:127]
T a[234:235],v220,20480
M v[124:127],v[180:183],a[180:183],v[124:127]
T a[236:237],v220,24576
M v[92:95],v[180:183],a[172:175],v[92:95]
T a[238:239],v220,28672
M v[92:95],v[176:179],a[168:171],v[92:95]
T a[240:241],v221,16384
D v231,s[16:19],1024
M v[96:99],v[184:187],a[168:171],v[96:99]
s_add_u32 s16,s40,129280
T a[242:243],v221,20480
M v[96:99],v[188:191],a[172:175],v[96:99]
T a[244:245],v221,24576
M v[128:131],v[188:191],a[180:183],v[128:131]
T a[246:247],v221,28672
M v[128:131],v[184:187],a[176:179],v[128:131]
T a[248:249],v222,16384
D v230,s[16:19],2048
M v[132:135],v[192:195],a[176:179],v[132:135]
T a[250:251],v222,20480
M v[132:135],v[196:199],a[180:183],v[132:135]
T a[252:253],v222,24576
M v[100:103],v[196:199],a[172:175],v[100:103]
T a[254:255],v222,28672
M v[100:103],v[192:195],a[168:171],v[100:103]
s_waitcnt lgkmcnt(8)
T v[144:145],v223,16384
D v231,s[16:19],3072
M v[0:3],a[216:219],a[72:75],v[0:3]
s_add_u32 m0,s45,98304
T v[146:147],v223,20480
M v[0:3],a[220:223],a[76:79],v[0:3]
s_add_u32 s16,s41,256
T v[148:149],v223,24576
M v[32:35],a[220:223],a[84:87],v[32:35]
T v[150:151],v223,28672
M v[32:35],a[216:219],a[80:83],v[32:35]
T v[152:153],v224,16384
M v[64:67],a[216:219],a[88:91],v[64:67]
T v[154:155],v224,20480
M v[64:67],a[220:223],a[92:95],v[64:67]
T v[156:157],v224,24576
M v[4:7],a[224:227],a[72:75],v[4:7]
T v[158:159],v224,28672
M v[4:7],a[228:231],a[76:79],v[4:7]
T v[160:161],v225,16384
M v[36:39],a[228:231],a[84:87],v[36:39]
T v[162:163],v225,20480
M v[36:39],a[224:227],a[80:83],v[36:39]
T v[164:165],v225,24576
M v[68:71],a[224:227],a[88:91],v[68:71]
T v[166:167],v225,28672
M v[68:71],a[228:231],a[92:95],v[68:71]
R a[144:147],v226,16384
M v[8:11],a[232:235],a[72:75],v[8:11]
T v[168:169],v218,32768
M v[8:11],a[236:239],a[76:79],v[8:11]
T v[170:171],v218,36864
M v[40:43],a[236:239],a[84:87],v[40:43]
R a[148:151],v227,16384
M v[40:43],a[232:235],a[80:83],v[40:43]
s_waitcnt lgkmcnt(8)
T v[172:173],v218,40960
M v[44:47],a[240:243],a[80:83],v[44:47]
s_waitcnt lgkmcnt(5)
s_barrier
T v[174:175],v218,45056
D v230,s[16:19],0
M v[44:47],a[244:247],a[84:87],v[44:47]
R a[156:159],v227,18432
M v[12:15],a[244:247],a[76:79],v[12:15]
R a[152:155],v226,18432
M v[12:15],a[240:243],a[72:75],v[12:15]
R a[160:163],v228,4096
M v[16:19],a[248:251],a[72:75],v[16:19]
R a[164:167],v229,4096
D v231,s[16:19],1024
M v[16:19],a[252:255],a[76:79],v[16:19]
s_add_u32 s16,s41,129280
T v[176:177],v219,32768
M v[48:51],a[252:255],a[84:87],v[48:51]
T v[178:179],v219,36864
M v[48:51],a[248:251],a[80:83],v[48:51]
T v[180:181],v219,40960
M v[52:55],v[144:147],a[80:83],v[52:55]
T v[182:183],v219,45056
D v230,s[16:19],2048
M v[52:55],v[148:151],a[84:87],v[52:55]
T v[184:185],v220,32768
M v[20:23],v[148:151],a[76:79],v[20:23]
T v[186:187],v220,36864
M v[20:23],v[144:147],a[72:75],v[20:23]
T v[188:189],v220,40960
M v[24:27],v[152:155],a[72:75],v[24:27]
T v[190:191],v220,45056
D v231,s[16:19],3072
M v[24:27],v[156:159],a[76:79],v[24:27]
s_add_u32 m0,s45,16384
T v[192:193],v221,32768
M v[56:59],v[156:159],a[84:87],v[56:59]
s_add_u32 s8,s65,0
T v[194:195],v221,36864
M v[56:59],v[152:155],a[80:83],v[56:59]
T v[196:197],v221,40960
M v[60:63],v[160:163],a[80:83],v[60:63]
T v[198:199],v221,45056
Dn v245,s[8:11],0
M v[60:63],v[164:167],a[84:87],v[60:63]
T a[216:217],v222,32768
M v[28:31],v[164:167],a[76:79],v[28:31]
T a[218:219],v222,36864
M v[28:31],v[160:163],a[72:75],v[28:31]
s_waitcnt lgkmcnt(8)
T a[220:221],v222,40960
M v[0:3],v[168:171],a[144:147],v[0:3]
T a[222:223],v222,45056
Dn v246,s[8:11],1024
M v[0:3],v[172:175],a[148:151],v[0:3]
T a[224:225],v223,32768
M v[32:35],v[172:175],a[156:159],v[32:35]
T a[226:227],v223,36864
M v[32:35],v[168:171],a[152:155],v[32:35]
T a[228:229],v223,40960
M v[64:67],v[168:171],a[160:163],v[64:67]
T a[230:231],v223,45056
Dn v245,s[8:11],2048
M v[64:67],v[172:175],a[164:167],v[64:67]
T a[232:233],v224,32768
M v[4:7],v[176:179],a[144:147],v[4:7]
T a[234:235],v224,36864
M v[4:7],v[180:183],a[148:151],v[4:7]
T a[236:237],v224,40960
M v[36:39],v[180:183],a[156:159],v[36:39]
T a[238:239],v224,45056
Dn v246,s[8:11],3072
M v[36:39],v[176:179],a[152:155],v[36:39]
s_add_u32 m0,s45,114688
T a[240:241],v225,32768
M v[68:71],v[176:179],a[160:163],v[68:71]
s_add_u32 s16,s42,256
T a[242:243],v225,36864
M v[68:71],v[180:183],a[164:167],v[68:71]
T a[244:245],v225,40960
M v[8:11],v[184:187],a[144:147],v[8:11]
s_waitcnt lgkmcnt(8)
T a[246:247],v225,45056
M v[8:11],v[188:191],a[148:151],v[8:11]
s_waitcnt vmcnt(18)
R a[168:171],v226,32768
M v[40:43],v[188:191],a[156:159],v[40:43]
T a[248:249],v218,49152
M v[40:43],v[184:187],a[152:155],v[40:43]
T a[250:251],v218,53248
M v[44:47],v[192:195],a[152:155],v[44:47]
R a[172:175],v227,32768
M v[44:47],v[196:199],a[156:159],v[44:47]
T a[252:253],v218,57344
M v[12:15],v[196:199],a[148:151],v[12:15]
s_waitcnt vmcnt(8) lgkmcnt(5)
s_barrier
T a[254:255],v218,61440
D v230,s[16:19],0
M v[12:15],v[192:195],a[144:147],v[12:15]
R a[180:183],v227,34816
M v[16:19],a[216:219],a[144:147],v[16:19]
R a[176:179],v226,34816
M v[16:19],a[220:223],a[148:151],v[16:19]
R a[184:187],v228,6144
M v[48:51],a[220:223],a[156:159],v[48:51]
R a[188:191],v229,6144
D v231,s[16:19],1024
M v[48:51],a[216:219],a[152:155],v[48:51]
s_add_u32 s16,s42,129280
T v[144:145],v219,49152
M v[52:55],a[224:227],a[152:155],v[52:55]
T v[146:147],v219,53248
M v[52:55],a[228:231],a[156:159],v[52:55]
T v[148:149],v219,57344
M v[20:23],a[228:231],a[148:151],v[20:23]
T v[150:151],v219,61440
D v230,s[16:19],2048
M v[20:23],a[224:227],a[144:147],v[20:23]
T v[152:153],v220,49152
M v[24:27],a[232:235],a[144:147],v[24:27]
T v[154:155],v220,53248
M v[24:27],a[236:239],a[148:151],v[24:27]
T v[156:157],v220,57344
M v[56:59],a[236:239],a[156:159],v[56:59]
T v[158:159],v220,61440
D v231,s[16:19],3072
M v[56:59],a[232:235],a[152:155],v[56:59]
s_add_u32 m0,s45,131072
T v[160:161],v221,49152
M v[60:63],a[240:243],a[152:155],v[60:63]
s_add_u32 s16,s43,256
T v[162:163],v221,53248
M v[60:63],a[244:247],a[156:159],v[60:63]
T v[164:165],v221,57344
M v[28:31],a[244:247],a[148:151],v[28:31]
T v[166:167],v221,61440
M v[28:31],a[240:243],a[144:147],v[28:31]
s_waitcnt lgkmcnt(8)
T v[168:169],v222,49152
M v[0:3],a[248:251],a[168:171],v[0:3]
T v[170:171],v222,53248
M v[0:3],a[252:255],a[172:175],v[0:3]
T v[172:173],v222,57344
M v[32:35],a[252:255],a[180:183],v[32:35]
T v[174:175],v222,61440
M v[32:35],a[248:251],a[176:179],v[32:35]
T v[176:177],v223,49152
M v[64:67],a[248:251],a[184:187],v[64:67]
T v[178:179],v223,53248
M v[64:67],a[252:255],a[188:191],v[64:67]
T v[180:181],v223,57344
v_mul_f32 v0,s58,v0
M v[4:7],v[144:147],a[168:171],v[4:7]
T v[182:183],v223,61440
v_mul_f32 v1,s58,v1
M v[4:7],v[148:151],a[172:175],v[4:7]
T v[184:185],v224,49152
v_mul_f32 v2,s58,v2
M v[36:39],v[148:151],a[180:183],v[36:39]
T v[186:187],v224,53248
v_mul_f32 v64,s58,v64
M v[36:39],v[144:147],a[176:179],v[36:39]
T v[188:189],v224,57344
v_mul_f32 v65,s58,v65
M v[68:71],v[144:147],a[184:187],v[68:71]
T v[190:191],v224,61440
v_mul_f32 v66,s58,v66
M v[68:71],v[148:151],a[188:191],v[68:71]
s_waitcnt lgkmcnt(8)
T v[192:193],v225,49152
v_mul_f32 v67,s58,v67
M v[8:11],v[152:155],a[168:171],v[8:11]
T v[194:195],v225,53248
C v64,v64,v65
M v[8:11],v[156:159],a[172:175],v[8:11]
T v[196:197],v225,57344
C v65,v66,v67
M v[40:43],v[156:159],a[180:183],v[40:43]
T v[198:199],v225,61440
v_mul_f32 v68,s58,v68
M v[40:43],v[152:155],a[176:179],v[40:43]
T a[216:217],v218,0
v_mul_f32 v69,s58,v69
M v[44:47],v[160:163],a[176:179],v[44:47]
v_mul_f32 v70,s58,v70
v_mul_f32 v71,s58,v71
M v[44:47],v[164:167],a[180:183],v[44:47]
T a[218:219],v218,4096
C v66,v68,v69
M v[12:15],v[164:167],a[172:175],v[12:15]
T a[220:221],v218,8192
C v67,v70,v71
M v[12:15],v[160:163],a[168:171],v[12:15]
v_permlane16_swap_b32 v64,v66
M v[16:19],v[168:171],a[168:171],v[16:19]
T a[222:223],v218,12288
v_mul_f32 v3,s58,v3
M v[16:19],v[172:175],a[172:175],v[16:19]
v_permlane16_swap_b32 v65,v67
M v[48:51],v[172:175],a[180:183],v[48:51]
ds_write_b128 v244,v[64:67]
M v[48:51],v[168:171],a[176:179],v[48:51]
s_waitcnt lgkmcnt(4)
T a[224:225],v219,0
v_mul_f32 v4,s58,v4
M v[52:55],v[176:179],a[176:179],v[52:55]
T a[226:227],v219,4096
v_mul_f32 v5,s58,v5
M v[52:55],v[180:183],a[180:183],v[52:55]
T a[228:229],v219,8192
v_mul_f32 v6,s58,v6
M v[20:23],v[180:183],a[172:175],v[20:23]
T a[230:231],v219,12288
v_mul_f32 v7,s58,v7
M v[20:23],v[176:179],a[168:171],v[20:23]
s_waitcnt vmcnt(8) lgkmcnt(4)
s_barrier
T a[232:233],v220,0
D v230,s[16:19],0
M v[24:27],v[184:187],a[168:171],v[24:27]
T a[234:235],v220,4096
C v0,v0,v1
M v[24:27],v[188:191],a[172:175],v[24:27]
T a[236:237],v220,8192
C v1,v2,v3
M v[56:59],v[188:191],a[180:183],v[56:59]
T a[238:239],v220,12288
C v2,v4,v5
M v[56:59],v[184:187],a[176:179],v[56:59]
T a[240:241],v221,0
D v231,s[16:19],1024
M v[60:63],v[192:195],a[176:179],v[60:63]
s_add_u32 s16,s43,129280
T a[242:243],v221,4096
C v3,v6,v7
M v[60:63],v[196:199],a[180:183],v[60:63]
T a[244:245],v221,8192
v_mul_f32 v8,s58,v8
M v[28:31],v[196:199],a[172:175],v[28:31]
T a[246:247],v221,12288
v_mul_f32 v9,s58,v9
M v[28:31],v[192:195],a[168:171],v[28:31]
T a[248:249],v222,0
D v230,s[16:19],2048
M v[72:75],a[216:219],a[48:51],v[72:75]
T a[250:251],v222,4096
v_mul_f32 v10,s58,v10
M v[72:75],a[220:223],a[52:55],v[72:75]
T a[252:253],v222,8192
v_mul_f32 v11,s58,v11
M v[104:107],a[220:223],a[60:63],v[104:107]
T a[254:255],v222,12288
v_mul_f32 v12,s58,v12
M v[104:107],a[216:219],a[56:59],v[104:107]
T v[144:145],v223,0
D v231,s[16:19],3072
M v[136:139],a[216:219],a[64:67],v[136:139]
s_add_u32 m0,s45,32768
T v[146:147],v223,4096
v_mul_f32 v13,s58,v13
M v[136:139],a[220:223],a[68:71],v[136:139]
s_waitcnt lgkmcnt(8)
T v[148:149],v223,8192
v_mul_f32 v14,s58,v14
M v[76:79],a[224:227],a[48:51],v[76:79]
s_add_u32 s8,s66,0
T v[150:151],v223,12288
v_mul_f32 v15,s58,v15
M v[76:79],a[228:231],a[52:55],v[76:79]
T v[152:153],v224,0
Dn v245,s[8:11],0
M v[108:111],a[228:231],a[60:63],v[108:111]
T v[154:155],v224,4096
C v8,v8,v9
M v[108:111],a[224:227],a[56:59],v[108:111]
T v[156:157],v224,8192
C v9,v10,v11
M v[140:143],a[224:227],a[64:67],v[140:143]
T v[158:159],v224,12288
C v10,v12,v13
M v[140:143],a[228:231],a[68:71],v[140:143]
T v[160:161],v225,0
Dn v246,s[8:11],1024
M v[80:83],a[232:235],a[48:51],v[80:83]
T v[162:163],v225,4096
C v11,v14,v15
M v[80:83],a[236:239],a[52:55],v[80:83]
T v[164:165],v225,8192
v_mul_f32 v16,s58,v16
M v[112:115],a[236:239],a[60:63],v[112:115]
T v[166:167],v225,12288
v_mul_f32 v17,s58,v17
M v[112:115],a[232:235],a[56:59],v[112:115]
T v[168:169],v218,16384
Dn v245,s[8:11],2048
M v[116:119],a[240:243],a[56:59],v[116:119]
s_waitcnt lgkmcnt(8)
T v[170:171],v218,20480
v_mul_f32 v18,s58,v18
M v[116:119],a[244:247],a[60:63],v[116:119]
T v[172:173],v218,24576
v_mul_f32 v19,s58,v19
M v[84:87],a[244:247],a[52:55],v[84:87]
T v[174:175],v218,28672
v_mul_f32 v20,s58,v20
M v[84:87],a[240:243],a[48:51],v[84:87]
T v[176:177],v219,16384
Dn v246,s[8:11],3072
M v[88:91],a[248:251],a[48:51],v[88:91]
s_waitcnt vmcnt(8) lgkmcnt(5)
s_barrier
T v[178:179],v219,20480
v_mul_f32 v21,s58,v21
M v[88:91],a[252:255],a[52:55],v[88:91]
s_add_u32 m0,s45,81920
T v[180:181],v219,24576
v_mul_f32 v22,s58,v22
M v[120:123],a[252:255],a[60:63],v[120:123]
s_add_u32 s3,s64,0
T v[182:183],v219,28672
v_mul_f32 v23,s58,v23
M v[120:123],a[248:251],a[56:59],v[120:123]
s_add_u32 s12,s3,s51
T v[184:185],v220,16384
C v16,v16,v17
M v[124:127],v[144:147],a[56:59],v[124:127]
T v[186:187],v220,20480
C v17,v18,v19
M v[124:127],v[148:151],a[60:63],v[124:127]
T v[188:189],v220,24576
C v18,v20,v21
M v[92:95],v[148:151],a[52:55],v[92:95]
T v[190:191],v220,28672
C v19,v22,v23
M v[92:95],v[144:147],a[48:51],v[92:95]
T v[192:193],v221,16384
v_mul_f32 v24,s58,v24
M v[96:99],v[152:155],a[48:51],v[96:99]
T v[194:195],v221,20480
v_mul_f32 v25,s58,v25
M v[96:99],v[156:159],a[52:55],v[96:99]
T v[196:197],v221,24576
v_mul_f32 v26,s58,v26
M v[128:131],v[156:159],a[60:63],v[128:131]
T v[198:199],v221,28672
v_mul_f32 v27,s58,v27
M v[128:131],v[152:155],a[56:59],v[128:131]
L_pg2:
s_cmp_eq_u32 s47,1
s_cbranch_scc1 L_bkT0_0
T a[216:217],v222,16384
v_mul_f32 v28,s58,v28
M v[132:135],v[160:163],a[56:59],v[132:135]
T a[218:219],v222,20480
v_mul_f32 v29,s58,v29
M v[132:135],v[164:167],a[60:63],v[132:135]
T a[220:221],v222,24576
v_mul_f32 v30,s58,v30
M v[100:103],v[164:167],a[52:55],v[100:103]
T a[222:223],v222,28672
v_mul_f32 v31,s58,v31
M v[100:103],v[160:163],a[48:51],v[100:103]
s_waitcnt lgkmcnt(8)
T a[224:225],v223,16384
C v24,v24,v25
M v[72:75],v[168:171],a[72:75],v[72:75]
T a[226:227],v223,20480
C v25,v26,v27
M v[72:75],v[172:175],a[76:79],v[72:75]
T a[228:229],v223,24576
C v26,v28,v29
M v[104:107],v[172:175],a[84:87],v[104:107]
T a[230:231],v223,28672
C v27,v30,v31
M v[104:107],v[168:171],a[80:83],v[104:107]
T a[232:233],v224,16384
v_mul_f32 v56,s58,v56
M v[136:139],v[168:171],a[88:91],v[136:139]
T a[234:235],v224,20480
v_mul_f32 v57,s58,v57
M v[136:139],v[172:175],a[92:95],v[136:139]
T a[236:237],v224,24576
v_mul_f32 v58,s58,v58
M v[76:79],v[176:179],a[72:75],v[76:79]
T a[238:239],v224,28672
v_mul_f32 v59,s58,v59
M v[76:79],v[180:183],a[76:79],v[76:79]
T a[240:241],v225,16384
v_mul_f32 v60,s58,v60
M v[108:111],v[180:183],a[84:87],v[108:111]
T a[242:243],v225,20480
v_mul_f32 v61,s58,v61
M v[108:111],v[176:179],a[80:83],v[108:111]
T a[244:245],v225,24576
v_mul_f32 v62,s58,v62
M v[140:143],v[176:179],a[88:91],v[140:143]
T a[246:247],v225,28672
v_mul_f32 v63,s58,v63
M v[140:143],v[180:183],a[92:95],v[140:143]
T v[232:233],v218,32768
C v56,v56,v57
M v[80:83],v[184:187],a[72:75],v[80:83]
T v[234:235],v218,36864
C v57,v58,v59
M v[80:83],v[188:191],a[76:79],v[80:83]
T a[96:97],v218,40960
C v58,v60,v61
M v[112:115],v[188:191],a[84:87],v[112:115]
T a[98:99],v218,45056
C v59,v62,v63
M v[112:115],v[184:187],a[80:83],v[112:115]
s_waitcnt lgkmcnt(8)
T a[100:101],v219,32768
v_mul_f32 v48,s58,v48
M v[116:119],v[192:195],a[80:83],v[116:119]
s_waitcnt vmcnt(4) lgkmcnt(5)
s_barrier
T a[102:103],v219,36864
Dn v254,s[12:15],0
M v[116:119],v[196:199],a[84:87],v[116:119]
T a[104:105],v219,40960
v_mul_f32 v49,s58,v49
M v[84:87],v[196:199],a[76:79],v[84:87]
T a[106:107],v219,45056
v_mul_f32 v50,s58,v50
M v[84:87],v[192:195],a[72:75],v[84:87]
T a[108:109],v220,32768
v_mul_f32 v51,s58,v51
M v[88:91],a[216:219],a[72:75],v[88:91]
T a[110:111],v220,36864
v_mul_f32 v52,s58,v52
M v[88:91],a[220:223],a[76:79],v[88:91]
T a[112:113],v220,40960
Dn v255,s[12:15],1024
M v[120:123],a[220:223],a[84:87],v[120:123]
T a[114:115],v220,45056
v_mul_f32 v53,s58,v53
M v[120:123],a[216:219],a[80:83],v[120:123]
T a[116:117],v221,32768
v_mul_f32 v54,s58,v54
M v[124:127],a[224:227],a[80:83],v[124:127]
T a[118:119],v221,36864
v_mul_f32 v55,s58,v55
M v[124:127],a[228:231],a[84:87],v[124:127]
T a[120:121],v221,40960
C v48,v48,v49
M v[92:95],a[228:231],a[76:79],v[92:95]
T a[122:123],v221,45056
Dn v254,s[12:15],2048
M v[92:95],a[224:227],a[72:75],v[92:95]
T a[124:125],v222,32768
C v49,v50,v51
M v[96:99],a[232:235],a[72:75],v[96:99]
T a[126:127],v222,36864
C v50,v52,v53
M v[96:99],a[236:239],a[76:79],v[96:99]
T a[128:129],v222,40960
C v51,v54,v55
M v[128:131],a[236:239],a[84:87],v[128:131]
T a[130:131],v222,45056
v_mul_f32 v40,s58,v40
M v[128:131],a[232:235],a[80:83],v[128:131]
T a[132:133],v223,32768
Dn v255,s[12:15],3072
M v[132:135],a[240:243],a[80:83],v[132:135]
s_add_u32 m0,s45,49152
T a[134:135],v223,36864
v_mul_f32 v41,s58,v41
M v[132:135],a[244:247],a[84:87],v[132:135]
s_add_u32 s20,s92,0
T a[136:137],v223,40960
v_mul_f32 v42,s58,v42
M v[100:103],a[244:247],a[76:79],v[100:103]
T a[138:139],v223,45056
v_mul_f32 v43,s58,v43
M v[100:103],a[240:243],a[72:75],v[100:103]
s_waitcnt lgkmcnt(8)
R a[140:143],v210,0
v_mul_f32 v44,s58,v44
M v[72:75],v[232:235],a[144:147],v[72:75]
R a[248:251],v211,0
D v247,s[20:23],0
M v[72:75],a[96:99],a[148:151],v[72:75]
s_add_u32 s20,s92,7168
R a[252:255],v212,0
v_mul_f32 v45,s58,v45
M v[104:107],a[96:99],a[156:159],v[104:107]
R a[216:219],v213,0
v_mul_f32 v46,s58,v46
M v[104:107],v[232:235],a[152:155],v[104:107]
v_permlane16_swap_b32 v0,v2
M v[136:139],v[232:235],a[160:163],v[136:139]
v_permlane16_swap_b32 v1,v3
M v[136:139],a[96:99],a[164:167],v[136:139]
R a[32:35],v244,0
D v247,s[20:23],1024
M v[76:79],a[100:103],a[144:147],v[76:79]
s_add_u32 s20,s92,14336
v_accvgpr_write_b32 a0,v0
v_accvgpr_write_b32 a1,v1
M v[76:79],a[104:107],a[148:151],v[76:79]
v_accvgpr_write_b32 a2,v2
v_accvgpr_write_b32 a3,v3
M v[108:111],a[104:107],a[156:159],v[108:111]
v_permlane16_swap_b32 v8,v10
M v[108:111],a[100:103],a[152:155],v[108:111]
v_permlane16_swap_b32 v9,v11
M v[140:143],a[100:103],a[160:163],v[140:143]
R a[36:39],v251,0
D v247,s[20:23],2048
M v[140:143],a[104:107],a[164:167],v[140:143]
s_add_u32 s20,s92,21504
v_accvgpr_write_b32 a4,v8
v_accvgpr_write_b32 a5,v9
M v[80:83],a[108:111],a[144:147],v[80:83]
v_accvgpr_write_b32 a6,v10
v_accvgpr_write_b32 a7,v11
M v[80:83],a[112:115],a[148:151],v[80:83]
v_permlane16_swap_b32 v16,v18
M v[112:115],a[112:115],a[156:159],v[112:115]
v_permlane16_swap_b32 v17,v19
M v[112:115],a[108:111],a[152:155],v[112:115]
R a[40:43],v252,0
D v247,s[20:23],3072
M v[116:119],a[116:119],a[152:155],v[116:119]
s_add_u32 m0,s45,98304
R a[44:47],v253,0
v_accvgpr_write_b32 a8,v16
M v[116:119],a[120:123],a[156:159],v[116:119]
s_add_u32 s3,s65,0
v_accvgpr_write_b32 a9,v17
v_accvgpr_write_b32 a10,v18
M v[84:87],a[120:123],a[148:151],v[84:87]
s_add_u32 s12,s3,s51
T a[220:221],v224,32768
v_accvgpr_write_b32 a11,v19
M v[84:87],a[116:119],a[144:147],v[84:87]
s_waitcnt lgkmcnt(3)
v_permlane16_swap_b32 v24,v26
M v[88:91],a[124:127],a[144:147],v[88:91]
Dn v254,s[12:15],0
v_accvgpr_write_b32 a12,v24
M v[88:91],a[128:131],a[148:151],v[88:91]
v_permlane16_swap_b32 v25,v27
M v[120:123],a[128:131],a[156:159],v[120:123]
v_accvgpr_write_b32 a13,v25
v_accvgpr_write_b32 a14,v26
M v[120:123],a[124:127],a[152:155],v[120:123]
T a[222:223],v224,36864
v_accvgpr_write_b32 a15,v27
M v[124:127],a[132:135],a[152:155],v[124:127]
Dn v255,s[12:15],1024
v_mul_f32 v47,s58,v47
M v[124:127],a[136:139],a[156:159],v[124:127]
T a[224:225],v224,40960
C v40,v40,v41
M v[92:95],a[136:139],a[148:151],v[92:95]
v_permlane16_swap_b32 v56,v58
M v[92:95],a[132:135],a[144:147],v[92:95]
T a[226:227],v224,45056
C v41,v42,v43
M v[144:147],a[140:143],a[0:3],0
Dn v254,s[12:15],2048
C v42,v44,v45
M v[144:147],a[248:251],a[4:7],v[144:147]
v_permlane16_swap_b32 v57,v59
M v[144:147],a[252:255],a[8:11],v[144:147]
C v43,v46,v47
v_accvgpr_write_b32 a28,v56
M v[144:147],a[216:219],a[12:15],v[144:147]
v_permlane16_swap_b32 v48,v50
v_permlane16_swap_b32 v49,v51
v_accvgpr_write_b32 a29,v57
v_accvgpr_write_b32 a30,v58
v_accvgpr_write_b32 a31,v59
s_nop 1
M v[148:151],a[216:219],a[28:31],0
Dn v255,s[12:15],3072
v_mul_f32 v32,s58,v32
v_mul_f32 v33,s58,v33
v_mul_f32 v34,s58,v34
v_mul_f32 v35,s58,v35
v_mul_f32 v36,s58,v36
v_mul_f32 v37,s58,v37
v_mul_f32 v38,s58,v38
v_mul_f32 v39,s58,v39
v_permlane16_swap_b32 v40,v42
v_permlane16_swap_b32 v41,v43
v_accvgpr_write_b32 a24,v48
v_accvgpr_write_b32 a25,v49
v_accvgpr_write_b32 a26,v50
v_accvgpr_write_b32 a27,v51
s_nop 1
M v[148:151],a[252:255],a[24:27],v[148:151]
s_add_u32 m0,s45,114688
C v32,v32,v33
v_accvgpr_write_b32 a20,v40
v_accvgpr_write_b32 a21,v41
v_accvgpr_write_b32 a22,v42
v_accvgpr_write_b32 a23,v43
s_nop 1
M v[148:151],a[248:251],a[20:23],v[148:151]
s_add_u32 s16,s36,512
T a[228:229],v225,32768
C v33,v34,v35
C v34,v36,v37
C v35,v38,v39
T a[230:231],v225,36864
v_permlane16_swap_b32 v32,v34
v_permlane16_swap_b32 v33,v35
v_accvgpr_write_b32 a16,v32
v_accvgpr_write_b32 a17,v33
v_accvgpr_write_b32 a18,v34
v_accvgpr_write_b32 a19,v35
s_nop 1
M v[148:151],a[140:143],a[16:19],v[148:151]
T a[232:233],v225,40960
T a[234:235],v225,45056
M v[160:163],a[140:143],a[32:35],0
T a[236:237],v218,49152
v_max3_f32 v196,v144,v145,v146
M v[160:163],a[248:251],a[36:39],v[160:163]
s_waitcnt lgkmcnt(5)
T a[238:239],v218,53248
T a[240:241],v218,57344
M v[160:163],a[252:255],a[40:43],v[160:163]
T a[242:243],v218,61440
v_max3_f32 v200,v148,v149,v150
M v[160:163],a[216:219],a[44:47],v[160:163]
T a[244:245],v219,49152
T a[246:247],v219,53248
M v[96:99],a[220:223],a[144:147],v[96:99]
T v[232:233],v219,57344
v_max_f32 v196,v196,v147
M v[96:99],a[224:227],a[148:151],v[96:99]
T v[234:235],v219,61440
v_max_f32 v200,v200,v151
M v[128:131],a[224:227],a[156:159],v[128:131]
R a[96:99],v214,0
v_max3_f32 v204,v160,v161,v162
M v[128:131],a[220:223],a[152:155],v[128:131]
s_waitcnt lgkmcnt(11)
R a[100:103],v215,0
v_max_f32 v204,v204,v163
M v[132:135],a[228:231],a[152:155],v[132:135]
s_waitcnt lgkmcnt(10)
s_cmp_lg_u32 s59,0
s_cbranch_scc1 L_mx0
L_mr0:
M v[132:135],a[232:235],a[156:159],v[132:135]
R a[104:107],v216,0
v_mov_b32 v205,v204
M v[100:103],a[232:235],a[148:151],v[100:103]
R a[108:111],v217,0
v_mov_b32 v197,v196
M v[100:103],a[228:231],a[144:147],v[100:103]
s_waitcnt lgkmcnt(8)
v_permlane16_swap_b32 v204,v205
M v[72:75],a[236:239],a[168:171],v[72:75]
R a[112:115],v210,4096
v_max_f32 v204,v204,v205
M v[72:75],a[240:243],a[172:175],v[72:75]
R a[116:119],v211,4096
v_mov_b32 v205,v204
M v[104:107],a[240:243],a[180:183],v[104:107]
R a[120:123],v212,4096
R a[124:127],v213,4096
M v[104:107],a[236:239],a[176:179],v[104:107]
v_permlane32_swap_b32 v204,v205
M v[136:139],a[236:239],a[184:187],v[136:139]
T a[128:129],v220,49152
v_min_f32_e64 v204,-v204,-v205
M v[136:139],a[240:243],a[188:191],v[136:139]
s_waitcnt lgkmcnt(7)
v_permlane16_swap_b32 v196,v197
M v[76:79],a[244:247],a[168:171],v[76:79]
v_mov_b32 v205,v204
v_mov_b32 v206,v204
M v[76:79],v[232:235],a[172:175],v[76:79]
v_mov_b32 v207,v204
v_max_f32 v196,v196,v197
M v[108:111],v[232:235],a[180:183],v[108:111]
v_mov_b32 v197,v196
v_mov_b32 v201,v200
M v[108:111],a[244:247],a[176:179],v[108:111]
T a[130:131],v220,53248
T a[132:133],v220,57344
M v[140:143],a[244:247],a[184:187],v[140:143]
v_permlane32_swap_b32 v196,v197
M v[140:143],v[232:235],a[188:191],v[140:143]
T a[134:135],v220,61440
v_min_f32_e64 v196,-v196,-v197
M v[160:163],a[96:99],a[32:35],v[204:207]
v_mov_b32 v197,v196
v_mov_b32 v198,v196
M v[160:163],a[100:103],a[36:39],v[160:163]
s_waitcnt lgkmcnt(3)
T a[136:137],v221,49152
v_mov_b32 v199,v196
M v[160:163],a[104:107],a[40:43],v[160:163]
v_permlane16_swap_b32 v200,v201
M v[160:163],a[108:111],a[44:47],v[160:163]
T a[138:139],v221,53248
v_max_f32 v200,v200,v201
M v[152:155],a[112:115],a[0:3],v[196:199]
T a[140:141],v221,57344
v_mov_b32 v201,v200
M v[152:155],a[116:119],a[4:7],v[152:155]
T a[142:143],v221,61440
T a[248:249],v222,49152
M v[152:155],a[120:123],a[8:11],v[152:155]
v_permlane32_swap_b32 v200,v201
M v[152:155],a[124:127],a[12:15],v[152:155]
T a[250:251],v222,53248
v_min_f32_e64 v200,-v200,-v201
T a[252:253],v222,57344
v_mov_b32 v201,v200
v_mov_b32 v202,v200
v_mov_b32 v203,v200
s_nop 1
M v[156:159],a[124:127],a[28:31],v[200:203]
T a[254:255],v222,61440
R a[216:219],v210,8192
M v[156:159],a[120:123],a[24:27],v[156:159]
R a[220:223],v211,8192
v_add_f32 v144,v144,v196
M v[156:159],a[116:119],a[20:23],v[156:159]
R a[224:227],v212,8192
R a[228:231],v213,8192
M v[156:159],a[112:115],a[16:19],v[156:159]
s_waitcnt lgkmcnt(9)
T a[232:233],v223,49152
v_add_f32 v145,v145,v196
M v[80:83],a[128:131],a[168:171],v[80:83]
v_add_f32 v146,v146,v196
v_add_f32 v147,v147,v196
M v[80:83],a[132:135],a[172:175],v[80:83]
T a[234:235],v223,53248
v_add_f32 v148,v148,v200
M v[112:115],a[132:135],a[180:183],v[112:115]
E v144
M v[112:115],a[128:131],a[176:179],v[112:115]
E v145
M v[116:119],a[136:139],a[176:179],v[116:119]
s_waitcnt lgkmcnt(7)
T a[236:237],v223,57344
C v164,v144,v145
M v[116:119],a[140:143],a[180:183],v[116:119]
E v146
M v[84:87],a[140:143],a[172:175],v[84:87]
T a[238:239],v223,61440
T a[240:241],v224,49152
M v[84:87],a[136:139],a[168:171],v[84:87]
E v147
M v[88:91],a[248:251],a[168:171],v[88:91]
s_waitcnt lgkmcnt(4)
C v165,v146,v147
v_add_f32 v149,v149,v200
M v[88:91],a[252:255],a[172:175],v[88:91]
v_add_f32 v150,v150,v200
v_add_f32 v151,v151,v200
M v[120:123],a[252:255],a[180:183],v[120:123]
T a[242:243],v224,53248
T a[244:245],v224,57344
M v[120:123],a[248:251],a[176:179],v[120:123]
E v148
M v[144:147],a[216:219],a[0:3],v[196:199]
T a[246:247],v224,61440
T v[232:233],v225,49152
M v[144:147],a[220:223],a[4:7],v[144:147]
E v149
M v[144:147],a[224:227],a[8:11],v[144:147]
E v150
M v[144:147],a[228:231],a[12:15],v[144:147]
E v151
C v168,v148,v149
C v169,v150,v151
M v[148:151],a[228:231],a[28:31],v[200:203]
T v[234:235],v225,53248
T a[96:97],v225,57344
M v[148:151],a[224:227],a[24:27],v[148:151]
T a[98:99],v225,61440
v_mul_f32 v136,s58,v136
M v[148:151],a[220:223],a[20:23],v[148:151]
R a[100:103],v210,12288
R a[104:107],v211,12288
M v[148:151],a[216:219],a[16:19],v[148:151]
s_waitcnt lgkmcnt(7)
R a[108:111],v212,12288
v_mul_f32 v137,s58,v137
M v[92:95],a[232:235],a[168:171],v[92:95]
R a[112:115],v213,12288
v_mul_f32 v138,s58,v138
M v[92:95],a[236:239],a[172:175],v[92:95]
E v160
M v[124:127],a[236:239],a[180:183],v[124:127]
E v161
M v[124:127],a[232:235],a[176:179],v[124:127]
E v162
M v[128:131],a[240:243],a[176:179],v[128:131]
s_waitcnt lgkmcnt(4)
s_barrier
R a[144:147],v214,16384
v_mul_f32 v139,s58,v139
M v[128:131],a[244:247],a[180:183],v[128:131]
E v163
M v[96:99],a[244:247],a[172:175],v[96:99]
v_mul_f32 v140,s58,v140
v_mul_f32 v141,s58,v141
M v[96:99],a[240:243],a[168:171],v[96:99]
v_mul_f32 v142,s58,v142
v_mul_f32 v143,s58,v143
M v[100:103],v[232:235],a[168:171],v[100:103]
C v136,v136,v137
C v208,v160,v161
M v[100:103],a[96:99],a[172:175],v[100:103]
C v137,v138,v139
C v209,v162,v163
M v[132:135],a[96:99],a[180:183],v[132:135]
C v138,v140,v141
C v139,v142,v143
M v[132:135],v[232:235],a[176:179],v[132:135]
s_waitcnt lgkmcnt(1)
R a[148:151],v215,16384
E v152
E v153
E v154
E v155
v_permlane16_swap_b32 v136,v138
v_permlane16_swap_b32 v137,v139
ds_write_b64 v242,v[208:209] offset:0
C v166,v152,v153
C v167,v154,v155
M v[152:155],a[100:103],a[0:3],v[196:199]
R a[152:155],v216,16384
ds_write_b128 v244,v[136:139]
D v230,s[16:19],0
M v[152:155],a[104:107],a[4:7],v[152:155]
R a[156:159],v217,16384
v_xor_b32 v251,1024,v244
M v[152:155],a[108:111],a[8:11],v[152:155]
E v156
M v[152:155],a[112:115],a[12:15],v[152:155]
R a[160:163],v210,16384
E v157
E v158
E v159
C v170,v156,v157
C v171,v158,v159
M v[156:159],a[112:115],a[28:31],v[200:203]
s_waitcnt vmcnt(9) lgkmcnt(2)
s_barrier
R a[164:167],v211,16384
D v231,s[16:19],1024
E v148
E v149
E v150
M v[156:159],a[108:111],a[24:27],v[156:159]
s_add_u32 s16,s36,129536
R a[168:171],v212,16384
R a[172:175],v213,16384
E v151
C v176,v148,v149
E v144
M v[156:159],a[104:107],a[20:23],v[156:159]
R a[176:179],v210,20480
D v230,s[16:19],2048
C v177,v150,v151
E v145
E v146
M v[156:159],a[100:103],a[16:19],v[156:159]
R a[180:183],v211,20480
R a[184:187],v212,20480
E v147
C v172,v144,v145
E v152
M v[160:163],a[144:147],a[32:35],v[204:207]
R a[188:191],v213,20480
D v231,s[16:19],3072
C v173,v146,v147
E v153
E v154
M v[160:163],a[148:151],a[36:39],v[160:163]
s_add_u32 m0,s46,151552
T a[248:249],v220,0
E v155
C v174,v152,v153
E v156
E v157
M v[160:163],a[152:155],a[40:43],v[160:163]
s_waitcnt lgkmcnt(4)
T a[250:251],v220,4096
C v175,v154,v155
E v158
E v159
C v178,v156,v157
v_xor_b32 v252,2048,v244
M v[160:163],a[156:159],a[44:47],v[160:163]
s_and_b32 s20,s92,0xffffff7f
T a[252:253],v220,8192
C v179,v158,v159
v_xor_b32 v253,3072,v244
v_mul_f32 v72,s58,v72
v_mul_f32 v73,s58,v73
v_mul_f32 v74,s58,v74
v_mul_f32 v75,s58,v75
v_mul_f32 v76,s58,v76
M v[148:151],a[160:163],a[16:19],v[200:203]
T a[254:255],v220,12288
D v240,s[20:23],0
E v160
E v161
E v162
M v[148:151],a[164:167],a[20:23],v[148:151]
s_add_u32 m0,s45,0
R a[216:219],v210,24576
E v163
C v208,v160,v161
v_mul_f32 v77,s58,v77
v_mul_f32 v78,s58,v78
v_mul_f32 v79,s58,v79
C v72,v72,v73
M v[148:151],a[168:171],a[24:27],v[148:151]
s_add_u32 s8,s67,0
R a[220:223],v211,24576
C v209,v162,v163
C v73,v74,v75
v_mul_f32 v104,s58,v104
v_mul_f32 v105,s58,v105
v_mul_f32 v106,s58,v106
v_mul_f32 v107,s58,v107
v_mul_f32 v108,s58,v108
M v[148:151],a[172:175],a[28:31],v[148:151]
R a[224:227],v212,24576
Dn v245,s[8:11],0
C v74,v76,v77
C v75,v78,v79
v_mul_f32 v109,s58,v109
v_mul_f32 v110,s58,v110
v_mul_f32 v111,s58,v111
C v104,v104,v105
M v[144:147],a[172:175],a[12:15],v[196:199]
R a[228:231],v213,24576
E v148
E v149
E v150
C v105,v106,v107
M v[144:147],a[168:171],a[8:11],v[144:147]
T a[232:233],v221,0
Dn v246,s[8:11],1024
M v[144:147],a[164:167],a[4:7],v[144:147]
T a[234:235],v221,4096
C v184,v148,v149
M v[144:147],a[160:163],a[0:3],v[144:147]
T a[236:237],v221,8192
C v106,v108,v109
M v[152:155],a[176:179],a[0:3],v[196:199]
L_pg3:
s_cmp_eq_u32 s47,1
s_cbranch_scc1 L_bkT0_0
s_waitcnt lgkmcnt(5)
T a[238:239],v221,12288
C v107,v110,v111
M v[152:155],a[180:183],a[4:7],v[152:155]
T a[240:241],v218,0
v_mul_f32 v80,s58,v80
M v[152:155],a[184:187],a[8:11],v[152:155]
T a[242:243],v218,4096
Dn v245,s[8:11],2048
M v[152:155],a[188:191],a[12:15],v[152:155]
E v144
M v[156:159],a[188:191],a[28:31],v[200:203]
T a[244:245],v218,8192
T a[246:247],v218,12288
M v[156:159],a[184:187],a[24:27],v[156:159]
E v145
M v[156:159],a[180:183],a[20:23],v[156:159]
R a[80:83],v244,0
C v180,v144,v145
M v[156:159],a[176:179],a[16:19],v[156:159]
R a[84:87],v251,0
Dn v246,s[8:11],3072
M v[8:11],a[248:251],v[164:167],0
s_add_u32 m0,s45,65536
E v146
M v[8:11],a[252:255],v[172:175],v[8:11]
s_add_u32 s20,s93,0
E v147
M v[40:43],a[252:255],v[176:179],0
R a[88:91],v252,0
C v181,v146,v147
M v[40:43],a[248:251],v[168:171],v[40:43]
E v151
M v[144:147],a[216:219],a[0:3],v[196:199]
R a[92:95],v253,0
D v247,s[20:23],0
M v[144:147],a[220:223],a[4:7],v[144:147]
s_waitcnt lgkmcnt(4)
R a[196:199],v243,0
C v185,v150,v151
M v[144:147],a[224:227],a[8:11],v[144:147]
s_add_u32 s20,s93,7168
R a[200:203],v243,1024
T a[144:145],v219,0
M v[144:147],a[228:231],a[12:15],v[144:147]
T a[146:147],v219,4096
v_mul_f32 v81,s58,v81
M v[148:151],a[228:231],a[28:31],v[200:203]
T a[148:149],v219,8192
T a[150:151],v219,12288
M v[148:151],a[224:227],a[24:27],v[148:151]
T a[152:153],v222,0
D v247,s[20:23],1024
M v[148:151],a[220:223],a[20:23],v[148:151]
s_add_u32 s20,s93,14336
T a[154:155],v222,4096
v_mul_f32 v82,s58,v82
M v[148:151],a[216:219],a[16:19],v[148:151]
T a[156:157],v222,8192
v_mul_f32 v83,s58,v83
M v[12:15],a[232:235],v[164:167],0
s_waitcnt vmcnt(6) lgkmcnt(7)
s_barrier
T a[158:159],v222,12288
D v247,s[20:23],2048
E v152
E v153
E v154
M v[12:15],a[236:239],v[172:175],v[12:15]
s_add_u32 s20,s93,21504
R a[160:163],v210,28672
E v155
C v182,v152,v153
E v156
E v157
M v[44:47],a[236:239],v[176:179],0
s_xor_b32 s3,s5,0
R a[164:167],v211,28672
D v247,s[20:23],3072
C v183,v154,v155
E v158
E v159
C v186,v156,v157
M v[44:47],a[232:235],v[168:171],v[44:47]
s_lshl_b32 s3,s3,4
R a[168:171],v212,28672
C v187,v158,v159
E v144
E v145
E v146
M v[32:35],a[240:243],v[168:171],0
s_sub_u32 s100,s3,147456
R a[172:175],v213,28672
E v147
C v188,v144,v145
E v148
E v149
M v[32:35],a[244:247],v[176:179],v[32:35]
s_add_u32 m0,s45,131072
T a[176:177],v223,0
v_add_lshl_u32 v238,s100,v244,4
C v189,v146,v147
E v150
E v151
C v192,v148,v149
M v[0:3],a[244:247],v[172:175],0
s_add_u32 s16,s37,512
buffer_store_byte v239,v238,s[84:87],s5 offen sc1
C v193,v150,v151
v_permlane16_swap_b32 v72,v74
v_permlane16_swap_b32 v73,v75
M v[0:3],a[240:243],v[164:167],v[0:3]
T a[178:179],v223,4096
v_accvgpr_write_b32 a48,v72
v_accvgpr_write_b32 a49,v73
v_accvgpr_write_b32 a50,v74
v_accvgpr_write_b32 a51,v75
v_permlane16_swap_b32 v104,v106
M v[64:67],a[240:243],a[196:199],0
T a[180:181],v223,8192
D v230,s[16:19],0
v_permlane16_swap_b32 v105,v107
v_accvgpr_write_b32 a64,v104
M v[64:67],a[244:247],a[200:203],v[64:67]
s_waitcnt lgkmcnt(2)
T a[182:183],v223,12288
v_accvgpr_write_b32 a65,v105
M v[4:7],a[144:147],v[164:167],0
T a[184:185],v224,0
v_accvgpr_write_b32 a66,v106
M v[4:7],a[148:151],v[172:175],v[4:7]
T a[186:187],v224,4096
v_accvgpr_write_b32 a67,v107
M v[36:39],a[148:151],v[176:179],0
T a[188:189],v224,8192
D v231,s[16:19],1024
M v[36:39],a[144:147],v[168:171],v[36:39]
s_add_u32 s16,s37,129536
T a[190:191],v224,12288
v_mul_f32 v84,s58,v84
M v[68:71],a[144:147],a[196:199],0
T a[248:249],v225,0
v_mul_f32 v85,s58,v85
M v[68:71],a[148:151],a[200:203],v[68:71]
T a[250:251],v225,4096
v_mul_f32 v86,s58,v86
M v[16:19],a[152:155],v[164:167],0
T a[252:253],v225,8192
v_mul_f32 v87,s58,v87
M v[16:19],a[156:159],v[172:175],v[16:19]
T a[254:255],v225,12288
D v230,s[16:19],2048
M v[48:51],a[156:159],v[176:179],0
R a[216:219],v214,32768
C v80,v80,v81
M v[48:51],a[152:155],v[168:171],v[48:51]
R a[220:223],v215,32768
C v81,v82,v83
M v[152:155],a[160:163],a[0:3],v[196:199]
ds_write_b64 v242,v[208:209] offset:2048
M v[152:155],a[164:167],a[4:7],v[152:155]
R a[224:227],v216,32768
D v231,s[16:19],3072
M v[152:155],a[168:171],a[8:11],v[152:155]
s_add_u32 m0,s46,155648
R a[228:231],v217,32768
C v82,v84,v85
M v[152:155],a[172:175],a[12:15],v[152:155]
s_and_b32 s20,s94,0xffffff7f
R a[232:235],v210,32768
C v83,v86,v87
M v[156:159],a[172:175],a[28:31],v[200:203]
R a[236:239],v211,32768
v_mul_f32 v112,s58,v112
M v[156:159],a[168:171],a[24:27],v[156:159]
R a[240:243],v212,32768
v_mul_f32 v113,s58,v113
M v[156:159],a[164:167],a[20:23],v[156:159]
R a[244:247],v213,32768
D v240,s[20:23],0
M v[156:159],a[160:163],a[16:19],v[156:159]
s_waitcnt lgkmcnt(7)
R a[96:99],v226,16384
v_mul_f32 v114,s58,v114
M v[20:23],a[176:179],v[164:167],0
s_add_u32 m0,s45,81920
T a[144:145],v218,32768
v_mul_f32 v115,s58,v115
M v[20:23],a[180:183],v[172:175],v[20:23]
s_add_u32 s3,s66,0
T a[146:147],v218,36864
v_mul_f32 v116,s58,v116
M v[52:55],a[180:183],v[176:179],0
s_add_u32 s12,s3,s51
R a[100:103],v227,16384
v_mul_f32 v117,s58,v117
M v[52:55],a[176:179],v[168:171],v[52:55]
T a[148:149],v218,40960
v_mul_f32 v118,s58,v118
M v[56:59],a[184:187],v[168:171],0
T a[150:151],v218,45056
v_mul_f32 v119,s58,v119
M v[56:59],a[188:191],v[176:179],v[56:59]
R a[108:111],v227,18432
C v112,v112,v113
M v[24:27],a[188:191],v[172:175],0
R a[104:107],v226,18432
C v113,v114,v115
M v[24:27],a[184:187],v[164:167],v[24:27]
R a[112:115],v228,0
C v114,v116,v117
M v[28:31],a[248:251],v[164:167],0
R a[116:119],v229,0
C v115,v118,v119
M v[28:31],a[252:255],v[172:175],v[28:31]
T a[152:153],v219,32768
v_mul_f32 v88,s58,v88
M v[60:63],a[252:255],v[176:179],0
s_waitcnt lgkmcnt(7)
s_barrier
T a[154:155],v219,36864
Dn v254,s[12:15],0
E v152
E v153
E v154
M v[60:63],a[248:251],v[168:171],v[60:63]
T a[156:157],v219,40960
E v155
C v190,v152,v153
E v156
E v157
M a[212:215],a[192:195],a[196:199],0
T a[158:159],v219,45056
Dn v255,s[12:15],1024
C v191,v154,v155
E v158
E v159
C v194,v156,v157
M a[212:215],a[192:195],a[200:203],a[212:215]
R a[160:163],v210,36864
C v195,v158,v159
v_permlane16_swap_b32 v80,v82
v_permlane16_swap_b32 v81,v83
v_permlane16_swap_b32 v112,v114
M a[204:207],a[192:195],v[164:167],0
R a[164:167],v211,36864
Dn v254,s[12:15],2048
v_accvgpr_write_b32 a52,v80
v_accvgpr_write_b32 a53,v81
v_accvgpr_write_b32 a54,v82
v_accvgpr_write_b32 a55,v83
v_permlane16_swap_b32 v113,v115
M a[204:207],a[192:195],v[172:175],a[204:207]
R a[168:171],v212,36864
v_accvgpr_write_b32 a68,v112
v_accvgpr_write_b32 a69,v113
v_accvgpr_write_b32 a70,v114
v_accvgpr_write_b32 a71,v115
v_mul_f32 v89,s58,v89
v_mul_f32 v90,s58,v90
v_mul_f32 v91,s58,v91
M a[208:211],a[192:195],v[168:171],0
R a[172:175],v213,36864
Dn v255,s[12:15],3072
v_mul_f32 v92,s58,v92
v_mul_f32 v93,s58,v93
v_mul_f32 v94,s58,v94
v_mul_f32 v95,s58,v95
C v88,v88,v89
v_mul_f32 v120,s58,v120
M a[208:211],a[192:195],v[176:179],a[208:211]
s_add_u32 m0,s45,16384
T a[176:177],v220,32768
C v89,v90,v91
v_mul_f32 v121,s58,v121
v_mul_f32 v122,s58,v122
v_mul_f32 v123,s58,v123
v_mul_f32 v124,s58,v124
v_mul_f32 v125,s58,v125
v_mul_f32 v126,s58,v126
M v[160:163],a[216:219],a[32:35],v[204:207]
s_add_u32 s8,s68,0
T a[178:179],v220,36864
C v90,v92,v93
C v91,v94,v95
v_mul_f32 v127,s58,v127
C v120,v120,v121
v_mul_f32 v128,s58,v128
v_mul_f32 v129,s58,v129
v_mul_f32 v130,s58,v130
M v[160:163],a[220:223],a[36:39],v[160:163]
T a[180:181],v220,40960
Dn v245,s[8:11],0
v_permlane16_swap_b32 v88,v90
v_permlane16_swap_b32 v89,v91
C v121,v122,v123
v_mul_f32 v131,s58,v131
M v[160:163],a[224:227],a[40:43],v[160:163]
T a[182:183],v220,45056
v_accvgpr_write_b32 a56,v88
v_accvgpr_write_b32 a57,v89
v_accvgpr_write_b32 a58,v90
v_accvgpr_write_b32 a59,v91
C v122,v124,v125
C v123,v126,v127
v_mul_f32 v132,s58,v132
M v[160:163],a[228:231],a[44:47],v[160:163]
T a[184:185],v221,32768
Dn v246,s[8:11],1024
v_permlane16_swap_b32 v120,v122
v_permlane16_swap_b32 v121,v123
v_mul_f32 v133,s58,v133
v_mul_f32 v134,s58,v134
M v[144:147],a[232:235],a[0:3],v[196:199]
T a[186:187],v221,36864
v_accvgpr_write_b32 a72,v120
v_accvgpr_write_b32 a73,v121
v_accvgpr_write_b32 a74,v122
v_accvgpr_write_b32 a75,v123
v_mul_f32 v135,s58,v135
C v128,v128,v129
v_mul_f32 v96,s58,v96
M v[144:147],a[236:239],a[4:7],v[144:147]
T a[188:189],v221,40960
Dn v245,s[8:11],2048
E v160
E v161
E v162
M v[144:147],a[240:243],a[8:11],v[144:147]
T a[190:191],v221,45056
E v163
C v208,v160,v161
C v129,v130,v131
v_mul_f32 v97,s58,v97
v_mul_f32 v98,s58,v98
v_mul_f32 v99,s58,v99
M v[144:147],a[244:247],a[12:15],v[144:147]
T a[248:249],v222,32768
Dn v246,s[8:11],3072
C v209,v162,v163
C v130,v132,v133
C v131,v134,v135
v_mul_f32 v100,s58,v100
v_mul_f32 v101,s58,v101
M v[148:151],a[244:247],a[28:31],v[200:203]
s_add_u32 m0,s45,49152
T a[250:251],v222,36864
v_mul_f32 v102,s58,v102
M v[148:151],a[240:243],a[24:27],v[148:151]
s_add_u32 s20,s94,0
T a[252:253],v222,40960
v_mul_f32 v103,s58,v103
M v[148:151],a[236:239],a[20:23],v[148:151]
T a[254:255],v222,45056
D v247,s[20:23],0
M v[148:151],a[232:235],a[16:19],v[148:151]
s_add_u32 s20,s94,7168
T a[216:217],v220,16384
C v96,v96,v97
M v[72:75],a[144:147],a[96:99],0
s_waitcnt lgkmcnt(5)
T a[218:219],v220,20480
C v97,v98,v99
M v[72:75],a[148:151],a[100:103],v[72:75]
T a[220:221],v220,24576
C v98,v100,v101
M v[104:107],a[148:151],a[108:111],0
T a[222:223],v220,28672
C v99,v102,v103
M v[104:107],a[144:147],a[104:107],v[104:107]
R a[224:227],v210,40960
D v247,s[20:23],1024
M v[136:139],a[144:147],a[112:115],0
s_add_u32 s20,s94,14336
E v144
M v[136:139],a[148:151],a[116:119],v[136:139]
E v145
M v[76:79],a[152:155],a[96:99],0
R a[228:231],v211,40960
C v164,v144,v145
M v[76:79],a[156:159],a[100:103],v[76:79]
E v146
M v[108:111],a[156:159],a[108:111],0
R a[196:199],v243,2048
D v247,s[20:23],2048
M v[108:111],a[152:155],a[104:107],v[108:111]
s_add_u32 s20,s94,21504
E v147
M v[140:143],a[152:155],a[112:115],0
s_xor_b32 s3,s5,1
R a[200:203],v243,3072
C v165,v146,v147
M v[140:143],a[156:159],a[116:119],v[140:143]
s_lshl_b32 s3,s3,4
E v148
M v[152:155],a[160:163],a[0:3],v[196:199]
s_sub_u32 s100,s3,147456
E v149
M v[152:155],a[164:167],a[4:7],v[152:155]
R a[232:235],v212,40960
D v247,s[20:23],3072
M v[152:155],a[168:171],a[8:11],v[152:155]
s_add_u32 m0,s45,98304
R a[236:239],v213,40960
v_add_lshl_u32 v238,s100,v244,4
M v[152:155],a[172:175],a[12:15],v[152:155]
s_add_u32 s3,s67,0
T a[240:241],v221,16384
C v168,v148,v149
M v[156:159],a[172:175],a[28:31],v[200:203]
s_add_u32 s12,s3,s51
E v150
M v[156:159],a[168:171],a[24:27],v[156:159]
E v151
M v[156:159],a[164:167],a[20:23],v[156:159]
T a[242:243],v221,20480
C v169,v150,v151
M v[156:159],a[160:163],a[16:19],v[156:159]
buffer_store_byte v239,v238,s[84:87],s5 offen sc1
M v[80:83],a[176:179],a[96:99],0
E v152
M v[80:83],a[180:183],a[100:103],v[80:83]
E v153
M v[112:115],a[180:183],a[108:111],0
T a[244:245],v221,24576
C v166,v152,v153
M v[112:115],a[176:179],a[104:107],v[112:115]
E v154
M v[116:119],a[184:187],a[104:107],0
E v155
M v[116:119],a[188:191],a[108:111],v[116:119]
T a[246:247],v221,28672
C v167,v154,v155
M v[84:87],a[188:191],a[100:103],0
E v156
M v[84:87],a[184:187],a[96:99],v[84:87]
s_waitcnt lgkmcnt(2)
E v157
M v[88:91],a[248:251],a[96:99],0
s_waitcnt vmcnt(12)
s_barrier
T a[144:145],v218,16384
E v158
E v159
C v170,v156,v157
v_permlane16_swap_b32 v128,v130
M v[88:91],a[252:255],a[100:103],v[88:91]
T a[146:147],v218,20480
C v171,v158,v159
v_permlane16_swap_b32 v129,v131
v_accvgpr_write_b32 a76,v128
v_accvgpr_write_b32 a78,v130
M v[120:123],a[252:255],a[108:111],0
T a[148:149],v218,24576
v_accvgpr_write_b32 a77,v129
v_accvgpr_write_b32 a79,v131
M v[120:123],a[248:251],a[104:107],v[120:123]
ds_write_b64 v242,v[208:209] offset:0
M v[8:11],a[216:219],v[180:183],v[8:11]
T a[150:151],v218,28672
M v[8:11],a[220:223],v[188:191],v[8:11]
v_permlane16_swap_b32 v96,v98
M v[40:43],a[220:223],v[192:195],v[40:43]
T a[152:153],v219,16384
v_accvgpr_write_b32 a60,v96
M v[40:43],a[216:219],v[184:187],v[40:43]
T a[154:155],v219,20480
v_accvgpr_write_b32 a62,v98
M v[144:147],a[224:227],a[0:3],v[196:199]
v_permlane16_swap_b32 v97,v99
M v[144:147],a[228:231],a[4:7],v[144:147]
T a[156:157],v219,24576
v_accvgpr_write_b32 a61,v97
M v[144:147],a[232:235],a[8:11],v[144:147]
T a[158:159],v219,28672
v_accvgpr_write_b32 a63,v99
M v[144:147],a[236:239],a[12:15],v[144:147]
T a[160:161],v222,16384
M v[148:151],a[236:239],a[28:31],v[200:203]
T a[162:163],v222,20480
M v[148:151],a[232:235],a[24:27],v[148:151]
T a[164:165],v222,24576
M v[148:151],a[228:231],a[20:23],v[148:151]
T a[166:167],v222,28672
M v[148:151],a[224:227],a[16:19],v[148:151]
E v144
M v[12:15],a[240:243],v[180:183],v[12:15]
s_waitcnt lgkmcnt(6)
E v145
M v[12:15],a[244:247],v[188:191],v[12:15]
R a[168:171],v210,45056
C v172,v144,v145
M v[44:47],a[244:247],v[192:195],v[44:47]
E v146
M v[44:47],a[240:243],v[184:187],v[44:47]
E v147
M v[32:35],a[144:147],v[184:187],v[32:35]
R a[172:175],v211,45056
C v173,v146,v147
M v[32:35],a[148:151],v[192:195],v[32:35]
R a[176:179],v212,45056
M v[0:3],a[148:151],v[188:191],v[0:3]
R a[180:183],v213,45056
M v[0:3],a[144:147],v[180:183],v[0:3]
E v148
M v[64:67],a[144:147],a[196:199],v[64:67]
E v149
M v[64:67],a[148:151],a[200:203],v[64:67]
T a[184:185],v223,16384
C v176,v148,v149
M v[4:7],a[152:155],v[180:183],v[4:7]
s_waitcnt lgkmcnt(4)
E v150
M v[4:7],a[156:159],v[188:191],v[4:7]
T a[186:187],v223,20480
M v[36:39],a[156:159],v[192:195],v[36:39]
T a[188:189],v223,24576
T a[190:191],v223,28672
M v[36:39],a[152:155],v[184:187],v[36:39]
E v151
M v[68:71],a[152:155],a[196:199],v[68:71]
T a[248:249],v224,16384
C v177,v150,v151
M v[68:71],a[156:159],a[200:203],v[68:71]
T a[250:251],v224,20480
M v[16:19],a[160:163],v[180:183],v[16:19]
T a[252:253],v224,24576
T a[254:255],v224,28672
M v[16:19],a[164:167],v[188:191],v[16:19]
T a[216:217],v225,16384
M v[48:51],a[164:167],v[192:195],v[48:51]
T a[218:219],v225,20480
M v[48:51],a[160:163],v[184:187],v[48:51]
T a[220:221],v225,24576
M v[152:155],a[168:171],a[0:3],v[196:199]
s_waitcnt lgkmcnt(9)
T a[222:223],v225,28672
M v[152:155],a[172:175],a[4:7],v[152:155]
R a[224:227],v214,0
M v[152:155],a[176:179],a[8:11],v[152:155]
R a[228:231],v215,0
M v[152:155],a[180:183],a[12:15],v[152:155]
R a[232:235],v216,0
M v[156:159],a[180:183],a[28:31],v[200:203]
R a[236:239],v217,0
M v[156:159],a[176:179],a[24:27],v[156:159]
R a[240:243],v210,0
M v[156:159],a[172:175],a[20:23],v[156:159]
R a[244:247],v211,0
M v[156:159],a[168:171],a[16:19],v[156:159]
E v152
M v[20:23],a[184:187],v[180:183],v[20:23]
s_waitcnt lgkmcnt(7)
E v153
M v[20:23],a[188:191],v[188:191],v[20:23]
R a[144:147],v212,0
C v174,v152,v153
M v[52:55],a[188:191],v[192:195],v[52:55]
E v154
M v[52:55],a[184:187],v[184:187],v[52:55]
E v155
M v[56:59],a[248:251],v[184:187],v[56:59]
R a[148:151],v213,0
C v175,v154,v155
M v[56:59],a[252:255],v[192:195],v[56:59]
E v156
M v[24:27],a[252:255],v[188:191],v[24:27]
E v157
M v[24:27],a[248:251],v[180:183],v[24:27]
T a[152:153],v223,32768
C v178,v156,v157
M v[28:31],a[216:219],v[180:183],v[28:31]
s_waitcnt lgkmcnt(3)
E v158
M v[28:31],a[220:223],v[188:191],v[28:31]
E v159
M v[60:63],a[220:223],v[192:195],v[60:63]
s_waitcnt vmcnt(9)
s_barrier
T a[154:155],v223,36864
Dn v254,s[12:15],0
C v179,v158,v159
M v[60:63],a[216:219],v[184:187],v[60:63]
T a[156:157],v223,40960
M a[212:215],a[192:195],a[196:199],a[212:215]
T a[158:159],v223,45056
M a[212:215],a[192:195],a[200:203],a[212:215]
T a[160:161],v224,32768
M a[204:207],a[192:195],v[180:183],a[204:207]
T a[162:163],v224,36864
Dn v255,s[12:15],1024
M a[204:207],a[192:195],v[188:191],a[204:207]
L_pg4:
s_cmp_eq_u32 s47,1
s_cbranch_scc1 L_bkT0_1
T a[164:165],v224,40960
M a[208:211],a[192:195],v[184:187],a[208:211]
T a[166:167],v224,45056
M a[208:211],a[192:195],v[192:195],a[208:211]
T a[168:169],v225,32768
M v[160:163],a[224:227],a[32:35],v[204:207]
T a[170:171],v225,36864
M v[160:163],a[228:231],a[36:39],v[160:163]
T a[172:173],v225,40960
Dn v254,s[12:15],2048
M v[160:163],a[232:235],a[40:43],v[160:163]
T a[174:175],v225,45056
M v[160:163],a[236:239],a[44:47],v[160:163]
R a[176:179],v210,4096
M v[144:147],a[240:243],a[0:3],v[196:199]
R a[180:183],v211,4096
M v[144:147],a[244:247],a[4:7],v[144:147]
s_waitcnt lgkmcnt(8)
R a[184:187],v212,4096
M v[144:147],a[144:147],a[8:11],v[144:147]
R a[188:191],v213,4096
Dn v255,s[12:15],3072
M v[144:147],a[148:151],a[12:15],v[144:147]
s_add_u32 m0,s45,32768
E v160
E v161
E v162
E v163
M v[148:151],a[148:151],a[28:31],v[200:203]
s_add_u32 s8,s69,0
R a[120:123],v226,32768
C v208,v160,v161
C v209,v162,v163
M v[148:151],a[144:147],a[24:27],v[148:151]
T a[248:249],v218,49152
Dn v245,s[8:11],0
E v144
E v145
E v146
M v[148:151],a[244:247],a[20:23],v[148:151]
T a[250:251],v218,53248
E v147
C v180,v144,v145
M v[148:151],a[240:243],a[16:19],v[148:151]
R a[124:127],v227,32768
C v181,v146,v147
M v[92:95],a[152:155],a[96:99],0
T a[252:253],v218,57344
Dn v246,s[8:11],1024
M v[92:95],a[156:159],a[100:103],v[92:95]
ds_write_b64 v242,v[208:209] offset:2048
M v[124:127],a[156:159],a[108:111],0
E v148
E v149
E v150
E v151
M v[124:127],a[152:155],a[104:107],v[124:127]
T a[254:255],v218,61440
Dn v245,s[8:11],2048
C v184,v148,v149
C v185,v150,v151
M v[128:131],a[160:163],a[104:107],0
s_waitcnt lgkmcnt(4)
R a[132:135],v227,34816
M v[128:131],a[164:167],a[108:111],v[128:131]
R a[128:131],v226,34816
M v[96:99],a[164:167],a[100:103],0
R a[136:139],v228,2048
M v[96:99],a[160:163],a[96:99],v[96:99]
R a[140:143],v229,2048
Dn v246,s[8:11],3072
M v[100:103],a[168:171],a[96:99],0
s_add_u32 m0,s45,65536
T a[216:217],v219,49152
M v[100:103],a[172:175],a[100:103],v[100:103]
s_add_u32 s20,s95,0
T a[218:219],v219,53248
M v[132:135],a[172:175],a[108:111],0
T a[220:221],v219,57344
T a[222:223],v219,61440
M v[132:135],a[168:171],a[104:107],v[132:135]
T a[224:225],v220,0
M v[152:155],a[176:179],a[0:3],v[196:199]
s_waitcnt lgkmcnt(9)
T a[226:227],v220,4096
D v247,s[20:23],0
M v[152:155],a[180:183],a[4:7],v[152:155]
s_add_u32 s20,s95,7168
T a[228:229],v220,8192
M v[152:155],a[184:187],a[8:11],v[152:155]
T a[230:231],v220,12288
M v[152:155],a[188:191],a[12:15],v[152:155]
R a[232:235],v210,8192
M v[156:159],a[188:191],a[28:31],v[200:203]
R a[236:239],v211,8192
M v[156:159],a[184:187],a[24:27],v[156:159]
R a[196:199],v243,0
D v247,s[20:23],1024
M v[156:159],a[180:183],a[20:23],v[156:159]
s_add_u32 s20,s95,14336
R a[200:203],v243,1024
M v[156:159],a[176:179],a[16:19],v[156:159]
E v152
E v153
E v154
E v155
M v[72:75],a[248:251],a[120:123],v[72:75]
s_waitcnt lgkmcnt(5)
R a[240:243],v212,8192
D v247,s[20:23],2048
C v182,v152,v153
C v183,v154,v155
M v[72:75],a[252:255],a[124:127],v[72:75]
s_add_u32 s20,s95,21504
E v156
E v157
E v158
E v159
M v[104:107],a[252:255],a[132:135],v[104:107]
s_xor_b32 s3,s5,2
R a[244:247],v213,8192
C v186,v156,v157
C v187,v158,v159
M v[104:107],a[248:251],a[128:131],v[104:107]
s_lshl_b32 s3,s3,4
T a[144:145],v221,0
D v247,s[20:23],3072
M v[136:139],a[248:251],a[136:139],v[136:139]
s_sub_u32 s100,s3,147456
T a[146:147],v221,4096
M v[136:139],a[252:255],a[140:143],v[136:139]
s_add_u32 m0,s45,114688
T a[148:149],v221,8192
v_add_lshl_u32 v238,s100,v244,4
M v[76:79],a[216:219],a[120:123],v[76:79]
s_add_u32 s16,s38,512
T a[150:151],v221,12288
M v[76:79],a[220:223],a[124:127],v[76:79]
T a[152:153],v218,0
M v[108:111],a[220:223],a[132:135],v[108:111]
s_waitcnt vmcnt(11) lgkmcnt(6)
s_barrier
buffer_store_byte v239,v238,s[84:87],s5 offen sc1
M v[108:111],a[216:219],a[128:131],v[108:111]
T a[154:155],v218,4096
M v[140:143],a[216:219],a[136:139],v[140:143]
T a[156:157],v218,8192
M v[140:143],a[220:223],a[140:143],v[140:143]
T a[158:159],v218,12288
M v[8:11],a[224:227],v[164:167],v[8:11]
T a[160:161],v219,0
M v[8:11],a[228:231],v[172:175],v[8:11]
T a[162:163],v219,4096
M v[40:43],a[228:231],v[176:179],v[40:43]
T a[164:165],v219,8192
M v[40:43],a[224:227],v[168:171],v[40:43]
T a[166:167],v219,12288
M v[144:147],a[232:235],a[0:3],v[196:199]
T a[168:169],v222,0
M v[144:147],a[236:239],a[4:7],v[144:147]
T a[170:171],v222,4096
M v[144:147],a[240:243],a[8:11],v[144:147]
s_waitcnt lgkmcnt(8)
T a[172:173],v222,8192
M v[144:147],a[244:247],a[12:15],v[144:147]
T a[174:175],v222,12288
D v230,s[16:19],0
M v[148:151],a[244:247],a[28:31],v[200:203]
R a[176:179],v210,12288
M v[148:151],a[240:243],a[24:27],v[148:151]
R a[180:183],v211,12288
M v[148:151],a[236:239],a[20:23],v[148:151]
R a[184:187],v212,12288
M v[148:151],a[232:235],a[16:19],v[148:151]
E v144
E v145
E v146
E v147
M v[12:15],a[144:147],v[164:167],v[12:15]
R a[188:191],v213,12288
D v231,s[16:19],1024
C v188,v144,v145
C v189,v146,v147
M v[12:15],a[148:151],v[172:175],v[12:15]
s_add_u32 s16,s38,129536
E v148
E v149
M v[44:47],a[148:151],v[176:179],v[44:47]
T a[248:249],v223,0
C v192,v148,v149
M v[44:47],a[144:147],v[168:171],v[44:47]
E v150
M v[32:35],a[152:155],v[168:171],v[32:35]
s_waitcnt lgkmcnt(2)
T a[250:251],v223,4096
D v230,s[16:19],2048
M v[32:35],a[156:159],v[176:179],v[32:35]
E v151
M v[0:3],a[156:159],v[172:175],v[0:3]
T a[252:253],v223,8192
C v193,v150,v151
M v[0:3],a[152:155],v[164:167],v[0:3]
T a[254:255],v223,12288
M v[64:67],a[152:155],a[196:199],v[64:67]
T a[216:217],v224,0
M v[64:67],a[156:159],a[200:203],v[64:67]
T a[218:219],v224,4096
D v231,s[16:19],3072
M v[4:7],a[160:163],v[164:167],v[4:7]
s_add_u32 m0,s46,151552
T a[220:221],v224,8192
M v[4:7],a[164:167],v[172:175],v[4:7]
s_and_b32 s20,s96,0xffffff7f
T a[222:223],v224,12288
M v[36:39],a[164:167],v[176:179],v[36:39]
T a[224:225],v225,0
M v[36:39],a[160:163],v[168:171],v[36:39]
T a[226:227],v225,4096
M v[68:71],a[160:163],a[196:199],v[68:71]
T a[228:229],v225,8192
D v240,s[20:23],0
M v[68:71],a[164:167],a[200:203],v[68:71]
s_add_u32 m0,s45,81920
T a[230:231],v225,12288
M v[16:19],a[168:171],v[164:167],v[16:19]
s_add_u32 s3,s68,0
R a[232:235],v214,16384
M v[16:19],a[172:175],v[172:175],v[16:19]
s_add_u32 s12,s3,s51
R a[236:239],v215,16384
M v[48:51],a[172:175],v[176:179],v[48:51]
R a[240:243],v216,16384
M v[48:51],a[168:171],v[168:171],v[48:51]
R a[244:247],v217,16384
M v[152:155],a[176:179],a[0:3],v[196:199]
R a[144:147],v210,16384
M v[152:155],a[180:183],a[4:7],v[152:155]
R a[148:151],v211,16384
M v[152:155],a[184:187],a[8:11],v[152:155]
s_waitcnt lgkmcnt(8)
R a[152:155],v212,16384
M v[152:155],a[188:191],a[12:15],v[152:155]
R a[156:159],v213,16384
M v[156:159],a[188:191],a[28:31],v[200:203]
T a[160:161],v220,49152
M v[156:159],a[184:187],a[24:27],v[156:159]
T a[162:163],v220,53248
M v[156:159],a[180:183],a[20:23],v[156:159]
T a[164:165],v220,57344
M v[156:159],a[176:179],a[16:19],v[156:159]
E v152
M v[20:23],a[248:251],v[164:167],v[20:23]
E v153
M v[20:23],a[252:255],v[172:175],v[20:23]
T a[166:167],v220,61440
C v190,v152,v153
M v[52:55],a[252:255],v[176:179],v[52:55]
E v154
M v[52:55],a[248:251],v[168:171],v[52:55]
E v155
M v[56:59],a[216:219],v[168:171],v[56:59]
T a[168:169],v221,49152
C v191,v154,v155
M v[56:59],a[220:223],v[176:179],v[56:59]
E v156
M v[24:27],a[220:223],v[172:175],v[24:27]
E v157
M v[24:27],a[216:219],v[164:167],v[24:27]
T a[170:171],v221,53248
C v194,v156,v157
M v[28:31],a[224:227],v[164:167],v[28:31]
s_waitcnt lgkmcnt(3)
E v158
M v[28:31],a[228:231],v[172:175],v[28:31]
E v159
M v[60:63],a[228:231],v[176:179],v[60:63]
s_waitcnt vmcnt(14)
s_barrier
T a[172:173],v221,57344
Dn v254,s[12:15],0
C v195,v158,v159
M v[60:63],a[224:227],v[168:171],v[60:63]
T a[174:175],v221,61440
M a[212:215],a[192:195],a[196:199],a[212:215]
T a[176:177],v222,49152
M a[212:215],a[192:195],a[200:203],a[212:215]
T a[178:179],v222,53248
M a[204:207],a[192:195],v[164:167],a[204:207]
T a[180:181],v222,57344
Dn v255,s[12:15],1024
M a[204:207],a[192:195],v[172:175],a[204:207]
T a[182:183],v222,61440
M a[208:211],a[192:195],v[168:171],a[208:211]
R a[184:187],v210,20480
M a[208:211],a[192:195],v[176:179],a[208:211]
R a[188:191],v211,20480
M v[160:163],a[232:235],a[32:35],v[204:207]
R a[248:251],v212,20480
M v[160:163],a[236:239],a[36:39],v[160:163]
R a[252:255],v213,20480
Dn v254,s[12:15],2048
M v[160:163],a[240:243],a[40:43],v[160:163]
T a[216:217],v223,49152
M v[160:163],a[244:247],a[44:47],v[160:163]
T a[218:219],v223,53248
M v[144:147],a[144:147],a[0:3],v[196:199]
T a[220:221],v223,57344
M v[144:147],a[148:151],a[4:7],v[144:147]
T a[222:223],v223,61440
M v[144:147],a[152:155],a[8:11],v[144:147]
T a[224:225],v224,49152
Dn v255,s[12:15],3072
M v[144:147],a[156:159],a[12:15],v[144:147]
s_add_u32 m0,s45,0
E v160
E v161
E v162
E v163
M v[148:151],a[156:159],a[28:31],v[200:203]
s_add_u32 s8,s70,0
T a[226:227],v224,53248
C v208,v160,v161
C v209,v162,v163
M v[148:151],a[152:155],a[24:27],v[148:151]
s_xor_b32 s3,s5,3
T a[228:229],v224,57344
Dn v245,s[8:11],0
E v144
E v145
E v146
M v[148:151],a[148:151],a[20:23],v[148:151]
s_lshl_b32 s3,s3,4
T a[230:231],v224,61440
E v147
C v164,v144,v145
M v[148:151],a[144:147],a[16:19],v[148:151]
s_sub_u32 s100,s3,147456
T a[232:233],v225,49152
C v165,v146,v147
M v[80:83],a[160:163],a[120:123],v[80:83]
s_waitcnt lgkmcnt(4)
T a[234:235],v225,53248
Dn v246,s[8:11],1024
v_add_lshl_u32 v238,s100,v244,4
M v[80:83],a[164:167],a[124:127],v[80:83]
E v148
E v149
E v150
E v151
M v[112:115],a[164:167],a[132:135],v[112:115]
T a[236:237],v225,57344
C v168,v148,v149
C v169,v150,v151
M v[112:115],a[160:163],a[128:131],v[112:115]
T a[238:239],v225,61440
Dn v245,s[8:11],2048
M v[116:119],a[168:171],a[128:131],v[116:119]
ds_write_b64 v242,v[208:209] offset:0
M v[116:119],a[172:175],a[132:135],v[116:119]
T a[240:241],v220,16384
M v[84:87],a[172:175],a[124:127],v[84:87]
T a[242:243],v220,20480
M v[84:87],a[168:171],a[120:123],v[84:87]
T a[244:245],v220,24576
Dn v246,s[8:11],3072
M v[88:91],a[176:179],a[120:123],v[88:91]
s_add_u32 m0,s45,131072
T a[246:247],v220,28672
M v[88:91],a[180:183],a[124:127],v[88:91]
s_add_u32 s16,s39,512
R a[144:147],v210,24576
M v[120:123],a[180:183],a[132:135],v[120:123]
R a[148:151],v211,24576
M v[120:123],a[176:179],a[128:131],v[120:123]
R a[196:199],v243,2048
M v[152:155],a[184:187],a[0:3],v[196:199]
buffer_store_byte v239,v238,s[84:87],s5 offen sc1
M v[152:155],a[188:191],a[4:7],v[152:155]
R a[200:203],v243,3072
M v[152:155],a[248:251],a[8:11],v[152:155]
R a[152:155],v212,24576
M v[152:155],a[252:255],a[12:15],v[152:155]
R a[156:159],v213,24576
M v[156:159],a[252:255],a[28:31],v[200:203]
T a[160:161],v221,16384
M v[156:159],a[248:251],a[24:27],v[156:159]
T a[162:163],v221,20480
M v[156:159],a[188:191],a[20:23],v[156:159]
T a[164:165],v221,24576
M v[156:159],a[184:187],a[16:19],v[156:159]
E v152
E v153
E v154
E v155
M v[92:95],a[216:219],a[120:123],v[92:95]
T a[166:167],v221,28672
C v166,v152,v153
C v167,v154,v155
M v[92:95],a[220:223],a[124:127],v[92:95]
E v156
E v157
E v158
E v159
M v[124:127],a[220:223],a[132:135],v[124:127]
T a[168:169],v218,16384
C v170,v156,v157
C v171,v158,v159
M v[124:127],a[216:219],a[128:131],v[124:127]
s_waitcnt lgkmcnt(2)
T a[170:171],v218,20480
M v[128:131],a[224:227],a[128:131],v[128:131]
T a[172:173],v218,24576
M v[128:131],a[228:231],a[132:135],v[128:131]
T a[174:175],v218,28672
M v[96:99],a[228:231],a[124:127],v[96:99]
T a[176:177],v219,16384
M v[96:99],a[224:227],a[120:123],v[96:99]
T a[178:179],v219,20480
M v[100:103],a[232:235],a[120:123],v[100:103]
s_waitcnt vmcnt(7)
s_barrier
T a[180:181],v219,24576
M v[100:103],a[236:239],a[124:127],v[100:103]
T a[182:183],v219,28672
M v[132:135],a[236:239],a[132:135],v[132:135]
T a[184:185],v222,16384
M v[132:135],a[232:235],a[128:131],v[132:135]
T a[186:187],v222,20480
M v[8:11],a[240:243],v[180:183],v[8:11]
T a[188:189],v222,24576
M v[8:11],a[244:247],v[188:191],v[8:11]
T a[190:191],v222,28672
M v[40:43],a[244:247],v[192:195],v[40:43]
R a[248:251],v210,28672
M v[40:43],a[240:243],v[184:187],v[40:43]
R a[252:255],v211,28672
M v[144:147],a[144:147],a[0:3],v[196:199]
R a[216:219],v212,28672
M v[144:147],a[148:151],a[4:7],v[144:147]
R a[220:223],v213,28672
M v[144:147],a[152:155],a[8:11],v[144:147]
T a[224:225],v223,16384
M v[144:147],a[156:159],a[12:15],v[144:147]
T a[226:227],v223,20480
M v[148:151],a[156:159],a[28:31],v[200:203]
T a[228:229],v223,24576
D v230,s[16:19],0
M v[148:151],a[152:155],a[24:27],v[148:151]
T a[230:231],v223,28672
M v[148:151],a[148:151],a[20:23],v[148:151]
T a[232:233],v224,16384
M v[148:151],a[144:147],a[16:19],v[148:151]
E v144
E v145
E v146
E v147
M v[12:15],a[160:163],v[180:183],v[12:15]
s_waitcnt lgkmcnt(5)
T a[234:235],v224,20480
D v231,s[16:19],1024
C v172,v144,v145
C v173,v146,v147
M v[12:15],a[164:167],v[188:191],v[12:15]
s_add_u32 s16,s39,129536
E v148
E v149
E v150
M v[44:47],a[164:167],v[192:195],v[44:47]
T a[236:237],v224,24576
C v176,v148,v149
M v[44:47],a[160:163],v[184:187],v[44:47]
T a[238:239],v224,28672
D v230,s[16:19],2048
M v[32:35],a[168:171],v[184:187],v[32:35]
E v151
M v[32:35],a[172:175],v[192:195],v[32:35]
T a[240:241],v225,16384
C v177,v150,v151
M v[0:3],a[172:175],v[188:191],v[0:3]
T a[242:243],v225,20480
M v[0:3],a[168:171],v[180:183],v[0:3]
T a[244:245],v225,24576
M v[64:67],a[168:171],a[196:199],v[64:67]
T a[246:247],v225,28672
D v231,s[16:19],3072
M v[64:67],a[172:175],a[200:203],v[64:67]
s_add_u32 m0,s45,98304
R a[144:147],v214,32768
M v[4:7],a[176:179],v[180:183],v[4:7]
s_add_u32 s3,s69,0
R a[148:151],v215,32768
M v[4:7],a[180:183],v[188:191],v[4:7]
s_add_u32 s12,s3,s51
R a[152:155],v216,32768
M v[36:39],a[180:183],v[192:195],v[36:39]
R a[156:159],v217,32768
M v[36:39],a[176:179],v[184:187],v[36:39]
R a[160:163],v210,32768
M v[68:71],a[176:179],a[196:199],v[68:71]
R a[164:167],v211,32768
M v[68:71],a[180:183],a[200:203],v[68:71]
R a[168:171],v212,32768
M v[16:19],a[184:187],v[180:183],v[16:19]
R a[172:175],v213,32768
M v[16:19],a[188:191],v[188:191],v[16:19]
R a[96:99],v226,16384
M v[48:51],a[188:191],v[192:195],v[48:51]
T a[176:177],v218,32768
M v[48:51],a[184:187],v[184:187],v[48:51]
T a[178:179],v218,36864
M v[152:155],a[248:251],a[0:3],v[196:199]
R a[100:103],v227,16384
M v[152:155],a[252:255],a[4:7],v[152:155]
T a[180:181],v218,40960
M v[152:155],a[216:219],a[8:11],v[152:155]
T a[182:183],v218,45056
M v[152:155],a[220:223],a[12:15],v[152:155]
R a[108:111],v227,18432
M v[156:159],a[220:223],a[28:31],v[200:203]
R a[104:107],v226,18432
M v[156:159],a[216:219],a[24:27],v[156:159]
R a[112:115],v228,4096
M v[156:159],a[252:255],a[20:23],v[156:159]
R a[116:119],v229,4096
M v[156:159],a[248:251],a[16:19],v[156:159]
s_waitcnt lgkmcnt(8)
E v152
M v[20:23],a[224:227],v[180:183],v[20:23]
E v153
M v[20:23],a[228:231],v[188:191],v[20:23]
T a[184:185],v219,32768
C v174,v152,v153
M v[52:55],a[228:231],v[192:195],v[52:55]
E v154
M v[52:55],a[224:227],v[184:187],v[52:55]
E v155
M v[56:59],a[232:235],v[184:187],v[56:59]
T a[186:187],v219,36864
C v175,v154,v155
M v[56:59],a[236:239],v[192:195],v[56:59]
E v156
M v[24:27],a[236:239],v[188:191],v[24:27]
E v157
M v[24:27],a[232:235],v[180:183],v[24:27]
T a[188:189],v219,40960
C v178,v156,v157
M v[28:31],a[240:243],v[180:183],v[28:31]
E v158
M v[28:31],a[244:247],v[188:191],v[28:31]
E v159
M v[60:63],a[244:247],v[192:195],v[60:63]
s_waitcnt vmcnt(9)
s_barrier
T a[190:191],v219,45056
Dn v254,s[12:15],0
C v179,v158,v159
M v[60:63],a[240:243],v[184:187],v[60:63]
T a[248:249],v220,32768
M a[212:215],a[192:195],a[196:199],a[212:215]
T a[250:251],v220,36864
M a[212:215],a[192:195],a[200:203],a[212:215]
L_pg5:
s_cmp_eq_u32 s47,1
s_cbranch_scc1 L_bkT0_1
T a[252:253],v220,40960
M a[204:207],a[192:195],v[180:183],a[204:207]
T a[254:255],v220,45056
Dn v255,s[12:15],1024
M a[204:207],a[192:195],v[188:191],a[204:207]
T a[216:217],v221,32768
M a[208:211],a[192:195],v[184:187],a[208:211]
T a[218:219],v221,36864
M a[208:211],a[192:195],v[192:195],a[208:211]
T a[220:221],v221,40960
M v[160:163],a[144:147],a[32:35],v[204:207]
T a[222:223],v221,45056
M v[160:163],a[148:151],a[36:39],v[160:163]
R a[224:227],v210,36864
Dn v254,s[12:15],2048
M v[160:163],a[152:155],a[40:43],v[160:163]
R a[228:231],v211,36864
M v[160:163],a[156:159],a[44:47],v[160:163]
R a[232:235],v212,36864
M v[144:147],a[160:163],a[0:3],v[196:199]
R a[236:239],v213,36864
M v[144:147],a[164:167],a[4:7],v[144:147]
T a[240:241],v222,32768
M v[144:147],a[168:171],a[8:11],v[144:147]
T a[242:243],v222,36864
Dn v255,s[12:15],3072
M v[144:147],a[172:175],a[12:15],v[144:147]
s_add_u32 m0,s45,16384
E v160
E v161
E v162
E v163
M v[148:151],a[172:175],a[28:31],v[200:203]
s_add_u32 s8,s71,0
T a[244:245],v222,40960
C v208,v160,v161
C v209,v162,v163
M v[148:151],a[168:171],a[24:27],v[148:151]
T a[246:247],v222,45056
Dn v245,s[8:11],0
E v144
E v145
E v146
M v[148:151],a[164:167],a[20:23],v[148:151]
T a[144:145],v223,32768
E v147
C v180,v144,v145
M v[148:151],a[160:163],a[16:19],v[148:151]
s_waitcnt lgkmcnt(3)
T a[146:147],v223,36864
C v181,v146,v147
M v[72:75],a[176:179],a[96:99],v[72:75]
T a[148:149],v223,40960
Dn v246,s[8:11],1024
M v[72:75],a[180:183],a[100:103],v[72:75]
ds_write_b64 v242,v[208:209] offset:2048
M v[104:107],a[180:183],a[108:111],v[104:107]
E v148
E v149
E v150
E v151
M v[104:107],a[176:179],a[104:107],v[104:107]
T a[150:151],v223,45056
Dn v245,s[8:11],2048
C v184,v148,v149
C v185,v150,v151
M v[136:139],a[176:179],a[112:115],v[136:139]
T a[152:153],v224,32768
M v[136:139],a[180:183],a[116:119],v[136:139]
T a[154:155],v224,36864
M v[76:79],a[184:187],a[96:99],v[76:79]
T a[156:157],v224,40960
M v[76:79],a[188:191],a[100:103],v[76:79]
T a[158:159],v224,45056
Dn v246,s[8:11],3072
M v[108:111],a[188:191],a[108:111],v[108:111]
s_add_u32 m0,s45,49152
T a[160:161],v225,32768
M v[108:111],a[184:187],a[104:107],v[108:111]
s_add_u32 s20,s96,0
T a[162:163],v225,36864
M v[140:143],a[184:187],a[112:115],v[140:143]
T a[164:165],v225,40960
M v[140:143],a[188:191],a[116:119],v[140:143]
T a[166:167],v225,45056
M v[80:83],a[248:251],a[96:99],v[80:83]
T a[168:169],v220,0
D v247,s[20:23],0
M v[80:83],a[252:255],a[100:103],v[80:83]
s_add_u32 s20,s96,7168
T a[170:171],v220,4096
M v[112:115],a[252:255],a[108:111],v[112:115]
T a[172:173],v220,8192
M v[112:115],a[248:251],a[104:107],v[112:115]
T a[174:175],v220,12288
M v[116:119],a[216:219],a[104:107],v[116:119]
R a[176:179],v210,40960
M v[116:119],a[220:223],a[108:111],v[116:119]
R a[180:183],v211,40960
D v247,s[20:23],1024
M v[84:87],a[220:223],a[100:103],v[84:87]
s_add_u32 s20,s96,14336
R a[184:187],v212,40960
M v[84:87],a[216:219],a[96:99],v[84:87]
R a[188:191],v213,40960
M v[152:155],a[224:227],a[0:3],v[196:199]
T a[248:249],v221,0
M v[152:155],a[228:231],a[4:7],v[152:155]
T a[250:251],v221,4096
M v[152:155],a[232:235],a[8:11],v[152:155]
T a[252:253],v221,8192
D v247,s[20:23],2048
M v[152:155],a[236:239],a[12:15],v[152:155]
s_add_u32 s20,s96,21504
T a[254:255],v221,12288
M v[156:159],a[236:239],a[28:31],v[200:203]
s_xor_b32 s3,s5,4
T a[216:217],v218,0
M v[156:159],a[232:235],a[24:27],v[156:159]
s_lshl_b32 s3,s3,4
T a[218:219],v218,4096
M v[156:159],a[228:231],a[20:23],v[156:159]
s_sub_u32 s100,s3,147456
E v152
E v153
E v154
E v155
M v[156:159],a[224:227],a[16:19],v[156:159]
D v247,s[20:23],3072
v_add_lshl_u32 v238,s100,v244,4
C v182,v152,v153
C v183,v154,v155
M v[88:91],a[240:243],a[96:99],v[88:91]
s_waitcnt lgkmcnt(4)
s_add_u32 m0,s45,114688
T a[220:221],v218,8192
M v[88:91],a[244:247],a[100:103],v[88:91]
s_add_u32 s16,s40,512
E v156
E v157
E v158
E v159
M v[120:123],a[244:247],a[108:111],v[120:123]
buffer_store_byte v239,v238,s[84:87],s5 offen sc1
C v186,v156,v157
C v187,v158,v159
M v[120:123],a[240:243],a[104:107],v[120:123]
T a[222:223],v218,12288
M v[124:127],a[144:147],a[104:107],v[124:127]
R a[196:199],v243,0
M v[124:127],a[148:151],a[108:111],v[124:127]
R a[200:203],v243,1024
M v[92:95],a[148:151],a[100:103],v[92:95]
T a[224:225],v219,0
M v[92:95],a[144:147],a[96:99],v[92:95]
T a[226:227],v219,4096
M v[96:99],a[152:155],a[96:99],v[96:99]
s_waitcnt vmcnt(10)
s_barrier
T a[228:229],v219,8192
M v[96:99],a[156:159],a[100:103],v[96:99]
T a[230:231],v219,12288
M v[128:131],a[156:159],a[108:111],v[128:131]
T a[232:233],v222,0
M v[128:131],a[152:155],a[104:107],v[128:131]
T a[234:235],v222,4096
M v[132:135],a[160:163],a[104:107],v[132:135]
T a[236:237],v222,8192
M v[132:135],a[164:167],a[108:111],v[132:135]
T a[238:239],v222,12288
M v[100:103],a[164:167],a[100:103],v[100:103]
R a[240:243],v210,45056
M v[100:103],a[160:163],a[96:99],v[100:103]
R a[244:247],v211,45056
M v[8:11],a[168:171],v[164:167],v[8:11]
R a[144:147],v212,45056
M v[8:11],a[172:175],v[172:175],v[8:11]
R a[148:151],v213,45056
M v[40:43],a[172:175],v[176:179],v[40:43]
T a[152:153],v223,0
M v[40:43],a[168:171],v[168:171],v[40:43]
T a[154:155],v223,4096
M v[144:147],a[176:179],a[0:3],v[196:199]
T a[156:157],v223,8192
D v230,s[16:19],0
M v[144:147],a[180:183],a[4:7],v[144:147]
T a[158:159],v223,12288
M v[144:147],a[184:187],a[8:11],v[144:147]
T a[160:161],v224,0
M v[144:147],a[188:191],a[12:15],v[144:147]
T a[162:163],v224,4096
M v[148:151],a[188:191],a[28:31],v[200:203]
T a[164:165],v224,8192
M v[148:151],a[184:187],a[24:27],v[148:151]
T a[166:167],v224,12288
D v231,s[16:19],1024
M v[148:151],a[180:183],a[20:23],v[148:151]
s_add_u32 s16,s40,129536
T a[168:169],v225,0
M v[148:151],a[176:179],a[16:19],v[148:151]
E v144
M v[12:15],a[248:251],v[164:167],v[12:15]
s_waitcnt lgkmcnt(7)
E v145
M v[12:15],a[252:255],v[172:175],v[12:15]
T a[170:171],v225,4096
C v188,v144,v145
M v[44:47],a[252:255],v[176:179],v[44:47]
T a[172:173],v225,8192
D v230,s[16:19],2048
M v[44:47],a[248:251],v[168:171],v[44:47]
E v146
M v[32:35],a[216:219],v[168:171],v[32:35]
E v147
M v[32:35],a[220:223],v[176:179],v[32:35]
T a[174:175],v225,12288
C v189,v146,v147
M v[0:3],a[220:223],v[172:175],v[0:3]
E v148
M v[0:3],a[216:219],v[164:167],v[0:3]
R a[176:179],v214,0
D v231,s[16:19],3072
M v[64:67],a[216:219],a[196:199],v[64:67]
s_add_u32 m0,s45,81920
E v149
M v[64:67],a[220:223],a[200:203],v[64:67]
s_add_u32 s3,s70,0
R a[180:183],v215,0
C v192,v148,v149
M v[4:7],a[224:227],v[164:167],v[4:7]
s_add_u32 s12,s3,s51
E v150
M v[4:7],a[228:231],v[172:175],v[4:7]
E v151
M v[36:39],a[228:231],v[176:179],v[36:39]
R a[184:187],v216,0
C v193,v150,v151
M v[36:39],a[224:227],v[168:171],v[36:39]
R a[188:191],v217,0
M v[68:71],a[224:227],a[196:199],v[68:71]
R a[248:251],v210,0
M v[68:71],a[228:231],a[200:203],v[68:71]
R a[252:255],v211,0
M v[16:19],a[232:235],v[164:167],v[16:19]
R a[216:219],v212,0
M v[16:19],a[236:239],v[172:175],v[16:19]
R a[220:223],v213,0
M v[48:51],a[236:239],v[176:179],v[48:51]
R a[120:123],v226,32768
M v[48:51],a[232:235],v[168:171],v[48:51]
T a[224:225],v218,49152
M v[152:155],a[240:243],a[0:3],v[196:199]
T a[226:227],v218,53248
M v[152:155],a[244:247],a[4:7],v[152:155]
R a[124:127],v227,32768
M v[152:155],a[144:147],a[8:11],v[152:155]
T a[228:229],v218,57344
M v[152:155],a[148:151],a[12:15],v[152:155]
T a[230:231],v218,61440
M v[156:159],a[148:151],a[28:31],v[200:203]
R a[132:135],v227,34816
M v[156:159],a[144:147],a[24:27],v[156:159]
R a[128:131],v226,34816
M v[156:159],a[244:247],a[20:23],v[156:159]
R a[136:139],v228,6144
M v[156:159],a[240:243],a[16:19],v[156:159]
E v152
M v[20:23],a[152:155],v[164:167],v[20:23]
s_waitcnt lgkmcnt(7)
E v153
M v[20:23],a[156:159],v[172:175],v[20:23]
R a[140:143],v229,6144
C v190,v152,v153
M v[52:55],a[156:159],v[176:179],v[52:55]
E v154
M v[52:55],a[152:155],v[168:171],v[52:55]
E v155
M v[56:59],a[160:163],v[168:171],v[56:59]
T a[232:233],v219,49152
C v191,v154,v155
M v[56:59],a[164:167],v[176:179],v[56:59]
E v156
M v[24:27],a[164:167],v[172:175],v[24:27]
E v157
M v[24:27],a[160:163],v[164:167],v[24:27]
T a[234:235],v219,53248
C v194,v156,v157
M v[28:31],a[168:171],v[164:167],v[28:31]
E v158
M v[28:31],a[172:175],v[172:175],v[28:31]
E v159
M v[60:63],a[172:175],v[176:179],v[60:63]
s_waitcnt vmcnt(13)
s_barrier
T a[236:237],v219,57344
Dn v254,s[12:15],0
C v195,v158,v159
M v[60:63],a[168:171],v[168:171],v[60:63]
T a[238:239],v219,61440
M a[212:215],a[192:195],a[196:199],a[212:215]
R a[240:243],v210,4096
M a[212:215],a[192:195],a[200:203],a[212:215]
R a[244:247],v211,4096
M a[204:207],a[192:195],v[164:167],a[204:207]
R a[144:147],v212,4096
Dn v255,s[12:15],1024
M a[204:207],a[192:195],v[172:175],a[204:207]
R a[148:151],v213,4096
M a[208:211],a[192:195],v[168:171],a[208:211]
T a[152:153],v220,49152
M a[208:211],a[192:195],v[176:179],a[208:211]
T a[154:155],v220,53248
M v[160:163],a[176:179],a[32:35],v[204:207]
T a[156:157],v220,57344
M v[160:163],a[180:183],a[36:39],v[160:163]
T a[158:159],v220,61440
Dn v254,s[12:15],2048
M v[160:163],a[184:187],a[40:43],v[160:163]
T a[160:161],v221,49152
M v[160:163],a[188:191],a[44:47],v[160:163]
T a[162:163],v221,53248
M v[144:147],a[248:251],a[0:3],v[196:199]
T a[164:165],v221,57344
M v[144:147],a[252:255],a[4:7],v[144:147]
T a[166:167],v221,61440
M v[144:147],a[216:219],a[8:11],v[144:147]
T a[168:169],v222,49152
Dn v255,s[12:15],3072
M v[144:147],a[220:223],a[12:15],v[144:147]
s_add_u32 m0,s45,32768
E v160
E v161
E v162
E v163
M v[148:151],a[220:223],a[28:31],v[200:203]
s_add_u32 s8,s64,131072
T a[170:171],v222,53248
C v208,v160,v161
C v209,v162,v163
M v[148:151],a[216:219],a[24:27],v[148:151]
T a[172:173],v222,57344
Dn v245,s[8:11],0
E v144
E v145
E v146
M v[148:151],a[252:255],a[20:23],v[148:151]
T a[174:175],v222,61440
E v147
C v164,v144,v145
M v[148:151],a[248:251],a[16:19],v[148:151]
s_waitcnt lgkmcnt(3)
T a[176:177],v220,16384
C v165,v146,v147
M v[72:75],a[224:227],a[120:123],v[72:75]
T a[178:179],v220,20480
Dn v246,s[8:11],1024
M v[72:75],a[228:231],a[124:127],v[72:75]
ds_write_b64 v242,v[208:209] offset:0
M v[104:107],a[228:231],a[132:135],v[104:107]
E v148
E v149
E v150
E v151
M v[104:107],a[224:227],a[128:131],v[104:107]
T a[180:181],v220,24576
Dn v245,s[8:11],2048
C v168,v148,v149
C v169,v150,v151
M v[136:139],a[224:227],a[136:139],v[136:139]
T a[182:183],v220,28672
M v[136:139],a[228:231],a[140:143],v[136:139]
R a[184:187],v210,8192
M v[76:79],a[232:235],a[120:123],v[76:79]
R a[188:191],v211,8192
M v[76:79],a[236:239],a[124:127],v[76:79]
R a[196:199],v243,2048
Dn v246,s[8:11],3072
M v[108:111],a[236:239],a[132:135],v[108:111]
s_add_u32 m0,s45,65536
R a[200:203],v243,3072
M v[108:111],a[232:235],a[128:131],v[108:111]
s_add_u32 s20,s97,0
R a[248:251],v212,8192
M v[140:143],a[232:235],a[136:139],v[140:143]
R a[252:255],v213,8192
M v[140:143],a[236:239],a[140:143],v[140:143]
T a[216:217],v221,16384
M v[152:155],a[240:243],a[0:3],v[196:199]
T a[218:219],v221,20480
D v247,s[20:23],0
M v[152:155],a[244:247],a[4:7],v[152:155]
s_add_u32 s20,s97,7168
T a[220:221],v221,24576
M v[152:155],a[144:147],a[8:11],v[152:155]
T a[222:223],v221,28672
M v[152:155],a[148:151],a[12:15],v[152:155]
T a[224:225],v218,16384
M v[156:159],a[148:151],a[28:31],v[200:203]
T a[226:227],v218,20480
M v[156:159],a[144:147],a[24:27],v[156:159]
T a[228:229],v218,24576
D v247,s[20:23],1024
M v[156:159],a[244:247],a[20:23],v[156:159]
s_add_u32 s20,s97,14336
T a[230:231],v218,28672
M v[156:159],a[240:243],a[16:19],v[156:159]
E v152
E v153
E v154
E v155
M v[80:83],a[152:155],a[120:123],v[80:83]
T a[232:233],v219,16384
D v247,s[20:23],2048
C v166,v152,v153
C v167,v154,v155
M v[80:83],a[156:159],a[124:127],v[80:83]
s_add_u32 s20,s97,21504
E v156
E v157
E v158
E v159
M v[112:115],a[156:159],a[132:135],v[112:115]
s_xor_b32 s3,s5,5
T a[234:235],v219,20480
C v170,v156,v157
C v171,v158,v159
M v[112:115],a[152:155],a[128:131],v[112:115]
s_lshl_b32 s3,s3,4
T a[236:237],v219,24576
D v247,s[20:23],3072
M v[116:119],a[160:163],a[128:131],v[116:119]
s_sub_u32 s100,s3,147456
T a[238:239],v219,28672
M v[116:119],a[164:167],a[132:135],v[116:119]
s_add_u32 m0,s46,155648
T a[240:241],v222,16384
v_add_lshl_u32 v238,s100,v244,4
M v[84:87],a[164:167],a[124:127],v[84:87]
s_and_b32 s20,s98,0xffffff7f
T a[242:243],v222,20480
M v[84:87],a[160:163],a[120:123],v[84:87]
s_waitcnt lgkmcnt(5)
T a[244:245],v222,24576
M v[88:91],a[168:171],a[120:123],v[88:91]
s_waitcnt vmcnt(9)
s_barrier
buffer_store_byte v239,v238,s[84:87],s5 offen sc1
M v[88:91],a[172:175],a[124:127],v[88:91]
T a[246:247],v222,28672
M v[120:123],a[172:175],a[132:135],v[120:123]
R a[144:147],v210,12288
M v[120:123],a[168:171],a[128:131],v[120:123]
R a[148:151],v211,12288
M v[8:11],a[176:179],v[180:183],v[8:11]
R a[152:155],v212,12288
M v[8:11],a[180:183],v[188:191],v[8:11]
R a[156:159],v213,12288
M v[40:43],a[180:183],v[192:195],v[40:43]
T a[160:161],v223,16384
M v[40:43],a[176:179],v[184:187],v[40:43]
T a[162:163],v223,20480
M v[144:147],a[184:187],a[0:3],v[196:199]
T a[164:165],v223,24576
M v[144:147],a[188:191],a[4:7],v[144:147]
T a[166:167],v223,28672
M v[144:147],a[248:251],a[8:11],v[144:147]
T a[168:169],v224,16384
M v[144:147],a[252:255],a[12:15],v[144:147]
T a[170:171],v224,20480
D v240,s[20:23],0
M v[148:151],a[252:255],a[28:31],v[200:203]
s_add_u32 m0,s45,98304
T a[172:173],v224,24576
M v[148:151],a[248:251],a[24:27],v[148:151]
s_add_u32 s3,s71,0
T a[174:175],v224,28672
M v[148:151],a[188:191],a[20:23],v[148:151]
s_add_u32 s12,s3,s51
E v144
E v145
E v146
E v147
M v[148:151],a[184:187],a[16:19],v[148:151]
T a[176:177],v225,16384
C v172,v144,v145
C v173,v146,v147
M v[12:15],a[216:219],v[180:183],v[12:15]
T a[178:179],v225,20480
M v[12:15],a[220:223],v[188:191],v[12:15]
T a[180:181],v225,24576
M v[44:47],a[220:223],v[192:195],v[44:47]
E v148
E v149
M v[44:47],a[216:219],v[184:187],v[44:47]
T a[182:183],v225,28672
C v176,v148,v149
M v[32:35],a[224:227],v[184:187],v[32:35]
E v150
M v[32:35],a[228:231],v[192:195],v[32:35]
E v151
M v[0:3],a[228:231],v[188:191],v[0:3]
R a[184:187],v214,16384
C v177,v150,v151
M v[0:3],a[224:227],v[180:183],v[0:3]
R a[188:191],v215,16384
M v[64:67],a[224:227],a[196:199],v[64:67]
R a[248:251],v216,16384
M v[64:67],a[228:231],a[200:203],v[64:67]
s_waitcnt lgkmcnt(4)
R a[252:255],v217,16384
M v[4:7],a[232:235],v[180:183],v[4:7]
R a[216:219],v210,16384
M v[4:7],a[236:239],v[188:191],v[4:7]
R a[220:223],v211,16384
M v[36:39],a[236:239],v[192:195],v[36:39]
R a[224:227],v212,16384
M v[36:39],a[232:235],v[184:187],v[36:39]
R a[228:231],v213,16384
M v[68:71],a[232:235],a[196:199],v[68:71]
T a[232:233],v223,49152
M v[68:71],a[236:239],a[200:203],v[68:71]
T a[234:235],v223,53248
M v[16:19],a[240:243],v[180:183],v[16:19]
T a[236:237],v223,57344
M v[16:19],a[244:247],v[188:191],v[16:19]
T a[238:239],v223,61440
M v[48:51],a[244:247],v[192:195],v[48:51]
T a[244:245],v224,57344
M v[48:51],a[240:243],v[184:187],v[48:51]
T a[240:241],v224,49152
M v[152:155],a[144:147],a[0:3],v[196:199]
T a[242:243],v224,53248
M v[152:155],a[148:151],a[4:7],v[152:155]
T a[246:247],v224,61440
M v[152:155],a[152:155],a[8:11],v[152:155]
R a[96:99],v226,16384
M v[152:155],a[156:159],a[12:15],v[152:155]
R a[100:103],v227,16384
M v[156:159],a[156:159],a[28:31],v[200:203]
R a[156:159],v211,20480
M v[156:159],a[152:155],a[24:27],v[156:159]
R a[152:155],v210,20480
M v[156:159],a[148:151],a[20:23],v[156:159]
T a[148:149],v225,57344
M v[156:159],a[144:147],a[16:19],v[156:159]
E v152
M v[20:23],a[160:163],v[180:183],v[20:23]
E v153
M v[20:23],a[164:167],v[188:191],v[20:23]
T a[144:145],v225,49152
C v174,v152,v153
M v[52:55],a[164:167],v[192:195],v[52:55]
E v154
M v[52:55],a[160:163],v[184:187],v[52:55]
E v155
M v[56:59],a[168:171],v[184:187],v[56:59]
T a[146:147],v225,53248
C v175,v154,v155
M v[56:59],a[172:175],v[192:195],v[56:59]
L_pg6:
s_cmp_eq_u32 s47,1
s_cbranch_scc1 L_bkT0_1
E v156
M v[24:27],a[172:175],v[188:191],v[24:27]
E v157
M v[24:27],a[168:171],v[180:183],v[24:27]
T a[150:151],v225,61440
C v178,v156,v157
M v[28:31],a[176:179],v[180:183],v[28:31]
s_waitcnt lgkmcnt(3)
E v158
M v[28:31],a[180:183],v[188:191],v[28:31]
E v159
M v[60:63],a[180:183],v[192:195],v[60:63]
s_waitcnt vmcnt(10)
s_barrier
R a[160:163],v212,20480
Dn v254,s[12:15],0
C v179,v158,v159
M v[60:63],a[176:179],v[184:187],v[60:63]
R a[164:167],v213,20480
M a[212:215],a[192:195],a[196:199],a[212:215]
T a[168:169],v218,32768
M a[212:215],a[192:195],a[200:203],a[212:215]
T a[170:171],v218,36864
M a[204:207],a[192:195],v[180:183],a[204:207]
T a[172:173],v218,40960
Dn v255,s[12:15],1024
M a[204:207],a[192:195],v[188:191],a[204:207]
T a[174:175],v218,45056
M a[208:211],a[192:195],v[184:187],a[208:211]
R a[108:111],v227,18432
M a[208:211],a[192:195],v[192:195],a[208:211]
R a[104:107],v226,18432
M v[160:163],a[184:187],a[32:35],v[204:207]
R a[112:115],v228,0
M v[160:163],a[188:191],a[36:39],v[160:163]
R a[116:119],v229,0
Dn v254,s[12:15],2048
M v[160:163],a[248:251],a[40:43],v[160:163]
T a[176:177],v219,32768
M v[160:163],a[252:255],a[44:47],v[160:163]
T a[178:179],v219,36864
M v[144:147],a[216:219],a[0:3],v[196:199]
T a[180:181],v219,40960
M v[144:147],a[220:223],a[4:7],v[144:147]
T a[182:183],v219,45056
M v[144:147],a[224:227],a[8:11],v[144:147]
T a[184:185],v220,0
Dn v255,s[12:15],3072
M v[144:147],a[228:231],a[12:15],v[144:147]
s_add_u32 m0,s45,0
E v160
E v161
E v162
E v163
M v[148:151],a[228:231],a[28:31],v[200:203]
s_add_u32 s8,s65,131072
T a[186:187],v220,4096
C v208,v160,v161
C v209,v162,v163
M v[148:151],a[224:227],a[24:27],v[148:151]
T a[188:189],v220,8192
Dn v245,s[8:11],0
E v144
E v145
E v146
M v[148:151],a[220:223],a[20:23],v[148:151]
T a[190:191],v220,12288
E v147
C v180,v144,v145
M v[148:151],a[216:219],a[16:19],v[148:151]
R a[248:251],v210,24576
C v181,v146,v147
M v[92:95],a[232:235],a[120:123],v[92:95]
R a[252:255],v211,24576
Dn v246,s[8:11],1024
M v[92:95],a[236:239],a[124:127],v[92:95]
ds_write_b64 v242,v[208:209] offset:2048
M v[124:127],a[236:239],a[132:135],v[124:127]
E v148
E v149
E v150
E v151
M v[124:127],a[232:235],a[128:131],v[124:127]
R a[196:199],v243,0
Dn v245,s[8:11],2048
C v184,v148,v149
C v185,v150,v151
M v[128:131],a[240:243],a[128:131],v[128:131]
R a[200:203],v243,1024
M v[128:131],a[244:247],a[132:135],v[128:131]
R a[216:219],v212,24576
M v[96:99],a[244:247],a[124:127],v[96:99]
R a[220:223],v213,24576
M v[96:99],a[240:243],a[120:123],v[96:99]
s_waitcnt lgkmcnt(4)
T a[224:225],v221,0
Dn v246,s[8:11],3072
M v[100:103],a[144:147],a[120:123],v[100:103]
s_add_u32 m0,s45,49152
T a[226:227],v221,4096
M v[100:103],a[148:151],a[124:127],v[100:103]
s_add_u32 s20,s98,0
T a[228:229],v221,8192
M v[132:135],a[148:151],a[132:135],v[132:135]
T a[230:231],v221,12288
M v[132:135],a[144:147],a[128:131],v[132:135]
T a[232:233],v218,0
M v[152:155],a[152:155],a[0:3],v[196:199]
T a[234:235],v218,4096
D v247,s[20:23],0
M v[152:155],a[156:159],a[4:7],v[152:155]
s_add_u32 s20,s98,7168
T a[236:237],v218,8192
M v[152:155],a[160:163],a[8:11],v[152:155]
T a[238:239],v218,12288
M v[152:155],a[164:167],a[12:15],v[152:155]
T a[240:241],v219,0
M v[156:159],a[164:167],a[28:31],v[200:203]
T a[242:243],v219,4096
M v[156:159],a[160:163],a[24:27],v[156:159]
T a[244:245],v219,8192
D v247,s[20:23],1024
M v[156:159],a[156:159],a[20:23],v[156:159]
s_add_u32 s20,s98,14336
T a[246:247],v219,12288
M v[156:159],a[152:155],a[16:19],v[156:159]
E v152
E v153
E v154
E v155
M v[72:75],a[168:171],a[96:99],v[72:75]
T a[144:145],v222,0
D v247,s[20:23],2048
C v182,v152,v153
C v183,v154,v155
M v[72:75],a[172:175],a[100:103],v[72:75]
s_add_u32 s20,s98,21504
E v156
E v157
E v158
E v159
M v[104:107],a[172:175],a[108:111],v[104:107]
s_xor_b32 s3,s5,6
T a[146:147],v222,4096
C v186,v156,v157
C v187,v158,v159
M v[104:107],a[168:171],a[104:107],v[104:107]
s_lshl_b32 s3,s3,4
T a[148:149],v222,8192
D v247,s[20:23],3072
M v[136:139],a[168:171],a[112:115],v[136:139]
s_sub_u32 s100,s3,147456
T a[150:151],v222,12288
M v[136:139],a[172:175],a[116:119],v[136:139]
s_add_u32 m0,s45,131072
R a[152:155],v210,28672
v_add_lshl_u32 v238,s100,v244,4
M v[76:79],a[176:179],a[96:99],v[76:79]
s_add_u32 s16,s41,512
R a[156:159],v211,28672
M v[76:79],a[180:183],a[100:103],v[76:79]
R a[160:163],v212,28672
M v[108:111],a[180:183],a[108:111],v[108:111]
s_waitcnt vmcnt(10) lgkmcnt(6)
s_barrier
buffer_store_byte v239,v238,s[84:87],s5 offen sc1
M v[108:111],a[176:179],a[104:107],v[108:111]
R a[164:167],v213,28672
M v[140:143],a[176:179],a[112:115],v[140:143]
T a[168:169],v223,0
M v[140:143],a[180:183],a[116:119],v[140:143]
T a[170:171],v223,4096
M v[8:11],a[184:187],v[164:167],v[8:11]
T a[172:173],v223,8192
M v[8:11],a[188:191],v[172:175],v[8:11]
T a[174:175],v223,12288
M v[40:43],a[188:191],v[176:179],v[40:43]
T a[176:177],v224,0
M v[40:43],a[184:187],v[168:171],v[40:43]
T a[178:179],v224,4096
M v[144:147],a[248:251],a[0:3],v[196:199]
T a[180:181],v224,8192
M v[144:147],a[252:255],a[4:7],v[144:147]
T a[182:183],v224,12288
M v[144:147],a[216:219],a[8:11],v[144:147]
T a[184:185],v225,0
M v[144:147],a[220:223],a[12:15],v[144:147]
T a[186:187],v225,4096
D v230,s[16:19],0
M v[148:151],a[220:223],a[28:31],v[200:203]
T a[188:189],v225,8192
M v[148:151],a[216:219],a[24:27],v[148:151]
T a[190:191],v225,12288
M v[148:151],a[252:255],a[20:23],v[148:151]
R a[252:255],v211,32768
M v[148:151],a[248:251],a[16:19],v[148:151]
E v144
E v145
E v146
E v147
M v[12:15],a[224:227],v[164:167],v[12:15]
R a[248:251],v210,32768
D v231,s[16:19],1024
C v188,v144,v145
C v189,v146,v147
M v[12:15],a[228:231],v[172:175],v[12:15]
s_add_u32 s16,s41,129536
E v148
E v149
M v[44:47],a[228:231],v[176:179],v[44:47]
R a[216:219],v212,32768
C v192,v148,v149
M v[44:47],a[224:227],v[168:171],v[44:47]
E v150
M v[32:35],a[232:235],v[168:171],v[32:35]
R a[220:223],v213,32768
D v230,s[16:19],2048
M v[32:35],a[236:239],v[176:179],v[32:35]
E v151
M v[0:3],a[236:239],v[172:175],v[0:3]
T a[224:225],v220,32768
C v193,v150,v151
M v[0:3],a[232:235],v[164:167],v[0:3]
T a[226:227],v220,36864
M v[64:67],a[232:235],a[196:199],v[64:67]
T a[228:229],v220,40960
M v[64:67],a[236:239],a[200:203],v[64:67]
T a[230:231],v220,45056
D v231,s[16:19],3072
M v[4:7],a[240:243],v[164:167],v[4:7]
s_add_u32 m0,s45,81920
T a[232:233],v221,32768
M v[4:7],a[244:247],v[172:175],v[4:7]
s_add_u32 s3,s64,131072
T a[234:235],v221,36864
M v[36:39],a[244:247],v[176:179],v[36:39]
s_add_u32 s12,s3,s51
T a[236:237],v221,40960
M v[36:39],a[240:243],v[168:171],v[36:39]
T a[238:239],v221,45056
M v[68:71],a[240:243],a[196:199],v[68:71]
T a[240:241],v222,32768
M v[68:71],a[244:247],a[200:203],v[68:71]
s_waitcnt lgkmcnt(8)
T a[242:243],v222,36864
M v[16:19],a[144:147],v[164:167],v[16:19]
T a[244:245],v222,40960
M v[16:19],a[148:151],v[172:175],v[16:19]
T a[246:247],v222,45056
M v[48:51],a[148:151],v[176:179],v[48:51]
T a[148:149],v223,40960
M v[48:51],a[144:147],v[168:171],v[48:51]
T a[144:145],v223,32768
M v[152:155],a[152:155],a[0:3],v[196:199]
T a[146:147],v223,36864
M v[152:155],a[156:159],a[4:7],v[152:155]
T a[150:151],v223,45056
M v[152:155],a[160:163],a[8:11],v[152:155]
M v[152:155],a[164:167],a[12:15],v[152:155]
M v[156:159],a[164:167],a[28:31],v[200:203]
R a[164:167],v217,32768
M v[156:159],a[160:163],a[24:27],v[156:159]
R a[160:163],v216,32768
M v[156:159],a[156:159],a[20:23],v[156:159]
R a[156:159],v215,32768
M v[156:159],a[152:155],a[16:19],v[156:159]
R a[152:155],v214,32768
M v[20:23],a[168:171],v[164:167],v[20:23]
E v152
M v[20:23],a[172:175],v[172:175],v[20:23]
E v153
M v[52:55],a[172:175],v[176:179],v[52:55]
E v154
M v[52:55],a[168:171],v[168:171],v[52:55]
E v155
M v[56:59],a[176:179],v[168:171],v[56:59]
E v156
M v[56:59],a[180:183],v[176:179],v[56:59]
E v157
M v[24:27],a[180:183],v[172:175],v[24:27]
E v158
M v[24:27],a[176:179],v[164:167],v[24:27]
E v159
M v[28:31],a[184:187],v[164:167],v[28:31]
C v190,v152,v153
C v191,v154,v155
M v[28:31],a[188:191],v[172:175],v[28:31]
C v194,v156,v157
C v195,v158,v159
M v[60:63],a[188:191],v[176:179],v[60:63]
s_waitcnt vmcnt(13)
s_barrier
R a[168:171],v210,36864
Dn v254,s[12:15],0
M v[60:63],a[184:187],v[168:171],v[60:63]
R a[172:175],v211,36864
M a[212:215],a[192:195],a[196:199],a[212:215]
R a[176:179],v212,36864
M a[212:215],a[192:195],a[200:203],a[212:215]
R a[180:183],v213,36864
M a[204:207],a[192:195],v[164:167],a[204:207]
T a[184:185],v224,32768
M a[204:207],a[192:195],v[172:175],a[204:207]
T a[186:187],v224,36864
Dn v255,s[12:15],1024
M a[208:211],a[192:195],v[168:171],a[208:211]
T a[188:189],v224,40960
M a[208:211],a[192:195],v[176:179],a[208:211]
T a[190:191],v224,45056
M v[144:147],a[248:251],a[48:51],0
R a[196:199],v243,2048
M v[144:147],a[252:255],a[52:55],v[144:147]
R a[200:203],v243,3072
M v[144:147],a[216:219],a[56:59],v[144:147]
Dn v254,s[12:15],2048
M v[144:147],a[220:223],a[60:63],v[144:147]
M v[148:151],a[220:223],a[76:79],0
M v[148:151],a[216:219],a[72:75],v[148:151]
M v[148:151],a[252:255],a[68:71],v[148:151]
Dn v255,s[12:15],3072
M v[148:151],a[248:251],a[64:67],v[148:151]
s_add_u32 m0,s45,16384
M v[160:163],a[248:251],a[80:83],0
s_add_u32 s8,s66,131072
M v[160:163],a[252:255],a[84:87],v[160:163]
s_xor_b32 s3,s5,7
v_max3_f32 v196,v144,v145,v146
M v[160:163],a[216:219],a[88:91],v[160:163]
s_lshl_b32 s3,s3,4
Dn v245,s[8:11],0
v_max_f32 v196,v196,v147
M v[160:163],a[220:223],a[92:95],v[160:163]
s_waitcnt lgkmcnt(0)
s_sub_u32 s100,s3,147456
v_max3_f32 v200,v148,v149,v150
M v[80:83],a[224:227],a[96:99],v[80:83]
v_max_f32 v200,v200,v151
v_add_lshl_u32 v238,s100,v244,4
M v[80:83],a[228:231],a[100:103],v[80:83]
M v[112:115],a[228:231],a[108:111],v[112:115]
Dn v246,s[8:11],1024
v_max3_f32 v204,v160,v161,v162
M v[112:115],a[224:227],a[104:107],v[112:115]
R a[224:227],v210,40960
v_max_f32 v204,v204,v163
M v[116:119],a[232:235],a[104:107],v[116:119]
s_cmp_lg_u32 s59,0
s_cbranch_scc1 L_mx1
L_mr1:
M v[116:119],a[236:239],a[108:111],v[116:119]
v_mov_b32 v205,v204
v_mov_b32 v197,v196
v_mov_b32 v201,v200
M v[84:87],a[236:239],a[100:103],v[84:87]
T a[248:249],v225,32768
Dn v245,s[8:11],2048
v_permlane16_swap_b32 v204,v205
v_permlane16_swap_b32 v196,v197
M v[84:87],a[232:235],a[96:99],v[84:87]
v_max_f32 v204,v204,v205
v_max_f32 v196,v196,v197
v_permlane16_swap_b32 v200,v201
M v[88:91],a[240:243],a[96:99],v[88:91]
v_mov_b32 v205,v204
v_mov_b32 v197,v196
v_max_f32 v200,v200,v201
M v[88:91],a[244:247],a[100:103],v[88:91]
Dn v246,s[8:11],3072
v_permlane32_swap_b32 v204,v205
v_permlane32_swap_b32 v196,v197
v_mov_b32 v201,v200
M v[120:123],a[244:247],a[108:111],v[120:123]
s_add_u32 m0,s45,114688
v_min_f32_e64 v204,-v204,-v205
v_min_f32_e64 v196,-v196,-v197
M v[120:123],a[240:243],a[104:107],v[120:123]
s_add_u32 s16,s42,512
v_mov_b32 v205,v204
v_mov_b32 v206,v204
v_mov_b32 v207,v204
v_mov_b32 v197,v196
v_mov_b32 v198,v196
v_mov_b32 v199,v196
v_permlane32_swap_b32 v200,v201
M v[124:127],a[144:147],a[104:107],v[124:127]
T a[250:251],v225,36864
v_min_f32_e64 v200,-v200,-v201
v_add_f32 v144,v144,v196
v_add_f32 v145,v145,v196
v_add_f32 v146,v146,v196
v_add_f32 v147,v147,v196
M v[124:127],a[148:151],a[108:111],v[124:127]
v_mov_b32 v201,v200
v_mov_b32 v202,v200
v_mov_b32 v203,v200
E v144
E v145
M v[92:95],a[148:151],a[100:103],v[92:95]
T a[252:253],v225,40960
E v146
E v147
C v164,v144,v145
v_add_f32 v148,v148,v200
v_add_f32 v149,v149,v200
M v[92:95],a[144:147],a[96:99],v[92:95]
T a[254:255],v225,45056
C v165,v146,v147
v_add_f32 v150,v150,v200
v_add_f32 v151,v151,v200
E v148
E v149
M v[160:163],a[152:155],a[80:83],v[204:207]
T a[216:217],v220,16384
E v150
E v151
C v168,v148,v149
M v[160:163],a[156:159],a[84:87],v[160:163]
T a[218:219],v220,20480
C v169,v150,v151
M v[160:163],a[160:163],a[88:91],v[160:163]
buffer_store_byte v239,v238,s[84:87],s5 offen sc1
M v[160:163],a[164:167],a[92:95],v[160:163]
T a[220:221],v220,24576
M v[152:155],a[168:171],a[48:51],v[196:199]
T a[222:223],v220,28672
M v[152:155],a[172:175],a[52:55],v[152:155]
R a[228:231],v211,40960
M v[152:155],a[176:179],a[56:59],v[152:155]
R a[232:235],v212,40960
M v[152:155],a[180:183],a[60:63],v[152:155]
E v160
E v161
E v162
E v163
M v[156:159],a[180:183],a[76:79],v[200:203]
R a[236:239],v213,40960
C v208,v160,v161
C v209,v162,v163
M v[156:159],a[176:179],a[72:75],v[156:159]
E v152
E v153
E v154
E v155
M v[156:159],a[172:175],a[68:71],v[156:159]
T a[240:241],v221,16384
C v166,v152,v153
C v167,v154,v155
M v[156:159],a[168:171],a[64:67],v[156:159]
ds_write_b64 v242,v[208:209] offset:0
M v[96:99],a[184:187],a[96:99],v[96:99]
T a[242:243],v221,20480
M v[96:99],a[188:191],a[100:103],v[96:99]
T a[244:245],v221,24576
M v[128:131],a[188:191],a[108:111],v[128:131]
T a[246:247],v221,28672
M v[128:131],a[184:187],a[104:107],v[128:131]
s_waitcnt lgkmcnt(5)
E v156
E v157
E v158
E v159
M v[132:135],a[248:251],a[104:107],v[132:135]
C v170,v156,v157
C v171,v158,v159
s_waitcnt vmcnt(7)
s_barrier
T a[144:145],v218,16384
M v[132:135],a[252:255],a[108:111],v[132:135]
T a[146:147],v218,20480
M v[100:103],a[252:255],a[100:103],v[100:103]
T a[148:149],v218,24576
M v[100:103],a[248:251],a[96:99],v[100:103]
T a[150:151],v218,28672
M v[8:11],a[216:219],v[180:183],v[8:11]
T a[152:153],v219,16384
M v[8:11],a[220:223],v[188:191],v[8:11]
T a[154:155],v219,20480
M v[40:43],a[220:223],v[192:195],v[40:43]
T a[156:157],v219,24576
M v[40:43],a[216:219],v[184:187],v[40:43]
T a[158:159],v219,28672
M a[212:215],a[192:195],a[196:199],a[212:215]
R a[160:163],v210,45056
M a[212:215],a[192:195],a[200:203],a[212:215]
R a[164:167],v211,45056
M a[204:207],a[192:195],v[180:183],a[204:207]
R a[168:171],v212,45056
M a[204:207],a[192:195],v[188:191],a[204:207]
R a[172:175],v213,45056
M a[208:211],a[192:195],v[184:187],a[208:211]
T a[176:177],v222,16384
D v230,s[16:19],0
M a[208:211],a[192:195],v[192:195],a[208:211]
T a[178:179],v222,20480
v_accvgpr_read_b32 v253,a212
M v[144:147],a[224:227],a[48:51],v[196:199]
T a[180:181],v222,24576
v_accvgpr_read_b32 v251,a204
M v[144:147],a[228:231],a[52:55],v[144:147]
T a[182:183],v222,28672
v_mov_b32 v250,v251
M v[144:147],a[232:235],a[56:59],v[144:147]
T a[184:185],v223,16384
v_accvgpr_read_b32 v252,a208
v_rcp_f32 v251,v251
M v[144:147],a[236:239],a[60:63],v[144:147]
D v231,s[16:19],1024
v_add_f32 v250,v250,v252
v_mul_f32 v8,v251,v8
v_mul_f32 v9,v251,v9
v_mul_f32 v10,v251,v10
v_mul_f32 v11,v251,v11
M v[148:151],a[236:239],a[76:79],v[200:203]
s_add_u32 s16,s42,129536
v_rcp_f32 v252,v252
v_add_f32 v250,v250,v253
C v8,v8,v9
M v[148:151],a[232:235],a[72:75],v[148:151]
v_rcp_f32 v253,v253
E v144
E v145
M v[148:151],a[228:231],a[68:71],v[148:151]
T a[186:187],v223,20480
D v230,s[16:19],2048
M v[148:151],a[224:227],a[64:67],v[148:151]
s_waitcnt lgkmcnt(2)
T a[188:189],v223,24576
C v172,v144,v145
M v[12:15],a[240:243],v[180:183],v[12:15]
T a[190:191],v223,28672
C v9,v10,v11
M v[12:15],a[244:247],v[188:191],v[12:15]
T a[248:249],v224,16384
v_accvgpr_write_b32 a4,v8
M v[44:47],a[244:247],v[192:195],v[44:47]
T a[250:251],v224,20480
v_accvgpr_write_b32 a5,v9
M v[44:47],a[240:243],v[184:187],v[44:47]
T a[252:253],v224,24576
D v231,s[16:19],3072
M v[32:35],a[144:147],v[184:187],v[32:35]
s_add_u32 m0,s45,98304
T a[254:255],v224,28672
v_mul_f32 v12,v251,v12
M v[32:35],a[148:151],v[192:195],v[32:35]
s_add_u32 s3,s65,131072
T a[216:217],v225,16384
v_mul_f32 v13,v251,v13
M v[0:3],a[148:151],v[188:191],v[0:3]
s_add_u32 s12,s3,s51
T a[218:219],v225,20480
v_mul_f32 v14,v251,v14
M v[0:3],a[144:147],v[180:183],v[0:3]
T a[220:221],v225,24576
v_mul_f32 v15,v251,v15
M v[64:67],a[144:147],a[196:199],v[64:67]
T a[222:223],v225,28672
C v10,v12,v13
M v[64:67],a[148:151],a[200:203],v[64:67]
R a[224:227],v214,0
C v11,v14,v15
M v[4:7],a[152:155],v[180:183],v[4:7]
R a[228:231],v215,0
v_accvgpr_write_b32 a6,v10
M v[4:7],a[156:159],v[188:191],v[4:7]
R a[232:235],v216,0
v_accvgpr_write_b32 a7,v11
M v[36:39],a[156:159],v[192:195],v[36:39]
R a[236:239],v217,0
v_mul_f32 v40,v252,v40
M v[36:39],a[152:155],v[184:187],v[36:39]
R a[240:243],v210,0
v_mul_f32 v41,v252,v41
M v[68:71],a[152:155],a[196:199],v[68:71]
R a[244:247],v211,0
v_mul_f32 v42,v252,v42
M v[68:71],a[156:159],a[200:203],v[68:71]
R a[144:147],v212,0
v_mul_f32 v43,v252,v43
M v[152:155],a[160:163],a[48:51],v[196:199]
L_pg7:
s_cmp_eq_u32 s47,1
s_cbranch_scc1 L_bkT0_1
R a[148:151],v213,0
v_mul_f32 v44,v252,v44
M v[152:155],a[164:167],a[52:55],v[152:155]
R a[120:123],v226,32768
v_mul_f32 v45,v252,v45
M v[152:155],a[168:171],a[56:59],v[152:155]
T a[152:153],v218,49152
v_mul_f32 v46,v252,v46
M v[152:155],a[172:175],a[60:63],v[152:155]
T a[154:155],v218,53248
v_mul_f32 v47,v252,v47
M v[156:159],a[172:175],a[76:79],v[200:203]
R a[124:127],v227,32768
C v40,v40,v41
M v[156:159],a[168:171],a[72:75],v[156:159]
E v146
M v[156:159],a[164:167],a[68:71],v[156:159]
E v147
M v[156:159],a[160:163],a[64:67],v[156:159]
T a[156:157],v218,57344
C v173,v146,v147
M v[16:19],a[176:179],v[180:183],v[16:19]
T a[158:159],v218,61440
C v41,v42,v43
M v[16:19],a[180:183],v[188:191],v[16:19]
R a[132:135],v227,34816
C v42,v44,v45
M v[48:51],a[180:183],v[192:195],v[48:51]
R a[128:131],v226,34816
C v43,v46,v47
M v[48:51],a[176:179],v[184:187],v[48:51]
s_waitcnt lgkmcnt(6)
R a[136:139],v228,2048
v_accvgpr_write_b32 a20,v40
M v[52:55],a[184:187],v[184:187],v[52:55]
E v148
M v[52:55],a[188:191],v[192:195],v[52:55]
E v149
M v[20:23],a[188:191],v[188:191],v[20:23]
E v150
M v[20:23],a[184:187],v[180:183],v[20:23]
E v151
M v[24:27],a[248:251],v[180:183],v[24:27]
s_waitcnt vmcnt(9)
s_barrier
R a[140:143],v229,2048
Dn v254,s[12:15],0
C v176,v148,v149
C v177,v150,v151
E v152
E v153
M v[24:27],a[252:255],v[188:191],v[24:27]
T a[160:161],v219,49152
E v154
E v155
C v174,v152,v153
E v156
M v[56:59],a[252:255],v[192:195],v[56:59]
T a[162:163],v219,53248
Dn v255,s[12:15],1024
C v175,v154,v155
E v157
E v158
M v[56:59],a[248:251],v[184:187],v[56:59]
T a[164:165],v219,57344
E v159
C v178,v156,v157
v_accvgpr_write_b32 a21,v41
v_accvgpr_write_b32 a22,v42
v_accvgpr_write_b32 a23,v43
v_mul_f32 v32,v252,v32
M v[60:63],a[216:219],v[184:187],v[60:63]
T a[166:167],v219,61440
Dn v254,s[12:15],2048
C v179,v158,v159
v_mul_f32 v33,v252,v33
v_mul_f32 v34,v252,v34
v_mul_f32 v35,v252,v35
v_mul_f32 v36,v252,v36
v_mul_f32 v37,v252,v37
M v[60:63],a[220:223],v[192:195],v[60:63]
T a[168:169],v220,49152
v_mul_f32 v38,v252,v38
v_mul_f32 v39,v252,v39
C v32,v32,v33
v_mul_f32 v0,v251,v0
v_mul_f32 v1,v251,v1
v_mul_f32 v2,v251,v2
v_mul_f32 v3,v251,v3
M v[28:31],a[220:223],v[188:191],v[28:31]
T a[170:171],v220,53248
Dn v255,s[12:15],3072
C v33,v34,v35
v_accvgpr_write_b32 a16,v32
v_mul_f32 v4,v251,v4
v_mul_f32 v5,v251,v5
v_mul_f32 v6,v251,v6
v_mul_f32 v7,v251,v7
M v[28:31],a[216:219],v[180:183],v[28:31]
s_add_u32 m0,s45,32768
T a[172:173],v220,57344
C v34,v36,v37
C v35,v38,v39
v_accvgpr_write_b32 a17,v33
C v0,v0,v1
v_mul_f32 v64,v253,v64
v_mul_f32 v65,v253,v65
v_mul_f32 v66,v253,v66
M v[160:163],a[224:227],a[80:83],v[204:207]
s_add_u32 s8,s67,131072
T a[174:175],v220,61440
v_accvgpr_write_b32 a18,v34
v_accvgpr_write_b32 a19,v35
C v1,v2,v3
v_accvgpr_write_b32 a0,v0
v_mul_f32 v67,v253,v67
v_mul_f32 v68,v253,v68
v_mul_f32 v69,v253,v69
M v[160:163],a[228:231],a[84:87],v[160:163]
T a[176:177],v221,49152
Dn v245,s[8:11],0
C v2,v4,v5
C v3,v6,v7
v_accvgpr_write_b32 a1,v1
v_mul_f32 v70,v253,v70
v_mul_f32 v71,v253,v71
C v64,v64,v65
M v[160:163],a[232:235],a[88:91],v[160:163]
T a[178:179],v221,53248
v_accvgpr_write_b32 a2,v2
v_accvgpr_write_b32 a3,v3
C v65,v66,v67
v_accvgpr_write_b32 a32,v64
v_mul_f32 v16,v251,v16
M v[160:163],a[236:239],a[92:95],v[160:163]
T a[180:181],v221,57344
Dn v246,s[8:11],1024
M v[144:147],a[240:243],a[48:51],v[196:199]
T a[182:183],v221,61440
C v66,v68,v69
M v[144:147],a[244:247],a[52:55],v[144:147]
R a[184:187],v210,4096
C v67,v70,v71
M v[144:147],a[144:147],a[56:59],v[144:147]
R a[188:191],v211,4096
v_accvgpr_write_b32 a33,v65
M v[144:147],a[148:151],a[60:63],v[144:147]
R a[248:251],v212,4096
v_accvgpr_write_b32 a34,v66
M v[148:151],a[148:151],a[76:79],v[200:203]
R a[252:255],v213,4096
Dn v245,s[8:11],2048
M v[148:151],a[144:147],a[72:75],v[148:151]
T a[216:217],v222,49152
v_accvgpr_write_b32 a35,v67
M v[148:151],a[244:247],a[68:71],v[148:151]
T a[218:219],v222,53248
v_mul_f32 v17,v251,v17
M v[148:151],a[240:243],a[64:67],v[148:151]
s_waitcnt lgkmcnt(8)
T a[220:221],v222,57344
v_mul_f32 v18,v251,v18
M v[72:75],a[152:155],a[120:123],v[72:75]
T a[222:223],v222,61440
v_mul_f32 v19,v251,v19
M v[72:75],a[156:159],a[124:127],v[72:75]
T a[224:225],v223,49152
Dn v246,s[8:11],3072
M v[104:107],a[156:159],a[132:135],v[104:107]
s_add_u32 m0,s45,65536
T a[226:227],v223,53248
v_mul_f32 v20,v251,v20
M v[104:107],a[152:155],a[128:131],v[104:107]
s_add_u32 s20,s99,0
T a[228:229],v223,57344
v_mul_f32 v21,v251,v21
M v[136:139],a[152:155],a[136:139],v[136:139]
T a[230:231],v223,61440
v_mul_f32 v22,v251,v22
M v[136:139],a[156:159],a[140:143],v[136:139]
T a[232:233],v224,49152
v_mul_f32 v23,v251,v23
M v[76:79],a[160:163],a[120:123],v[76:79]
T a[234:235],v224,53248
D v247,s[20:23],0
M v[76:79],a[164:167],a[124:127],v[76:79]
s_add_u32 s20,s99,7168
T a[236:237],v224,57344
C v16,v16,v17
M v[108:111],a[164:167],a[132:135],v[108:111]
T a[238:239],v224,61440
C v17,v18,v19
M v[108:111],a[160:163],a[128:131],v[108:111]
T a[240:241],v225,49152
C v18,v20,v21
M v[140:143],a[160:163],a[136:139],v[140:143]
T a[242:243],v225,53248
C v19,v22,v23
M v[140:143],a[164:167],a[140:143],v[140:143]
T a[244:245],v225,57344
D v247,s[20:23],1024
M v[80:83],a[168:171],a[120:123],v[80:83]
s_add_u32 s20,s99,14336
T a[246:247],v225,61440
v_accvgpr_write_b32 a8,v16
M v[80:83],a[172:175],a[124:127],v[80:83]
T a[144:145],v220,0
v_accvgpr_write_b32 a9,v17
M v[112:115],a[172:175],a[132:135],v[112:115]
T a[146:147],v220,4096
v_accvgpr_write_b32 a10,v18
M v[112:115],a[168:171],a[128:131],v[112:115]
T a[148:149],v220,8192
v_accvgpr_write_b32 a11,v19
M v[116:119],a[176:179],a[128:131],v[116:119]
s_waitcnt lgkmcnt(8)
T a[150:151],v220,12288
D v247,s[20:23],2048
M v[116:119],a[180:183],a[132:135],v[116:119]
s_add_u32 s20,s99,21504
R a[152:155],v210,8192
v_mul_f32 v48,v252,v48
M v[84:87],a[180:183],a[124:127],v[84:87]
R a[156:159],v211,8192
v_mul_f32 v49,v252,v49
M v[84:87],a[176:179],a[120:123],v[84:87]
R a[160:163],v212,8192
v_mul_f32 v50,v252,v50
M v[152:155],a[184:187],a[48:51],v[196:199]
R a[164:167],v213,8192
v_mul_f32 v51,v252,v51
M v[152:155],a[188:191],a[52:55],v[152:155]
T a[168:169],v221,0
D v247,s[20:23],3072
M v[152:155],a[248:251],a[56:59],v[152:155]
s_add_u32 m0,s45,131072
T a[170:171],v221,4096
v_mul_f32 v52,v252,v52
M v[152:155],a[252:255],a[60:63],v[152:155]
s_add_u32 s16,s43,512
E v144
M v[156:159],a[252:255],a[76:79],v[200:203]
E v145
M v[156:159],a[248:251],a[72:75],v[156:159]
E v146
M v[156:159],a[188:191],a[68:71],v[156:159]
E v147
M v[156:159],a[184:187],a[64:67],v[156:159]
T a[172:173],v221,8192
C v180,v144,v145
M v[88:91],a[216:219],a[120:123],v[88:91]
T a[174:175],v221,12288
C v181,v146,v147
M v[88:91],a[220:223],a[124:127],v[88:91]
T a[176:177],v218,0
v_mul_f32 v53,v252,v53
M v[120:123],a[220:223],a[132:135],v[120:123]
T a[178:179],v218,4096
v_mul_f32 v54,v252,v54
M v[120:123],a[216:219],a[128:131],v[120:123]
E v148
M v[124:127],a[224:227],a[128:131],v[124:127]
E v149
M v[124:127],a[228:231],a[132:135],v[124:127]
E v150
M v[92:95],a[228:231],a[124:127],v[92:95]
E v151
M v[92:95],a[224:227],a[120:123],v[92:95]
T a[180:181],v218,8192
C v184,v148,v149
M v[96:99],a[232:235],a[120:123],v[96:99]
s_waitcnt vmcnt(10) lgkmcnt(3)
s_barrier
T a[182:183],v218,12288
C v185,v150,v151
M v[96:99],a[236:239],a[124:127],v[96:99]
R a[196:199],v243,0
v_mul_f32 v55,v252,v55
M v[128:131],a[236:239],a[132:135],v[128:131]
R a[200:203],v243,1024
C v48,v48,v49
M v[128:131],a[232:235],a[128:131],v[128:131]
T a[184:185],v219,0
C v49,v50,v51
M v[132:135],a[240:243],a[128:131],v[132:135]
T a[186:187],v219,4096
C v50,v52,v53
M v[132:135],a[244:247],a[132:135],v[132:135]
T a[188:189],v219,8192
C v51,v54,v55
M v[100:103],a[244:247],a[124:127],v[100:103]
T a[190:191],v219,12288
v_accvgpr_write_b32 a24,v48
M v[100:103],a[240:243],a[120:123],v[100:103]
T a[248:249],v222,0
v_accvgpr_write_b32 a25,v49
M v[8:11],a[144:147],v[164:167],0
T a[250:251],v222,4096
v_accvgpr_write_b32 a26,v50
M v[8:11],a[148:151],v[172:175],v[8:11]
T a[252:253],v222,8192
v_accvgpr_write_b32 a27,v51
M v[40:43],a[148:151],v[176:179],0
T a[254:255],v222,12288
v_mul_f32 v56,v252,v56
M v[40:43],a[144:147],v[168:171],v[40:43]
R a[216:219],v210,12288
D v230,s[16:19],0
M v[144:147],a[152:155],a[48:51],v[196:199]
R a[220:223],v211,12288
v_mul_f32 v57,v252,v57
M v[144:147],a[156:159],a[52:55],v[144:147]
R a[224:227],v212,12288
v_mul_f32 v58,v252,v58
M v[144:147],a[160:163],a[56:59],v[144:147]
R a[228:231],v213,12288
v_mul_f32 v59,v252,v59
M v[144:147],a[164:167],a[60:63],v[144:147]
T a[232:233],v223,0
v_mul_f32 v60,v252,v60
M v[148:151],a[164:167],a[76:79],v[200:203]
T a[234:235],v223,4096
D v231,s[16:19],1024
M v[148:151],a[160:163],a[72:75],v[148:151]
s_add_u32 s16,s43,129536
E v152
M v[148:151],a[156:159],a[68:71],v[148:151]
E v153
M v[148:151],a[152:155],a[64:67],v[148:151]
E v154
M v[12:15],a[168:171],v[164:167],0
E v155
M v[12:15],a[172:175],v[172:175],v[12:15]
T a[236:237],v223,8192
D v230,s[16:19],2048
M v[44:47],a[172:175],v[176:179],0
C v182,v152,v153
C v183,v154,v155
M v[44:47],a[168:171],v[168:171],v[44:47]
s_waitcnt lgkmcnt(3)
T a[238:239],v223,12288
v_mul_f32 v61,v252,v61
M v[32:35],a[176:179],v[168:171],0
T a[240:241],v224,0
v_mul_f32 v62,v252,v62
M v[32:35],a[180:183],v[176:179],v[32:35]
T a[242:243],v224,4096
v_mul_f32 v63,v252,v63
M v[0:3],a[180:183],v[172:175],0
T a[244:245],v224,8192
D v231,s[16:19],3072
M v[0:3],a[176:179],v[164:167],v[0:3]
s_add_u32 m0,s46,151552
E v156
M v[64:67],a[176:179],a[196:199],0
s_and_b32 s20,s92,0xffffff7f
E v157
M v[64:67],a[180:183],a[200:203],v[64:67]
E v158
M v[4:7],a[184:187],v[164:167],0
E v159
M v[4:7],a[188:191],v[172:175],v[4:7]
D v240,s[20:23],0
C v186,v156,v157
M v[36:39],a[188:191],v[176:179],0
s_add_u32 m0,s45,81920
T a[246:247],v224,12288
C v187,v158,v159
M v[36:39],a[184:187],v[168:171],v[36:39]
s_add_u32 s3,s66,131072
T a[144:145],v225,0
C v56,v56,v57
M v[68:71],a[184:187],a[196:199],0
s_add_u32 s12,s3,s51
T a[146:147],v225,4096
C v57,v58,v59
M v[68:71],a[188:191],a[200:203],v[68:71]
T a[148:149],v225,8192
C v58,v60,v61
M v[16:19],a[248:251],v[164:167],0
T a[150:151],v225,12288
C v59,v62,v63
M v[16:19],a[252:255],v[172:175],v[16:19]
v_accvgpr_write_b32 a28,v56
v_accvgpr_write_b32 a29,v57
M v[48:51],a[252:255],v[176:179],0
v_accvgpr_write_b32 a30,v58
v_accvgpr_write_b32 a31,v59
M v[48:51],a[248:251],v[168:171],v[48:51]
v_mul_f32 v24,v251,v24
v_mul_f32 v25,v251,v25
M v[152:155],a[216:219],a[48:51],v[196:199]
v_mul_f32 v26,v251,v26
v_mul_f32 v27,v251,v27
M v[152:155],a[220:223],a[52:55],v[152:155]
v_mul_f32 v28,v251,v28
v_mul_f32 v29,v251,v29
M v[152:155],a[224:227],a[56:59],v[152:155]
v_mul_f32 v30,v251,v30
v_mul_f32 v31,v251,v31
M v[152:155],a[228:231],a[60:63],v[152:155]
R a[152:155],v214,16384
C v24,v24,v25
M v[156:159],a[228:231],a[76:79],v[200:203]
C v25,v26,v27
v_accvgpr_write_b32 a12,v24
M v[156:159],a[224:227],a[72:75],v[156:159]
C v26,v28,v29
C v27,v30,v31
M v[156:159],a[220:223],a[68:71],v[156:159]
v_accvgpr_write_b32 a13,v25
v_accvgpr_write_b32 a14,v26
M v[156:159],a[216:219],a[64:67],v[156:159]
s_waitcnt lgkmcnt(1)
R a[156:159],v215,16384
v_accvgpr_write_b32 a15,v27
M v[20:23],a[232:235],v[164:167],0
E v160
M v[20:23],a[236:239],v[172:175],v[20:23]
E v161
M v[52:55],a[236:239],v[176:179],0
E v162
M v[52:55],a[232:235],v[168:171],v[52:55]
E v163
M v[56:59],a[240:243],v[168:171],0
C v208,v160,v161
C v209,v162,v163
M v[56:59],a[244:247],v[176:179],v[56:59]
ds_write_b64 v242,v[208:209] offset:2048
M v[24:27],a[244:247],v[172:175],0
R a[160:163],v216,16384
R a[164:167],v217,16384
M v[24:27],a[240:243],v[164:167],v[24:27]
R a[168:171],v210,16384
v_xor_b32 v251,1024,v244
M v[28:31],a[144:147],v[164:167],0
R a[172:175],v211,16384
R a[176:179],v212,16384
M v[28:31],a[148:151],v[172:175],v[28:31]
R a[180:183],v213,16384
v_xor_b32 v252,2048,v244
M v[60:63],a[148:151],v[176:179],0
R a[96:99],v226,16384
v_xor_b32 v253,3072,v244
M v[60:63],a[144:147],v[168:171],v[60:63]
s_waitcnt vmcnt(13) lgkmcnt(7)
s_barrier
T a[184:185],v218,32768
Dn v254,s[12:15],0
E v144
E v145
E v146
M a[212:215],a[192:195],a[196:199],0
T a[186:187],v218,36864
E v147
C v188,v144,v145
E v148
E v149
M a[212:215],a[192:195],a[200:203],a[212:215]
R a[100:103],v227,16384
Dn v255,s[12:15],1024
C v189,v146,v147
E v150
E v151
C v192,v148,v149
M a[204:207],a[192:195],v[164:167],0
T a[188:189],v218,40960
T a[190:191],v218,45056
C v193,v150,v151
E v152
E v153
M a[204:207],a[192:195],v[172:175],a[204:207]
R a[108:111],v227,18432
Dn v254,s[12:15],2048
E v154
E v155
C v190,v152,v153
M a[208:211],a[192:195],v[168:171],0
R a[104:107],v226,18432
C v191,v154,v155
E v156
E v157
E v158
M a[208:211],a[192:195],v[176:179],a[208:211]
R a[112:115],v228,4096
Dn v255,s[12:15],3072
E v159
C v194,v156,v157
M v[160:163],a[152:155],a[80:83],v[204:207]
s_add_u32 m0,s45,0
R a[116:119],v229,4096
T a[248:249],v219,32768
C v195,v158,v159
M v[160:163],a[156:159],a[84:87],v[160:163]
s_waitcnt lgkmcnt(5)
s_add_u32 s8,s68,131072
T a[250:251],v219,36864
M v[160:163],a[160:163],a[88:91],v[160:163]
T a[252:253],v219,40960
T a[254:255],v219,45056
M v[160:163],a[164:167],a[92:95],v[160:163]
R a[216:219],v210,20480
Dn v245,s[8:11],0
M v[144:147],a[168:171],a[48:51],v[196:199]
R a[220:223],v211,20480
M v[144:147],a[172:175],a[52:55],v[144:147]
R a[224:227],v212,20480
M v[144:147],a[176:179],a[56:59],v[144:147]
R a[228:231],v213,20480
M v[144:147],a[180:183],a[60:63],v[144:147]
E v160
E v161
E v162
E v163
M v[148:151],a[180:183],a[76:79],v[200:203]
T a[232:233],v220,32768
Dn v246,s[8:11],1024
C v208,v160,v161
C v209,v162,v163
M v[148:151],a[176:179],a[72:75],v[148:151]
E v144
E v145
E v146
E v147
M v[148:151],a[172:175],a[68:71],v[148:151]
T a[234:235],v220,36864
C v164,v144,v145
C v165,v146,v147
M v[148:151],a[168:171],a[64:67],v[148:151]
T a[236:237],v220,40960
Dn v245,s[8:11],2048
M v[72:75],a[184:187],a[96:99],v[72:75]
ds_write_b64 v242,v[208:209] offset:0
M v[72:75],a[188:191],a[100:103],v[72:75]
s_waitcnt lgkmcnt(4)
T a[238:239],v220,45056
M v[104:107],a[188:191],a[108:111],v[104:107]
E v148
E v149
E v150
E v151
M v[104:107],a[184:187],a[104:107],v[104:107]
T a[240:241],v221,32768
Dn v246,s[8:11],3072
C v168,v148,v149
C v169,v150,v151
M v[136:139],a[184:187],a[112:115],v[136:139]
s_add_u32 m0,s45,49152
T a[242:243],v221,36864
M v[136:139],a[188:191],a[116:119],v[136:139]
s_add_u32 s20,s92,0
T a[244:245],v221,40960
M v[76:79],a[248:251],a[96:99],v[76:79]
T a[246:247],v221,45056
M v[76:79],a[252:255],a[100:103],v[76:79]
T a[144:145],v222,32768
D v247,s[20:23],0
M v[108:111],a[252:255],a[108:111],v[108:111]
s_add_u32 s20,s92,7168
T a[146:147],v222,36864
M v[108:111],a[248:251],a[104:107],v[108:111]
T a[148:149],v222,40960
M v[140:143],a[248:251],a[112:115],v[140:143]
T a[150:151],v222,45056
M v[140:143],a[252:255],a[116:119],v[140:143]
T a[152:153],v220,16384
M v[152:155],a[216:219],a[48:51],v[196:199]
T a[154:155],v220,20480
D v247,s[20:23],1024
M v[152:155],a[220:223],a[52:55],v[152:155]
s_add_u32 s20,s92,14336
T a[156:157],v220,24576
M v[152:155],a[224:227],a[56:59],v[152:155]
T a[158:159],v220,28672
M v[152:155],a[228:231],a[60:63],v[152:155]
R a[160:163],v210,24576
M v[156:159],a[228:231],a[76:79],v[200:203]
R a[164:167],v211,24576
M v[156:159],a[224:227],a[72:75],v[156:159]
R a[196:199],v243,2048
D v247,s[20:23],2048
M v[156:159],a[220:223],a[68:71],v[156:159]
L_pg8:
s_cmp_eq_u32 s47,1
s_cbranch_scc1 L_bkT0_2
s_add_u32 s20,s92,21504
R a[200:203],v243,3072
M v[156:159],a[216:219],a[64:67],v[156:159]
s_waitcnt lgkmcnt(8)
E v152
E v153
E v154
E v155
M v[80:83],a[232:235],a[96:99],v[80:83]
R a[168:171],v212,24576
D v247,s[20:23],3072
C v166,v152,v153
C v167,v154,v155
M v[80:83],a[236:239],a[100:103],v[80:83]
s_add_u32 m0,s45,98304
E v156
E v157
E v158
E v159
M v[112:115],a[236:239],a[108:111],v[112:115]
s_add_u32 s3,s67,131072
R a[172:175],v213,24576
C v170,v156,v157
C v171,v158,v159
M v[112:115],a[232:235],a[104:107],v[112:115]
s_add_u32 s12,s3,s51
T a[176:177],v221,16384
M v[116:119],a[240:243],a[104:107],v[116:119]
T a[178:179],v221,20480
M v[116:119],a[244:247],a[108:111],v[116:119]
T a[180:181],v221,24576
M v[84:87],a[244:247],a[100:103],v[84:87]
T a[182:183],v221,28672
M v[84:87],a[240:243],a[96:99],v[84:87]
T a[184:185],v218,16384
M v[88:91],a[144:147],a[96:99],v[88:91]
s_waitcnt vmcnt(10) lgkmcnt(6)
s_barrier
T a[186:187],v218,20480
M v[88:91],a[148:151],a[100:103],v[88:91]
T a[188:189],v218,24576
M v[120:123],a[148:151],a[108:111],v[120:123]
T a[190:191],v218,28672
M v[120:123],a[144:147],a[104:107],v[120:123]
T a[248:249],v219,16384
M v[8:11],a[152:155],v[180:183],v[8:11]
T a[250:251],v219,20480
M v[8:11],a[156:159],v[188:191],v[8:11]
T a[252:253],v219,24576
M v[40:43],a[156:159],v[192:195],v[40:43]
T a[254:255],v219,28672
M v[40:43],a[152:155],v[184:187],v[40:43]
T a[216:217],v222,16384
M v[144:147],a[160:163],a[48:51],v[196:199]
T a[218:219],v222,20480
M v[144:147],a[164:167],a[52:55],v[144:147]
T a[220:221],v222,24576
M v[144:147],a[168:171],a[56:59],v[144:147]
s_waitcnt lgkmcnt(8)
T a[222:223],v222,28672
M v[144:147],a[172:175],a[60:63],v[144:147]
R a[224:227],v210,28672
M v[148:151],a[172:175],a[76:79],v[200:203]
R a[228:231],v211,28672
M v[148:151],a[168:171],a[72:75],v[148:151]
R a[232:235],v212,28672
M v[148:151],a[164:167],a[68:71],v[148:151]
R a[236:239],v213,28672
M v[148:151],a[160:163],a[64:67],v[148:151]
E v144
E v145
E v146
E v147
M v[12:15],a[176:179],v[180:183],v[12:15]
T a[240:241],v223,16384
C v172,v144,v145
C v173,v146,v147
M v[12:15],a[180:183],v[188:191],v[12:15]
E v148
E v149
E v150
M v[44:47],a[180:183],v[192:195],v[44:47]
T a[242:243],v223,20480
C v176,v148,v149
M v[44:47],a[176:179],v[184:187],v[44:47]
E v151
M v[32:35],a[184:187],v[184:187],v[32:35]
s_waitcnt lgkmcnt(2)
T a[244:245],v223,24576
C v177,v150,v151
M v[32:35],a[188:191],v[192:195],v[32:35]
T a[246:247],v223,28672
M v[0:3],a[188:191],v[188:191],v[0:3]
T a[144:145],v224,16384
M v[0:3],a[184:187],v[180:183],v[0:3]
T a[146:147],v224,20480
M v[64:67],a[184:187],a[196:199],v[64:67]
T a[148:149],v224,24576
M v[64:67],a[188:191],a[200:203],v[64:67]
T a[150:151],v224,28672
M v[4:7],a[248:251],v[180:183],v[4:7]
T a[152:153],v225,16384
M v[4:7],a[252:255],v[188:191],v[4:7]
T a[154:155],v225,20480
M v[36:39],a[252:255],v[192:195],v[36:39]
T a[156:157],v225,24576
M v[36:39],a[248:251],v[184:187],v[36:39]
T a[158:159],v225,28672
M v[68:71],a[248:251],a[196:199],v[68:71]
R a[160:163],v214,32768
M v[68:71],a[252:255],a[200:203],v[68:71]
R a[164:167],v215,32768
M v[16:19],a[216:219],v[180:183],v[16:19]
R a[168:171],v216,32768
M v[16:19],a[220:223],v[188:191],v[16:19]
R a[172:175],v217,32768
M v[48:51],a[220:223],v[192:195],v[48:51]
R a[176:179],v210,32768
M v[48:51],a[216:219],v[184:187],v[48:51]
R a[180:183],v211,32768
M v[152:155],a[224:227],a[48:51],v[196:199]
R a[184:187],v212,32768
M v[152:155],a[228:231],a[52:55],v[152:155]
R a[188:191],v213,32768
M v[152:155],a[232:235],a[56:59],v[152:155]
T a[248:249],v223,32768
M v[152:155],a[236:239],a[60:63],v[152:155]
T a[250:251],v223,36864
M v[156:159],a[236:239],a[76:79],v[200:203]
T a[252:253],v223,40960
M v[156:159],a[232:235],a[72:75],v[156:159]
T a[254:255],v223,45056
M v[156:159],a[228:231],a[68:71],v[156:159]
T a[216:217],v224,32768
M v[156:159],a[224:227],a[64:67],v[156:159]
s_waitcnt lgkmcnt(8)
E v152
M v[20:23],a[240:243],v[180:183],v[20:23]
E v153
M v[20:23],a[244:247],v[188:191],v[20:23]
T a[218:219],v224,36864
C v174,v152,v153
M v[52:55],a[244:247],v[192:195],v[52:55]
E v154
M v[52:55],a[240:243],v[184:187],v[52:55]
E v155
M v[56:59],a[144:147],v[184:187],v[56:59]
T a[220:221],v224,40960
C v175,v154,v155
M v[56:59],a[148:151],v[192:195],v[56:59]
E v156
M v[24:27],a[148:151],v[188:191],v[24:27]
E v157
M v[24:27],a[144:147],v[180:183],v[24:27]
T a[222:223],v224,45056
C v178,v156,v157
M v[28:31],a[152:155],v[180:183],v[28:31]
E v158
M v[28:31],a[156:159],v[188:191],v[28:31]
E v159
M v[60:63],a[156:159],v[192:195],v[60:63]
s_waitcnt vmcnt(8)
s_barrier
T a[224:225],v225,32768
Dn v254,s[12:15],0
C v179,v158,v159
M v[60:63],a[152:155],v[184:187],v[60:63]
T a[226:227],v225,36864
M a[212:215],a[192:195],a[196:199],a[212:215]
T a[228:229],v225,40960
M a[212:215],a[192:195],a[200:203],a[212:215]
T a[230:231],v225,45056
M a[204:207],a[192:195],v[180:183],a[204:207]
R a[232:235],v210,36864
Dn v255,s[12:15],1024
M a[204:207],a[192:195],v[188:191],a[204:207]
R a[236:239],v211,36864
M a[208:211],a[192:195],v[184:187],a[208:211]
R a[240:243],v212,36864
M a[208:211],a[192:195],v[192:195],a[208:211]
R a[244:247],v213,36864
M v[160:163],a[160:163],a[80:83],v[204:207]
R a[120:123],v226,32768
M v[160:163],a[164:167],a[84:87],v[160:163]
T a[144:145],v218,49152
Dn v254,s[12:15],2048
M v[160:163],a[168:171],a[88:91],v[160:163]
T a[146:147],v218,53248
M v[160:163],a[172:175],a[92:95],v[160:163]
R a[124:127],v227,32768
M v[144:147],a[176:179],a[48:51],v[196:199]
s_waitcnt lgkmcnt(8)
T a[148:149],v218,57344
M v[144:147],a[180:183],a[52:55],v[144:147]
T a[150:151],v218,61440
M v[144:147],a[184:187],a[56:59],v[144:147]
R a[132:135],v227,34816
Dn v255,s[12:15],3072
M v[144:147],a[188:191],a[60:63],v[144:147]
s_add_u32 m0,s45,16384
E v160
E v161
E v162
E v163
M v[148:151],a[188:191],a[76:79],v[200:203]
s_add_u32 s8,s69,131072
R a[128:131],v226,34816
C v208,v160,v161
C v209,v162,v163
M v[148:151],a[184:187],a[72:75],v[148:151]
R a[136:139],v228,6144
Dn v245,s[8:11],0
E v144
E v145
E v146
M v[148:151],a[180:183],a[68:71],v[148:151]
R a[140:143],v229,6144
E v147
C v180,v144,v145
M v[148:151],a[176:179],a[64:67],v[148:151]
T a[152:153],v219,49152
C v181,v146,v147
M v[92:95],a[248:251],a[96:99],v[92:95]
T a[154:155],v219,53248
Dn v246,s[8:11],1024
M v[92:95],a[252:255],a[100:103],v[92:95]
ds_write_b64 v242,v[208:209] offset:2048
M v[124:127],a[252:255],a[108:111],v[124:127]
E v148
E v149
E v150
E v151
M v[124:127],a[248:251],a[104:107],v[124:127]
T a[156:157],v219,57344
Dn v245,s[8:11],2048
C v184,v148,v149
C v185,v150,v151
M v[128:131],a[216:219],a[104:107],v[128:131]
T a[158:159],v219,61440
M v[128:131],a[220:223],a[108:111],v[128:131]
T a[160:161],v220,0
M v[96:99],a[220:223],a[100:103],v[96:99]
T a[162:163],v220,4096
M v[96:99],a[216:219],a[96:99],v[96:99]
T a[164:165],v220,8192
Dn v246,s[8:11],3072
M v[100:103],a[224:227],a[96:99],v[100:103]
s_add_u32 m0,s45,65536
T a[166:167],v220,12288
M v[100:103],a[228:231],a[100:103],v[100:103]
s_add_u32 s20,s93,0
R a[168:171],v210,40960
M v[132:135],a[228:231],a[108:111],v[132:135]
R a[172:175],v211,40960
M v[132:135],a[224:227],a[104:107],v[132:135]
s_waitcnt lgkmcnt(7)
R a[196:199],v243,0
M v[152:155],a[232:235],a[48:51],v[196:199]
R a[200:203],v243,1024
D v247,s[20:23],0
M v[152:155],a[236:239],a[52:55],v[152:155]
s_add_u32 s20,s93,7168
R a[176:179],v212,40960
M v[152:155],a[240:243],a[56:59],v[152:155]
R a[180:183],v213,40960
M v[152:155],a[244:247],a[60:63],v[152:155]
T a[184:185],v221,0
M v[156:159],a[244:247],a[76:79],v[200:203]
T a[186:187],v221,4096
M v[156:159],a[240:243],a[72:75],v[156:159]
T a[188:189],v221,8192
D v247,s[20:23],1024
M v[156:159],a[236:239],a[68:71],v[156:159]
s_add_u32 s20,s93,14336
T a[190:191],v221,12288
M v[156:159],a[232:235],a[64:67],v[156:159]
E v152
E v153
E v154
E v155
M v[72:75],a[144:147],a[120:123],v[72:75]
T a[248:249],v218,0
D v247,s[20:23],2048
C v182,v152,v153
C v183,v154,v155
M v[72:75],a[148:151],a[124:127],v[72:75]
s_add_u32 s20,s93,21504
E v156
E v157
E v158
E v159
M v[104:107],a[148:151],a[132:135],v[104:107]
T a[250:251],v218,4096
C v186,v156,v157
C v187,v158,v159
M v[104:107],a[144:147],a[128:131],v[104:107]
T a[252:253],v218,8192
D v247,s[20:23],3072
v_mul_f32 v72,s58,v72
v_mul_f32 v73,s58,v73
v_mul_f32 v74,s58,v74
v_mul_f32 v75,s58,v75
M v[136:139],a[144:147],a[136:139],v[136:139]
s_add_u32 m0,s45,114688
T a[254:255],v218,12288
C v72,v72,v73
M v[136:139],a[148:151],a[140:143],v[136:139]
s_add_u32 s16,s36,768
T a[216:217],v219,0
C v73,v74,v75
v_mul_f32 v104,s58,v104
v_mul_f32 v105,s58,v105
v_mul_f32 v106,s58,v106
v_mul_f32 v107,s58,v107
M v[76:79],a[152:155],a[120:123],v[76:79]
s_waitcnt lgkmcnt(4)
T a[218:219],v219,4096
C v104,v104,v105
M v[76:79],a[156:159],a[124:127],v[76:79]
T a[220:221],v219,8192
v_mul_f32 v136,s58,v136
v_mul_f32 v137,s58,v137
v_mul_f32 v138,s58,v138
v_mul_f32 v139,s58,v139
C v105,v106,v107
M v[108:111],a[156:159],a[132:135],v[108:111]
C v136,v136,v137
C v137,v138,v139
v_mul_f32 v76,s58,v76
v_mul_f32 v77,s58,v77
v_mul_f32 v78,s58,v78
v_mul_f32 v79,s58,v79
C v74,v76,v77
C v75,v78,v79
s_waitcnt vmcnt(9)
s_barrier
v_permlane16_swap_b32 v72,v74
v_permlane16_swap_b32 v73,v75
M v[108:111],a[152:155],a[128:131],v[108:111]
T a[222:223],v219,12288
v_accvgpr_write_b32 a96,v72
v_accvgpr_write_b32 a97,v73
v_accvgpr_write_b32 a98,v74
v_accvgpr_write_b32 a99,v75
M v[140:143],a[152:155],a[136:139],v[140:143]
T a[224:225],v222,0
M v[140:143],a[156:159],a[140:143],v[140:143]
T a[226:227],v222,4096
v_mul_f32 v108,s58,v108
v_mul_f32 v109,s58,v109
v_mul_f32 v110,s58,v110
v_mul_f32 v111,s58,v111
M v[8:11],a[160:163],v[164:167],v[8:11]
T a[228:229],v222,8192
C v106,v108,v109
C v107,v110,v111
M v[8:11],a[164:167],v[172:175],v[8:11]
T a[230:231],v222,12288
v_mul_f32 v140,s58,v140
v_mul_f32 v141,s58,v141
v_mul_f32 v142,s58,v142
M v[40:43],a[164:167],v[176:179],v[40:43]
R a[232:235],v210,45056
v_mul_f32 v143,s58,v143
M v[40:43],a[160:163],v[168:171],v[40:43]
R a[236:239],v211,45056
C v138,v140,v141
M v[144:147],a[168:171],a[48:51],v[196:199]
R a[240:243],v212,45056
C v139,v142,v143
M v[144:147],a[172:175],a[52:55],v[144:147]
R a[244:247],v213,45056
D v230,s[16:19],0
M v[144:147],a[176:179],a[56:59],v[144:147]
v_permlane16_swap_b32 v136,v138
M v[144:147],a[180:183],a[60:63],v[144:147]
v_permlane16_swap_b32 v137,v139
M v[148:151],a[180:183],a[76:79],v[200:203]
ds_write_b128 v244,v[136:139]
M v[148:151],a[176:179],a[72:75],v[148:151]
T a[144:145],v223,0
D v231,s[16:19],1024
M v[148:151],a[172:175],a[68:71],v[148:151]
s_add_u32 s16,s36,129792
v_permlane16_swap_b32 v104,v106
M v[148:151],a[168:171],a[64:67],v[148:151]
T a[146:147],v223,4096
v_accvgpr_write_b32 a112,v104
M v[12:15],a[184:187],v[164:167],v[12:15]
T a[148:149],v223,8192
v_accvgpr_write_b32 a114,v106
M v[12:15],a[188:191],v[172:175],v[12:15]
E v144
M v[44:47],a[188:191],v[176:179],v[44:47]
T a[150:151],v223,12288
D v230,s[16:19],2048
M v[44:47],a[184:187],v[168:171],v[44:47]
s_waitcnt lgkmcnt(5)
E v145
M v[32:35],a[248:251],v[168:171],v[32:35]
T a[152:153],v224,0
C v188,v144,v145
M v[32:35],a[252:255],v[176:179],v[32:35]
E v146
M v[0:3],a[252:255],v[172:175],v[0:3]
E v147
M v[0:3],a[248:251],v[164:167],v[0:3]
T a[154:155],v224,4096
D v231,s[16:19],3072
M v[64:67],a[248:251],a[196:199],v[64:67]
s_add_u32 m0,s46,155648
T a[156:157],v224,8192
C v189,v146,v147
M v[64:67],a[252:255],a[200:203],v[64:67]
s_and_b32 s20,s94,0xffffff7f
E v148
M v[4:7],a[216:219],v[164:167],v[4:7]
E v149
M v[4:7],a[220:223],v[172:175],v[4:7]
T a[158:159],v224,12288
C v192,v148,v149
M v[36:39],a[220:223],v[176:179],v[36:39]
T a[160:161],v225,0
D v240,s[20:23],0
M v[36:39],a[216:219],v[168:171],v[36:39]
s_add_u32 m0,s45,81920
E v150
M v[68:71],a[216:219],a[196:199],v[68:71]
s_add_u32 s3,s68,131072
E v151
M v[68:71],a[220:223],a[200:203],v[68:71]
s_add_u32 s12,s3,s51
T a[162:163],v225,4096
C v193,v150,v151
M v[16:19],a[224:227],v[164:167],v[16:19]
v_permlane16_swap_b32 v105,v107
M v[16:19],a[228:231],v[172:175],v[16:19]
T a[164:165],v225,8192
v_accvgpr_write_b32 a113,v105
M v[48:51],a[228:231],v[176:179],v[48:51]
T a[166:167],v225,12288
v_accvgpr_write_b32 a115,v107
M v[48:51],a[224:227],v[168:171],v[48:51]
R a[168:171],v214,0
M v[152:155],a[232:235],a[48:51],v[196:199]
R a[172:175],v215,0
M v[152:155],a[236:239],a[52:55],v[152:155]
R a[176:179],v216,0
M v[152:155],a[240:243],a[56:59],v[152:155]
R a[180:183],v217,0
M v[152:155],a[244:247],a[60:63],v[152:155]
R a[184:187],v210,0
M v[156:159],a[244:247],a[76:79],v[200:203]
R a[188:191],v211,0
M v[156:159],a[240:243],a[72:75],v[156:159]
R a[248:251],v212,0
M v[156:159],a[236:239],a[68:71],v[156:159]
R a[252:255],v213,0
M v[156:159],a[232:235],a[64:67],v[156:159]
s_waitcnt lgkmcnt(8)
E v152
M v[20:23],a[144:147],v[164:167],v[20:23]
E v153
M v[20:23],a[148:151],v[172:175],v[20:23]
T a[216:217],v220,49152
C v190,v152,v153
M v[52:55],a[148:151],v[176:179],v[52:55]
E v154
M v[52:55],a[144:147],v[168:171],v[52:55]
E v155
M v[56:59],a[152:155],v[168:171],v[56:59]
T a[218:219],v220,53248
C v191,v154,v155
M v[56:59],a[156:159],v[176:179],v[56:59]
E v156
M v[24:27],a[156:159],v[172:175],v[24:27]
E v157
M v[24:27],a[152:155],v[164:167],v[24:27]
T a[220:221],v220,57344
C v194,v156,v157
M v[28:31],a[160:163],v[164:167],v[28:31]
E v158
M v[28:31],a[164:167],v[172:175],v[28:31]
E v159
M v[60:63],a[164:167],v[176:179],v[60:63]
s_waitcnt vmcnt(13)
s_barrier
T a[222:223],v220,61440
Dn v254,s[12:15],0
C v195,v158,v159
M v[60:63],a[160:163],v[168:171],v[60:63]
T a[224:225],v221,49152
M a[212:215],a[192:195],a[196:199],a[212:215]
T a[226:227],v221,53248
M a[212:215],a[192:195],a[200:203],a[212:215]
T a[228:229],v221,57344
M a[204:207],a[192:195],v[164:167],a[204:207]
T a[230:231],v221,61440
Dn v255,s[12:15],1024
M a[204:207],a[192:195],v[172:175],a[204:207]
T a[232:233],v222,49152
M a[208:211],a[192:195],v[168:171],a[208:211]
T a[234:235],v222,53248
M a[208:211],a[192:195],v[176:179],a[208:211]
s_waitcnt lgkmcnt(7)
T a[236:237],v222,57344
M v[160:163],a[168:171],a[80:83],v[204:207]
T a[238:239],v222,61440
M v[160:163],a[172:175],a[84:87],v[160:163]
R a[240:243],v210,4096
Dn v254,s[12:15],2048
M v[160:163],a[176:179],a[88:91],v[160:163]
R a[244:247],v211,4096
M v[160:163],a[180:183],a[92:95],v[160:163]
R a[144:147],v212,4096
M v[144:147],a[184:187],a[48:51],v[196:199]
R a[148:151],v213,4096
M v[144:147],a[188:191],a[52:55],v[144:147]
T a[152:153],v223,49152
M v[144:147],a[248:251],a[56:59],v[144:147]
T a[154:155],v223,53248
Dn v255,s[12:15],3072
M v[144:147],a[252:255],a[60:63],v[144:147]
s_add_u32 m0,s45,32768
E v160
E v161
E v162
E v163
M v[148:151],a[252:255],a[76:79],v[200:203]
s_add_u32 s8,s70,131072
T a[156:157],v223,57344
C v208,v160,v161
C v209,v162,v163
M v[148:151],a[248:251],a[72:75],v[148:151]
T a[158:159],v223,61440
Dn v245,s[8:11],0
E v144
E v145
E v146
M v[148:151],a[188:191],a[68:71],v[148:151]
T a[160:161],v224,49152
E v147
C v164,v144,v145
M v[148:151],a[184:187],a[64:67],v[148:151]
T a[162:163],v224,53248
C v165,v146,v147
M v[80:83],a[216:219],a[120:123],v[80:83]
s_waitcnt lgkmcnt(4)
T a[164:165],v224,57344
Dn v246,s[8:11],1024
M v[80:83],a[220:223],a[124:127],v[80:83]
ds_write_b64 v242,v[208:209] offset:0
M v[112:115],a[220:223],a[132:135],v[112:115]
E v148
E v149
E v150
E v151
M v[112:115],a[216:219],a[128:131],v[112:115]
T a[166:167],v224,61440
Dn v245,s[8:11],2048
C v168,v148,v149
C v169,v150,v151
M v[116:119],a[224:227],a[128:131],v[116:119]
T a[168:169],v225,49152
v_mul_f32 v80,s58,v80
v_mul_f32 v81,s58,v81
v_mul_f32 v82,s58,v82
v_mul_f32 v83,s58,v83
M v[116:119],a[228:231],a[132:135],v[116:119]
T a[170:171],v225,53248
C v80,v80,v81
v_mul_f32 v112,s58,v112
v_mul_f32 v113,s58,v113
v_mul_f32 v114,s58,v114
v_mul_f32 v115,s58,v115
M v[84:87],a[228:231],a[124:127],v[84:87]
L_pg9:
s_cmp_eq_u32 s47,1
s_cbranch_scc1 L_bkT0_2
T a[172:173],v225,57344
Dn v246,s[8:11],3072
C v81,v82,v83
C v112,v112,v113
M v[84:87],a[224:227],a[120:123],v[84:87]
s_add_u32 m0,s45,131072
T a[174:175],v225,61440
v_mul_f32 v116,s58,v116
v_mul_f32 v117,s58,v117
v_mul_f32 v118,s58,v118
v_mul_f32 v119,s58,v119
C v113,v114,v115
M v[88:91],a[232:235],a[120:123],v[88:91]
s_add_u32 s16,s37,768
T a[176:177],v220,16384
C v114,v116,v117
C v115,v118,v119
M v[88:91],a[236:239],a[124:127],v[88:91]
T a[178:179],v220,20480
v_mul_f32 v84,s58,v84
v_mul_f32 v85,s58,v85
v_mul_f32 v86,s58,v86
v_mul_f32 v87,s58,v87
v_permlane16_swap_b32 v112,v114
M v[120:123],a[236:239],a[132:135],v[120:123]
T a[180:181],v220,24576
C v82,v84,v85
C v83,v86,v87
v_permlane16_swap_b32 v113,v115
v_accvgpr_write_b32 a116,v112
v_accvgpr_write_b32 a118,v114
M v[120:123],a[232:235],a[128:131],v[120:123]
T a[182:183],v220,28672
v_permlane16_swap_b32 v80,v82
v_permlane16_swap_b32 v81,v83
v_accvgpr_write_b32 a117,v113
v_accvgpr_write_b32 a119,v115
v_mul_f32 v88,s58,v88
M v[152:155],a[240:243],a[48:51],v[196:199]
R a[184:187],v210,8192
v_accvgpr_write_b32 a100,v80
v_accvgpr_write_b32 a101,v81
v_accvgpr_write_b32 a102,v82
v_accvgpr_write_b32 a103,v83
v_mul_f32 v89,s58,v89
v_mul_f32 v90,s58,v90
v_mul_f32 v91,s58,v91
M v[152:155],a[244:247],a[52:55],v[152:155]
R a[188:191],v211,8192
C v88,v88,v89
v_mul_f32 v120,s58,v120
v_mul_f32 v121,s58,v121
v_mul_f32 v122,s58,v122
v_mul_f32 v123,s58,v123
M v[152:155],a[144:147],a[56:59],v[152:155]
R a[196:199],v243,2048
C v89,v90,v91
C v120,v120,v121
M v[152:155],a[148:151],a[60:63],v[152:155]
R a[200:203],v243,3072
C v121,v122,v123
M v[156:159],a[148:151],a[76:79],v[200:203]
R a[248:251],v212,8192
M v[156:159],a[144:147],a[72:75],v[156:159]
R a[252:255],v213,8192
M v[156:159],a[244:247],a[68:71],v[156:159]
T a[216:217],v221,16384
M v[156:159],a[240:243],a[64:67],v[156:159]
E v152
E v153
E v154
E v155
M v[92:95],a[152:155],a[120:123],v[92:95]
s_waitcnt lgkmcnt(5)
T a[218:219],v221,20480
C v166,v152,v153
C v167,v154,v155
M v[92:95],a[156:159],a[124:127],v[92:95]
E v156
E v157
E v158
E v159
M v[124:127],a[156:159],a[132:135],v[124:127]
T a[220:221],v221,24576
C v170,v156,v157
C v171,v158,v159
M v[124:127],a[152:155],a[128:131],v[124:127]
T a[222:223],v221,28672
v_mul_f32 v92,s58,v92
v_mul_f32 v93,s58,v93
v_mul_f32 v94,s58,v94
v_mul_f32 v95,s58,v95
M v[128:131],a[160:163],a[128:131],v[128:131]
T a[224:225],v218,16384
C v90,v92,v93
C v91,v94,v95
M v[128:131],a[164:167],a[132:135],v[128:131]
T a[226:227],v218,20480
v_permlane16_swap_b32 v88,v90
v_mul_f32 v124,s58,v124
v_mul_f32 v125,s58,v125
v_mul_f32 v126,s58,v126
v_mul_f32 v127,s58,v127
M v[96:99],a[164:167],a[124:127],v[96:99]
T a[228:229],v218,24576
v_permlane16_swap_b32 v89,v91
v_accvgpr_write_b32 a104,v88
v_accvgpr_write_b32 a106,v90
C v122,v124,v125
C v123,v126,v127
M v[96:99],a[160:163],a[120:123],v[96:99]
T a[230:231],v218,28672
v_accvgpr_write_b32 a105,v89
v_accvgpr_write_b32 a107,v91
M v[100:103],a[168:171],a[120:123],v[100:103]
s_waitcnt vmcnt(4) lgkmcnt(4)
s_barrier
T a[232:233],v219,16384
v_permlane16_swap_b32 v120,v122
v_permlane16_swap_b32 v121,v123
v_mul_f32 v128,s58,v128
v_mul_f32 v129,s58,v129
v_mul_f32 v130,s58,v130
M v[100:103],a[172:175],a[124:127],v[100:103]
T a[234:235],v219,20480
v_accvgpr_write_b32 a120,v120
v_accvgpr_write_b32 a121,v121
v_accvgpr_write_b32 a122,v122
v_accvgpr_write_b32 a123,v123
v_mul_f32 v131,s58,v131
C v128,v128,v129
M v[132:135],a[172:175],a[132:135],v[132:135]
T a[236:237],v219,24576
C v129,v130,v131
M v[132:135],a[168:171],a[128:131],v[132:135]
T a[238:239],v219,28672
v_mul_f32 v96,s58,v96
M v[8:11],a[176:179],v[180:183],v[8:11]
T a[240:241],v222,16384
v_mul_f32 v97,s58,v97
M v[8:11],a[180:183],v[188:191],v[8:11]
T a[242:243],v222,20480
v_mul_f32 v98,s58,v98
M v[40:43],a[180:183],v[192:195],v[40:43]
T a[244:245],v222,24576
v_mul_f32 v132,s58,v132
M v[40:43],a[176:179],v[184:187],v[40:43]
T a[246:247],v222,28672
v_mul_f32 v133,s58,v133
M v[144:147],a[184:187],a[48:51],v[196:199]
R a[144:147],v210,12288
v_mul_f32 v134,s58,v134
M v[144:147],a[188:191],a[52:55],v[144:147]
R a[148:151],v211,12288
D v230,s[16:19],0
M v[144:147],a[248:251],a[56:59],v[144:147]
R a[152:155],v212,12288
v_mul_f32 v135,s58,v135
M v[144:147],a[252:255],a[60:63],v[144:147]
R a[156:159],v213,12288
C v130,v132,v133
M v[148:151],a[252:255],a[76:79],v[200:203]
T a[160:161],v223,16384
C v131,v134,v135
M v[148:151],a[248:251],a[72:75],v[148:151]
T a[162:163],v223,20480
v_mul_f32 v99,s58,v99
M v[148:151],a[188:191],a[68:71],v[148:151]
T a[164:165],v223,24576
D v231,s[16:19],1024
M v[148:151],a[184:187],a[64:67],v[148:151]
s_add_u32 s16,s37,129792
T a[166:167],v223,28672
v_mul_f32 v100,s58,v100
M v[12:15],a[216:219],v[180:183],v[12:15]
T a[168:169],v224,16384
v_mul_f32 v101,s58,v101
M v[12:15],a[220:223],v[188:191],v[12:15]
T a[170:171],v224,20480
v_mul_f32 v102,s58,v102
M v[44:47],a[220:223],v[192:195],v[44:47]
T a[172:173],v224,24576
v_mul_f32 v103,s58,v103
M v[44:47],a[216:219],v[184:187],v[44:47]
s_waitcnt lgkmcnt(8)
T a[174:175],v224,28672
D v230,s[16:19],2048
M v[32:35],a[224:227],v[184:187],v[32:35]
T a[176:177],v225,16384
C v96,v96,v97
M v[32:35],a[228:231],v[192:195],v[32:35]
T a[178:179],v225,20480
C v97,v98,v99
M v[0:3],a[228:231],v[188:191],v[0:3]
T a[180:181],v225,24576
C v98,v100,v101
M v[0:3],a[224:227],v[180:183],v[0:3]
T a[182:183],v225,28672
C v99,v102,v103
M v[64:67],a[224:227],a[196:199],v[64:67]
R a[36:39],v214,16384
D v231,s[16:19],3072
M v[64:67],a[228:231],a[200:203],v[64:67]
s_add_u32 m0,s45,98304
E v144
M v[4:7],a[232:235],v[180:183],v[4:7]
s_add_u32 s3,s69,131072
E v145
M v[4:7],a[236:239],v[188:191],v[4:7]
s_add_u32 s12,s3,s51
R a[40:43],v215,16384
C v172,v144,v145
M v[36:39],a[236:239],v[192:195],v[36:39]
E v146
M v[36:39],a[232:235],v[184:187],v[36:39]
E v147
M v[68:71],a[232:235],a[196:199],v[68:71]
R a[44:47],v216,16384
C v173,v146,v147
M v[68:71],a[236:239],a[200:203],v[68:71]
E v148
M v[16:19],a[240:243],v[180:183],v[16:19]
E v149
M v[16:19],a[244:247],v[188:191],v[16:19]
R v[232:235],v217,16384
C v176,v148,v149
M v[48:51],a[244:247],v[192:195],v[48:51]
E v150
M v[48:51],a[240:243],v[184:187],v[48:51]
E v151
M v[152:155],a[144:147],a[48:51],v[196:199]
R a[248:251],v210,16384
C v177,v150,v151
M v[152:155],a[148:151],a[52:55],v[152:155]
v_permlane16_swap_b32 v128,v130
M v[152:155],a[152:155],a[56:59],v[152:155]
s_waitcnt lgkmcnt(3)
R a[252:255],v211,16384
v_accvgpr_write_b32 a124,v128
M v[152:155],a[156:159],a[60:63],v[152:155]
R a[216:219],v212,16384
v_accvgpr_write_b32 a126,v130
M v[156:159],a[156:159],a[76:79],v[200:203]
v_permlane16_swap_b32 v129,v131
M v[156:159],a[152:155],a[72:75],v[156:159]
R a[220:223],v213,16384
v_accvgpr_write_b32 a125,v129
M v[156:159],a[148:151],a[68:71],v[156:159]
T a[224:225],v218,32768
v_accvgpr_write_b32 a127,v131
M v[156:159],a[144:147],a[64:67],v[156:159]
E v152
M v[20:23],a[160:163],v[180:183],v[20:23]
E v153
M v[20:23],a[164:167],v[188:191],v[20:23]
R a[144:147],v226,16384
C v174,v152,v153
M v[52:55],a[164:167],v[192:195],v[52:55]
E v154
M v[52:55],a[160:163],v[184:187],v[52:55]
E v155
M v[56:59],a[168:171],v[184:187],v[56:59]
T a[226:227],v218,36864
C v175,v154,v155
M v[56:59],a[172:175],v[192:195],v[56:59]
E v156
M v[24:27],a[172:175],v[188:191],v[24:27]
E v157
M v[24:27],a[168:171],v[180:183],v[24:27]
R a[148:151],v227,16384
C v178,v156,v157
M v[28:31],a[176:179],v[180:183],v[28:31]
E v158
M v[28:31],a[180:183],v[188:191],v[28:31]
E v159
M v[60:63],a[180:183],v[192:195],v[60:63]
s_barrier
T a[228:229],v218,40960
Dn v254,s[12:15],0
C v179,v158,v159
v_permlane16_swap_b32 v96,v98
v_permlane16_swap_b32 v97,v99
M v[60:63],a[176:179],v[184:187],v[60:63]
T a[230:231],v218,45056
v_accvgpr_write_b32 a108,v96
v_accvgpr_write_b32 a109,v97
v_accvgpr_write_b32 a110,v98
v_accvgpr_write_b32 a111,v99
M a[212:215],a[192:195],a[196:199],a[212:215]
R a[156:159],v227,18432
M a[212:215],a[192:195],a[200:203],a[212:215]
R a[152:155],v226,18432
Dn v255,s[12:15],1024
M a[204:207],a[192:195],v[180:183],a[204:207]
R a[160:163],v228,0
M a[204:207],a[192:195],v[188:191],a[204:207]
R a[164:167],v229,0
M a[208:211],a[192:195],v[184:187],a[208:211]
T a[232:233],v219,32768
M a[208:211],a[192:195],v[192:195],a[208:211]
T a[234:235],v219,36864
M v[160:163],a[36:39],a[80:83],v[204:207]
T a[236:237],v219,40960
Dn v254,s[12:15],2048
M v[160:163],a[40:43],a[84:87],v[160:163]
s_waitcnt lgkmcnt(7)
T a[238:239],v219,45056
M v[160:163],a[44:47],a[88:91],v[160:163]
R a[240:243],v210,20480
M v[160:163],v[232:235],a[92:95],v[160:163]
R a[244:247],v211,20480
M v[144:147],a[248:251],a[48:51],v[196:199]
R a[36:39],v212,20480
M v[144:147],a[252:255],a[52:55],v[144:147]
R a[40:43],v213,20480
Dn v255,s[12:15],3072
M v[144:147],a[216:219],a[56:59],v[144:147]
s_add_u32 m0,s45,0
T a[44:45],v220,32768
M v[144:147],a[220:223],a[60:63],v[144:147]
s_add_u32 s8,s71,131072
E v160
E v161
E v162
E v163
M v[148:151],a[220:223],a[76:79],v[200:203]
T a[46:47],v220,36864
Dn v245,s[8:11],0
C v208,v160,v161
C v209,v162,v163
M v[148:151],a[216:219],a[72:75],v[148:151]
E v144
E v145
E v146
E v147
M v[148:151],a[252:255],a[68:71],v[148:151]
T v[232:233],v220,40960
C v180,v144,v145
C v181,v146,v147
M v[148:151],a[248:251],a[64:67],v[148:151]
T v[234:235],v220,45056
Dn v246,s[8:11],1024
M v[72:75],a[224:227],a[144:147],0
ds_write_b64 v242,v[208:209] offset:2048
M v[72:75],a[228:231],a[148:151],v[72:75]
s_waitcnt lgkmcnt(4)
T a[248:249],v221,32768
M v[104:107],a[228:231],a[156:159],0
E v148
E v149
E v150
E v151
M v[104:107],a[224:227],a[152:155],v[104:107]
T a[250:251],v221,36864
Dn v245,s[8:11],2048
C v184,v148,v149
C v185,v150,v151
M v[136:139],a[224:227],a[160:163],0
T a[252:253],v221,40960
M v[136:139],a[228:231],a[164:167],v[136:139]
T a[254:255],v221,45056
M v[76:79],a[232:235],a[144:147],0
T a[216:217],v222,32768
M v[76:79],a[236:239],a[148:151],v[76:79]
T a[218:219],v222,36864
Dn v246,s[8:11],3072
M v[108:111],a[236:239],a[156:159],0
s_add_u32 m0,s45,49152
T a[220:221],v222,40960
M v[108:111],a[232:235],a[152:155],v[108:111]
s_add_u32 s20,s94,0
T a[222:223],v222,45056
M v[140:143],a[232:235],a[160:163],0
T a[224:225],v220,0
M v[140:143],a[236:239],a[164:167],v[140:143]
T a[226:227],v220,4096
M v[152:155],a[240:243],a[48:51],v[196:199]
T a[228:229],v220,8192
D v247,s[20:23],0
M v[152:155],a[244:247],a[52:55],v[152:155]
s_add_u32 s20,s94,7168
T a[230:231],v220,12288
M v[152:155],a[36:39],a[56:59],v[152:155]
R a[232:235],v210,24576
M v[152:155],a[40:43],a[60:63],v[152:155]
R a[236:239],v211,24576
M v[156:159],a[40:43],a[76:79],v[200:203]
R a[128:131],v244,0
M v[156:159],a[36:39],a[72:75],v[156:159]
R a[132:135],v251,0
D v247,s[20:23],1024
M v[156:159],a[244:247],a[68:71],v[156:159]
s_add_u32 s20,s94,14336
R a[136:139],v252,0
M v[156:159],a[240:243],a[64:67],v[156:159]
s_waitcnt lgkmcnt(8)
R a[140:143],v253,0
E v152
E v153
E v154
M v[80:83],a[44:47],a[144:147],0
R a[196:199],v243,0
D v247,s[20:23],2048
E v155
C v182,v152,v153
M v[80:83],v[232:235],a[148:151],v[80:83]
s_add_u32 s20,s94,21504
R a[200:203],v243,1024
R a[240:243],v212,24576
C v183,v154,v155
E v156
E v157
M v[112:115],v[232:235],a[156:159],0
R a[244:247],v213,24576
E v158
E v159
C v186,v156,v157
M v[112:115],a[44:47],a[152:155],v[112:115]
T a[36:37],v221,0
D v247,s[20:23],3072
C v187,v158,v159
M v[116:119],a[248:251],a[152:155],0
s_add_u32 m0,s45,81920
T a[38:39],v221,4096
M v[116:119],a[252:255],a[156:159],v[116:119]
s_add_u32 s3,s70,131072
T a[40:41],v221,8192
M v[84:87],a[252:255],a[148:151],0
s_add_u32 s12,s3,s51
T a[42:43],v221,12288
M v[84:87],a[248:251],a[144:147],v[84:87]
T a[44:45],v218,0
M v[88:91],a[216:219],a[144:147],0
s_waitcnt vmcnt(8) lgkmcnt(6)
s_barrier
T a[46:47],v218,4096
M v[88:91],a[220:223],a[148:151],v[88:91]
T v[232:233],v218,8192
M v[120:123],a[220:223],a[156:159],0
T v[234:235],v218,12288
M v[120:123],a[216:219],a[152:155],v[120:123]
T a[248:249],v219,0
M v[8:11],a[224:227],v[164:167],v[8:11]
T a[250:251],v219,4096
M v[8:11],a[228:231],v[172:175],v[8:11]
T a[252:253],v219,8192
M v[40:43],a[228:231],v[176:179],v[40:43]
T a[254:255],v219,12288
M v[40:43],a[224:227],v[168:171],v[40:43]
T a[216:217],v222,0
M v[144:147],a[232:235],a[48:51],v[196:199]
T a[218:219],v222,4096
M v[144:147],a[236:239],a[52:55],v[144:147]
T a[220:221],v222,8192
M v[144:147],a[240:243],a[56:59],v[144:147]
s_waitcnt lgkmcnt(8)
T a[222:223],v222,12288
M v[144:147],a[244:247],a[60:63],v[144:147]
R a[224:227],v210,28672
M v[148:151],a[244:247],a[76:79],v[200:203]
R a[228:231],v211,28672
M v[148:151],a[240:243],a[72:75],v[148:151]
T a[240:241],v223,0
M v[148:151],a[236:239],a[68:71],v[148:151]
R a[236:239],v213,28672
M v[148:151],a[232:235],a[64:67],v[148:151]
E v144
E v145
E v146
E v147
M v[12:15],a[36:39],v[164:167],v[12:15]
R a[232:235],v212,28672
C v188,v144,v145
C v189,v146,v147
M v[12:15],a[40:43],v[172:175],v[12:15]
E v148
E v149
E v150
M v[44:47],a[40:43],v[176:179],v[44:47]
T a[242:243],v223,4096
C v192,v148,v149
M v[44:47],a[36:39],v[168:171],v[44:47]
E v151
M v[32:35],a[44:47],v[168:171],v[32:35]
s_waitcnt lgkmcnt(2)
T a[244:245],v223,8192
C v193,v150,v151
M v[32:35],v[232:235],v[176:179],v[32:35]
T a[246:247],v223,12288
M v[0:3],v[232:235],v[172:175],v[0:3]
T a[36:37],v224,0
M v[0:3],a[44:47],v[164:167],v[0:3]
T a[38:39],v224,4096
M v[64:67],a[44:47],a[196:199],v[64:67]
T a[40:41],v224,8192
M v[64:67],v[232:235],a[200:203],v[64:67]
T a[42:43],v224,12288
M v[4:7],a[248:251],v[164:167],v[4:7]
T a[44:45],v225,0
M v[4:7],a[252:255],v[172:175],v[4:7]
T a[46:47],v225,4096
M v[36:39],a[252:255],v[176:179],v[36:39]
T v[232:233],v225,8192
M v[36:39],a[248:251],v[168:171],v[36:39]
T v[234:235],v225,12288
M v[68:71],a[248:251],a[196:199],v[68:71]
R a[248:251],v214,32768
M v[68:71],a[252:255],a[200:203],v[68:71]
R a[252:255],v215,32768
M v[16:19],a[216:219],v[164:167],v[16:19]
R a[168:171],v226,32768
M v[16:19],a[220:223],v[172:175],v[16:19]
R a[172:175],v227,32768
M v[48:51],a[220:223],v[176:179],v[48:51]
R a[220:223],v217,32768
M v[48:51],a[216:219],v[168:171],v[48:51]
R a[216:219],v216,32768
M v[152:155],a[224:227],a[48:51],v[196:199]
R a[180:183],v227,34816
M v[152:155],a[228:231],a[52:55],v[152:155]
s_waitcnt lgkmcnt(8)
R a[176:179],v226,34816
M v[152:155],a[232:235],a[56:59],v[152:155]
R a[184:187],v228,2048
M v[152:155],a[236:239],a[60:63],v[152:155]
R a[188:191],v229,2048
M v[156:159],a[236:239],a[76:79],v[200:203]
R a[236:239],v213,32768
M v[156:159],a[232:235],a[72:75],v[156:159]
R a[232:235],v212,32768
M v[156:159],a[228:231],a[68:71],v[156:159]
R a[228:231],v211,32768
M v[156:159],a[224:227],a[64:67],v[156:159]
E v152
M v[20:23],a[240:243],v[164:167],v[20:23]
E v153
M v[20:23],a[244:247],v[172:175],v[20:23]
R a[224:227],v210,32768
C v190,v152,v153
M v[52:55],a[244:247],v[176:179],v[52:55]
E v154
M v[52:55],a[240:243],v[168:171],v[52:55]
E v155
M v[56:59],a[36:39],v[168:171],v[56:59]
T a[240:241],v223,32768
C v191,v154,v155
M v[56:59],a[40:43],v[176:179],v[56:59]
E v156
M v[24:27],a[40:43],v[172:175],v[24:27]
E v157
M v[24:27],a[36:39],v[164:167],v[24:27]
T a[242:243],v223,36864
C v194,v156,v157
M v[28:31],a[44:47],v[164:167],v[28:31]
s_waitcnt lgkmcnt(3)
E v158
M v[28:31],v[232:235],v[172:175],v[28:31]
E v159
M v[60:63],v[232:235],v[176:179],v[60:63]
s_barrier
T a[244:245],v223,40960
Dn v254,s[12:15],0
C v195,v158,v159
M v[60:63],a[44:47],v[168:171],v[60:63]
T a[246:247],v223,45056
M a[212:215],a[192:195],a[196:199],a[212:215]
T a[36:37],v224,32768
M a[212:215],a[192:195],a[200:203],a[212:215]
T a[38:39],v224,36864
M a[204:207],a[192:195],v[164:167],a[204:207]
T a[40:41],v224,40960
Dn v255,s[12:15],1024
M a[204:207],a[192:195],v[172:175],a[204:207]
T a[42:43],v224,45056
M a[208:211],a[192:195],v[168:171],a[208:211]
T a[44:45],v225,32768
M a[208:211],a[192:195],v[176:179],a[208:211]
L_pg10:
s_cmp_eq_u32 s47,1
s_cbranch_scc1 L_bkT0_2
T a[46:47],v225,36864
M v[160:163],a[248:251],a[80:83],v[204:207]
T v[232:233],v225,40960
M v[160:163],a[252:255],a[84:87],v[160:163]
T v[234:235],v225,45056
Dn v254,s[12:15],2048
M v[160:163],a[216:219],a[88:91],v[160:163]
R a[248:251],v210,36864
M v[160:163],a[220:223],a[92:95],v[160:163]
s_waitcnt lgkmcnt(8)
R a[252:255],v211,36864
M v[144:147],a[224:227],a[48:51],v[196:199]
R a[216:219],v212,36864
M v[144:147],a[228:231],a[52:55],v[144:147]
R a[220:223],v213,36864
M v[144:147],a[232:235],a[56:59],v[144:147]
R a[196:199],v243,2048
Dn v255,s[12:15],3072
M v[144:147],a[236:239],a[60:63],v[144:147]
s_add_u32 m0,s45,16384
E v160
E v161
E v162
E v163
M v[148:151],a[236:239],a[76:79],v[200:203]
s_add_u32 s8,s64,262144
T a[236:237],v219,57344
C v208,v160,v161
C v209,v162,v163
M v[148:151],a[232:235],a[72:75],v[148:151]
T a[232:233],v219,49152
Dn v245,s[8:11],0
E v144
E v145
E v146
M v[148:151],a[228:231],a[68:71],v[148:151]
T a[228:229],v218,57344
E v147
C v164,v144,v145
M v[148:151],a[224:227],a[64:67],v[148:151]
T a[224:225],v218,49152
C v165,v146,v147
M v[92:95],a[240:243],a[144:147],0
T a[226:227],v218,53248
Dn v246,s[8:11],1024
M v[92:95],a[244:247],a[148:151],v[92:95]
ds_write_b64 v242,v[208:209] offset:0
M v[124:127],a[244:247],a[156:159],0
E v148
E v149
E v150
E v151
M v[124:127],a[240:243],a[152:155],v[124:127]
s_waitcnt lgkmcnt(4)
T a[230:231],v218,61440
Dn v245,s[8:11],2048
C v168,v148,v149
C v169,v150,v151
M v[128:131],a[36:39],a[152:155],0
T a[234:235],v219,53248
M v[128:131],a[40:43],a[156:159],v[128:131]
T a[238:239],v219,61440
M v[96:99],a[40:43],a[148:151],0
T a[240:241],v220,16384
M v[96:99],a[36:39],a[144:147],v[96:99]
T a[242:243],v220,20480
Dn v246,s[8:11],3072
M v[100:103],a[44:47],a[144:147],0
s_add_u32 m0,s45,65536
T a[244:245],v220,24576
M v[100:103],v[232:235],a[148:151],v[100:103]
s_add_u32 s20,s95,0
T a[246:247],v220,28672
M v[132:135],v[232:235],a[156:159],0
R a[36:39],v210,40960
M v[132:135],a[44:47],a[152:155],v[132:135]
R a[40:43],v211,40960
M v[152:155],a[248:251],a[48:51],v[196:199]
R a[200:203],v243,3072
D v247,s[20:23],0
M v[152:155],a[252:255],a[52:55],v[152:155]
s_add_u32 s20,s95,7168
R a[44:47],v212,40960
M v[152:155],a[216:219],a[56:59],v[152:155]
R v[232:235],v213,40960
M v[152:155],a[220:223],a[60:63],v[152:155]
M v[156:159],a[220:223],a[76:79],v[200:203]
T a[220:221],v218,24576
M v[156:159],a[216:219],a[72:75],v[156:159]
T a[216:217],v218,16384
D v247,s[20:23],1024
M v[156:159],a[252:255],a[68:71],v[156:159]
s_add_u32 s20,s95,14336
T a[252:253],v221,24576
M v[156:159],a[248:251],a[64:67],v[156:159]
s_waitcnt lgkmcnt(7)
E v152
E v153
E v154
E v155
M v[72:75],a[224:227],a[168:171],v[72:75]
T a[248:249],v221,16384
D v247,s[20:23],2048
C v166,v152,v153
C v167,v154,v155
M v[72:75],a[228:231],a[172:175],v[72:75]
s_add_u32 s20,s95,21504
E v156
E v157
E v158
E v159
M v[104:107],a[228:231],a[180:183],v[104:107]
T a[250:251],v221,20480
C v170,v156,v157
C v171,v158,v159
M v[104:107],a[224:227],a[176:179],v[104:107]
T a[254:255],v221,28672
D v247,s[20:23],3072
M v[136:139],a[224:227],a[184:187],v[136:139]
s_add_u32 m0,s45,114688
T a[218:219],v218,20480
M v[136:139],a[228:231],a[188:191],v[136:139]
s_add_u32 s16,s38,768
T a[222:223],v218,28672
M v[76:79],a[232:235],a[168:171],v[76:79]
T a[224:225],v219,16384
M v[76:79],a[236:239],a[172:175],v[76:79]
T a[226:227],v219,20480
M v[108:111],a[236:239],a[180:183],v[108:111]
s_mov_b32 s47,1
s_cmp_eq_u32 s44,0
s_cbranch_scc1 L_pg12
s_cmp_eq_u32 s44,1
s_cbranch_scc1 L_pg13
s_cmp_eq_u32 s44,2
s_cbranch_scc1 L_pg14
s_cmp_eq_u32 s44,3
s_cbranch_scc1 L_pg15
L_bkB14_0:
s_mov_b32 s47,0
s_waitcnt vmcnt(8) lgkmcnt(6)
s_barrier
T a[228:229],v219,24576
M v[108:111],a[232:235],a[176:179],v[108:111]
T a[230:231],v219,28672
M v[140:143],a[232:235],a[184:187],v[140:143]
T a[232:233],v222,16384
M v[140:143],a[236:239],a[188:191],v[140:143]
T a[234:235],v222,20480
M v[8:11],a[240:243],v[180:183],v[8:11]
T a[236:237],v222,24576
M v[8:11],a[244:247],v[188:191],v[8:11]
T a[238:239],v222,28672
M v[40:43],a[244:247],v[192:195],v[40:43]
R a[244:247],v211,45056
M v[40:43],a[240:243],v[184:187],v[40:43]
R a[240:243],v210,45056
M v[144:147],a[36:39],a[48:51],v[196:199]
M v[144:147],a[40:43],a[52:55],v[144:147]
M v[144:147],a[44:47],a[56:59],v[144:147]
M v[144:147],v[232:235],a[60:63],v[144:147]
M v[148:151],v[232:235],a[76:79],v[200:203]
T v[232:233],v223,24576
D v230,s[16:19],0
M v[148:151],a[44:47],a[72:75],v[148:151]
T a[44:45],v223,16384
M v[148:151],a[40:43],a[68:71],v[148:151]
R a[40:43],v213,45056
M v[148:151],a[36:39],a[64:67],v[148:151]
s_waitcnt lgkmcnt(4)
E v144
E v145
E v146
E v147
M v[12:15],a[248:251],v[180:183],v[12:15]
R a[36:39],v212,45056
D v231,s[16:19],1024
C v172,v144,v145
C v173,v146,v147
M v[12:15],a[252:255],v[188:191],v[12:15]
s_add_u32 s16,s38,129792
E v148
E v149
E v150
M v[44:47],a[252:255],v[192:195],v[44:47]
T a[46:47],v223,20480
C v176,v148,v149
M v[44:47],a[248:251],v[184:187],v[44:47]
T v[234:235],v223,28672
D v230,s[16:19],2048
M v[32:35],a[216:219],v[184:187],v[32:35]
E v151
M v[32:35],a[220:223],v[192:195],v[32:35]
T a[248:249],v224,16384
C v177,v150,v151
M v[0:3],a[220:223],v[188:191],v[0:3]
T a[250:251],v224,20480
M v[0:3],a[216:219],v[180:183],v[0:3]
T a[252:253],v224,24576
M v[64:67],a[216:219],a[196:199],v[64:67]
T a[254:255],v224,28672
D v231,s[16:19],3072
M v[64:67],a[220:223],a[200:203],v[64:67]
s_add_u32 m0,s46,151552
T a[216:217],v225,16384
M v[4:7],a[224:227],v[180:183],v[4:7]
s_and_b32 s20,s96,0xffffff7f
T a[218:219],v225,20480
M v[4:7],a[228:231],v[188:191],v[4:7]
T a[220:221],v225,24576
M v[36:39],a[228:231],v[192:195],v[36:39]
T a[222:223],v225,28672
M v[36:39],a[224:227],v[184:187],v[36:39]
D v240,s[20:23],0
M v[68:71],a[224:227],a[196:199],v[68:71]
s_add_u32 m0,s45,98304
R a[224:227],v214,0
M v[68:71],a[228:231],a[200:203],v[68:71]
s_add_u32 s3,s71,131072
R a[228:231],v215,0
M v[16:19],a[232:235],v[180:183],v[16:19]
s_add_u32 s12,s3,s51
M v[16:19],a[236:239],v[188:191],v[16:19]
M v[48:51],a[236:239],v[192:195],v[48:51]
R a[236:239],v217,0
M v[48:51],a[232:235],v[184:187],v[48:51]
s_waitcnt lgkmcnt(5)
R a[232:235],v216,0
M v[152:155],a[240:243],a[48:51],v[196:199]
M v[152:155],a[244:247],a[52:55],v[152:155]
M v[152:155],a[36:39],a[56:59],v[152:155]
M v[152:155],a[40:43],a[60:63],v[152:155]
M v[156:159],a[40:43],a[76:79],v[200:203]
R a[40:43],v213,0
M v[156:159],a[36:39],a[72:75],v[156:159]
R a[36:39],v212,0
M v[156:159],a[244:247],a[68:71],v[156:159]
R a[244:247],v211,0
M v[156:159],a[240:243],a[64:67],v[156:159]
R a[240:243],v210,0
M v[20:23],a[44:47],v[180:183],v[20:23]
E v152
M v[20:23],v[232:235],v[188:191],v[20:23]
E v153
M v[52:55],v[232:235],v[192:195],v[52:55]
T v[232:233],v220,57344
C v174,v152,v153
M v[52:55],a[44:47],v[184:187],v[52:55]
E v154
M v[56:59],a[248:251],v[184:187],v[56:59]
E v155
M v[56:59],a[252:255],v[192:195],v[56:59]
T a[44:45],v220,49152
C v175,v154,v155
M v[24:27],a[252:255],v[188:191],v[24:27]
E v156
M v[24:27],a[248:251],v[180:183],v[24:27]
E v157
M v[28:31],a[216:219],v[180:183],v[28:31]
s_waitcnt lgkmcnt(2)
T a[46:47],v220,53248
C v178,v156,v157
M v[28:31],a[220:223],v[188:191],v[28:31]
E v158
M v[60:63],a[220:223],v[192:195],v[60:63]
s_barrier
T v[234:235],v220,61440
Dn v254,s[12:15],0
E v159
M v[60:63],a[216:219],v[184:187],v[60:63]
T a[248:249],v221,49152
C v179,v158,v159
M a[212:215],a[192:195],a[196:199],a[212:215]
T a[250:251],v221,53248
M a[212:215],a[192:195],a[200:203],a[212:215]
T a[252:253],v221,57344
M a[204:207],a[192:195],v[180:183],a[204:207]
T a[254:255],v221,61440
Dn v255,s[12:15],1024
M a[204:207],a[192:195],v[188:191],a[204:207]
T a[216:217],v222,49152
M a[208:211],a[192:195],v[184:187],a[208:211]
T a[218:219],v222,53248
M a[208:211],a[192:195],v[192:195],a[208:211]
T a[220:221],v222,57344
M v[160:163],a[224:227],a[80:83],v[204:207]
T a[222:223],v222,61440
M v[160:163],a[228:231],a[84:87],v[160:163]
R a[224:227],v210,4096
Dn v254,s[12:15],2048
M v[160:163],a[232:235],a[88:91],v[160:163]
R a[228:231],v211,4096
M v[160:163],a[236:239],a[92:95],v[160:163]
R a[232:235],v212,4096
M v[144:147],a[240:243],a[48:51],v[196:199]
R a[236:239],v213,4096
M v[144:147],a[244:247],a[52:55],v[144:147]
R a[196:199],v243,0
M v[144:147],a[36:39],a[56:59],v[144:147]
R a[200:203],v243,1024
Dn v255,s[12:15],3072
M v[144:147],a[40:43],a[60:63],v[144:147]
s_add_u32 m0,s45,32768
E v160
E v161
E v162
E v163
M v[148:151],a[40:43],a[76:79],v[200:203]
s_add_u32 s8,s65,262144
T a[40:41],v224,57344
C v208,v160,v161
C v209,v162,v163
M v[148:151],a[36:39],a[72:75],v[148:151]
T a[36:37],v224,49152
Dn v245,s[8:11],0
E v144
E v145
E v146
M v[148:151],a[244:247],a[68:71],v[148:151]
T a[244:245],v223,57344
E v147
C v180,v144,v145
M v[148:151],a[240:243],a[64:67],v[148:151]
s_waitcnt lgkmcnt(3)
T a[240:241],v223,49152
C v181,v146,v147
M v[80:83],a[44:47],a[168:171],v[80:83]
T a[242:243],v223,53248
Dn v246,s[8:11],1024
M v[80:83],v[232:235],a[172:175],v[80:83]
ds_write_b64 v242,v[208:209] offset:2048
M v[112:115],v[232:235],a[180:183],v[112:115]
E v148
E v149
E v150
E v151
M v[112:115],a[44:47],a[176:179],v[112:115]
T a[246:247],v223,61440
Dn v245,s[8:11],2048
C v184,v148,v149
C v185,v150,v151
M v[116:119],a[248:251],a[176:179],v[116:119]
T a[38:39],v224,53248
M v[116:119],a[252:255],a[180:183],v[116:119]
T a[42:43],v224,61440
M v[84:87],a[252:255],a[172:175],v[84:87]
T a[44:45],v225,49152
M v[84:87],a[248:251],a[168:171],v[84:87]
T a[46:47],v225,53248
Dn v246,s[8:11],3072
M v[88:91],a[216:219],a[168:171],v[88:91]
s_add_u32 m0,s45,131072
T v[232:233],v225,57344
M v[88:91],a[220:223],a[172:175],v[88:91]
s_add_u32 s16,s39,768
T v[234:235],v225,61440
M v[120:123],a[220:223],a[180:183],v[120:123]
T a[248:249],v220,0
M v[120:123],a[216:219],a[176:179],v[120:123]
T a[250:251],v220,4096
M v[152:155],a[224:227],a[48:51],v[196:199]
T a[252:253],v220,8192
M v[152:155],a[228:231],a[52:55],v[152:155]
T a[254:255],v220,12288
M v[152:155],a[232:235],a[56:59],v[152:155]
R a[216:219],v210,8192
M v[152:155],a[236:239],a[60:63],v[152:155]
R a[220:223],v211,8192
M v[156:159],a[236:239],a[76:79],v[200:203]
T a[236:237],v221,8192
M v[156:159],a[232:235],a[72:75],v[156:159]
T a[232:233],v221,0
M v[156:159],a[228:231],a[68:71],v[156:159]
R a[228:231],v213,8192
M v[156:159],a[224:227],a[64:67],v[156:159]
s_waitcnt lgkmcnt(8)
E v152
E v153
E v154
E v155
M v[92:95],a[240:243],a[168:171],v[92:95]
R a[224:227],v212,8192
C v182,v152,v153
C v183,v154,v155
M v[92:95],a[244:247],a[172:175],v[92:95]
E v156
E v157
E v158
E v159
M v[124:127],a[244:247],a[180:183],v[124:127]
T a[234:235],v221,4096
C v186,v156,v157
C v187,v158,v159
M v[124:127],a[240:243],a[176:179],v[124:127]
T a[238:239],v221,12288
M v[128:131],a[36:39],a[176:179],v[128:131]
T a[240:241],v218,0
M v[128:131],a[40:43],a[180:183],v[128:131]
T a[242:243],v218,4096
M v[96:99],a[40:43],a[172:175],v[96:99]
T a[244:245],v218,8192
M v[96:99],a[36:39],a[168:171],v[96:99]
T a[246:247],v218,12288
M v[100:103],a[44:47],a[168:171],v[100:103]
s_waitcnt vmcnt(4) lgkmcnt(6)
s_barrier
T a[36:37],v219,0
M v[100:103],v[232:235],a[172:175],v[100:103]
T a[38:39],v219,4096
M v[132:135],v[232:235],a[180:183],v[132:135]
T a[40:41],v219,8192
M v[132:135],a[44:47],a[176:179],v[132:135]
T a[42:43],v219,12288
M v[8:11],a[248:251],v[164:167],v[8:11]
T a[44:45],v222,0
M v[8:11],a[252:255],v[172:175],v[8:11]
T a[46:47],v222,4096
M v[40:43],a[252:255],v[176:179],v[40:43]
T v[232:233],v222,8192
M v[40:43],a[248:251],v[168:171],v[40:43]
T v[234:235],v222,12288
M v[144:147],a[216:219],a[48:51],v[196:199]
R a[248:251],v210,12288
M v[144:147],a[220:223],a[52:55],v[144:147]
R a[252:255],v211,12288
M v[144:147],a[224:227],a[56:59],v[144:147]
R a[84:87],v210,16384
M v[144:147],a[228:231],a[60:63],v[144:147]
R a[88:91],v211,16384
M v[148:151],a[228:231],a[76:79],v[200:203]
T a[228:229],v223,8192
D v230,s[16:19],0
M v[148:151],a[224:227],a[72:75],v[148:151]
T a[224:225],v223,0
M v[148:151],a[220:223],a[68:71],v[148:151]
R a[220:223],v213,12288
M v[148:151],a[216:219],a[64:67],v[148:151]
s_waitcnt lgkmcnt(8)
E v144
E v145
E v146
E v147
M v[12:15],a[232:235],v[164:167],v[12:15]
R a[216:219],v212,12288
D v231,s[16:19],1024
C v188,v144,v145
C v189,v146,v147
M v[12:15],a[236:239],v[172:175],v[12:15]
s_add_u32 s16,s39,129792
E v148
E v149
E v150
M v[44:47],a[236:239],v[176:179],v[44:47]
T a[226:227],v223,4096
C v192,v148,v149
M v[44:47],a[232:235],v[168:171],v[44:47]
T a[230:231],v223,12288
D v230,s[16:19],2048
M v[32:35],a[240:243],v[168:171],v[32:35]
E v151
M v[32:35],a[244:247],v[176:179],v[32:35]
T a[232:233],v224,0
C v193,v150,v151
M v[0:3],a[244:247],v[172:175],v[0:3]
T a[234:235],v224,4096
M v[0:3],a[240:243],v[164:167],v[0:3]
T a[236:237],v224,8192
M v[64:67],a[240:243],a[196:199],v[64:67]
T a[238:239],v224,12288
D v231,s[16:19],3072
M v[64:67],a[244:247],a[200:203],v[64:67]
s_add_u32 m0,s45,81920
T a[240:241],v225,0
M v[4:7],a[36:39],v[164:167],v[4:7]
s_add_u32 s3,s64,262144
T a[242:243],v225,4096
M v[4:7],a[40:43],v[172:175],v[4:7]
s_add_u32 s12,s3,s51
T a[244:245],v225,8192
M v[36:39],a[40:43],v[176:179],v[36:39]
T a[246:247],v225,12288
M v[36:39],a[36:39],v[168:171],v[36:39]
R a[92:95],v212,16384
M v[68:71],a[36:39],a[196:199],v[68:71]
R a[36:39],v213,16384
M v[68:71],a[40:43],a[200:203],v[68:71]
R a[144:147],v226,16384
M v[16:19],a[44:47],v[164:167],v[16:19]
s_waitcnt lgkmcnt(8)
T a[40:41],v218,32768
M v[16:19],v[232:235],v[172:175],v[16:19]
T a[42:43],v218,36864
M v[48:51],v[232:235],v[176:179],v[48:51]
R a[148:151],v227,16384
M v[48:51],a[44:47],v[168:171],v[48:51]
T a[44:45],v218,40960
M v[152:155],a[248:251],a[48:51],v[196:199]
T a[46:47],v218,45056
M v[152:155],a[252:255],a[52:55],v[152:155]
R a[156:159],v227,18432
M v[152:155],a[216:219],a[56:59],v[152:155]
R a[152:155],v226,18432
M v[152:155],a[220:223],a[60:63],v[152:155]
R a[160:163],v228,4096
M v[156:159],a[220:223],a[76:79],v[200:203]
R a[164:167],v229,4096
M v[156:159],a[216:219],a[72:75],v[156:159]
T v[232:233],v219,32768
M v[156:159],a[252:255],a[68:71],v[156:159]
T v[234:235],v219,36864
M v[156:159],a[248:251],a[64:67],v[156:159]
E v152
M v[20:23],a[224:227],v[164:167],v[20:23]
E v153
M v[20:23],a[228:231],v[172:175],v[20:23]
T a[248:249],v219,40960
C v190,v152,v153
M v[52:55],a[228:231],v[176:179],v[52:55]
E v154
M v[52:55],a[224:227],v[168:171],v[52:55]
E v155
M v[56:59],a[232:235],v[168:171],v[56:59]
s_waitcnt lgkmcnt(4)
T a[250:251],v219,45056
C v191,v154,v155
M v[56:59],a[236:239],v[176:179],v[56:59]
E v156
M v[24:27],a[236:239],v[172:175],v[24:27]
E v157
M v[24:27],a[232:235],v[164:167],v[24:27]
T a[252:253],v220,32768
C v194,v156,v157
M v[28:31],a[240:243],v[164:167],v[28:31]
E v158
M v[28:31],a[244:247],v[172:175],v[28:31]
E v159
M v[60:63],a[244:247],v[176:179],v[60:63]
s_barrier
T a[254:255],v220,36864
Dn v254,s[12:15],0
C v195,v158,v159
M v[60:63],a[240:243],v[168:171],v[60:63]
T a[216:217],v220,40960
M a[212:215],a[192:195],a[196:199],a[212:215]
T a[218:219],v220,45056
M a[212:215],a[192:195],a[200:203],a[212:215]
R a[220:223],v214,16384
M a[204:207],a[192:195],v[164:167],a[204:207]
R a[224:227],v215,16384
Dn v255,s[12:15],1024
M a[204:207],a[192:195],v[172:175],a[204:207]
R a[228:231],v216,16384
M a[208:211],a[192:195],v[168:171],a[208:211]
R a[232:235],v217,16384
M a[208:211],a[192:195],v[176:179],a[208:211]
R a[236:239],v210,20480
M v[144:147],a[84:87],a[96:99],0
R a[240:243],v211,20480
M v[144:147],a[88:91],a[100:103],v[144:147]
R a[244:247],v212,20480
Dn v254,s[12:15],2048
M v[144:147],a[92:95],a[104:107],v[144:147]
L_pg11:
s_cmp_eq_u32 s47,1
s_cbranch_scc1 L_bkT0_2
R a[196:199],v243,2048
M v[144:147],a[36:39],a[108:111],v[144:147]
R a[200:203],v243,3072
M v[148:151],a[36:39],a[124:127],0
M v[148:151],a[92:95],a[120:123],v[148:151]
M v[148:151],a[88:91],a[116:119],v[148:151]
Dn v255,s[12:15],3072
M v[148:151],a[84:87],a[112:115],v[148:151]
s_add_u32 m0,s45,0
M v[160:163],a[84:87],a[128:131],0
s_add_u32 s8,s66,262144
v_max3_f32 v196,v144,v145,v146
M v[160:163],a[88:91],a[132:135],v[160:163]
v_max_f32 v196,v196,v147
M v[160:163],a[92:95],a[136:139],v[160:163]
Dn v245,s[8:11],0
M v[160:163],a[36:39],a[140:143],v[160:163]
v_max3_f32 v200,v148,v149,v150
M v[72:75],a[40:43],a[144:147],v[72:75]
v_max_f32 v200,v200,v151
M v[72:75],a[44:47],a[148:151],v[72:75]
M v[104:107],a[44:47],a[156:159],v[104:107]
Dn v246,s[8:11],1024
M v[104:107],a[40:43],a[152:155],v[104:107]
M v[136:139],a[40:43],a[160:163],v[136:139]
s_waitcnt lgkmcnt(0)
T a[40:41],v222,40960
v_max3_f32 v204,v160,v161,v162
M v[136:139],a[44:47],a[164:167],v[136:139]
T a[42:43],v222,45056
v_max_f32 v204,v204,v163
M v[76:79],v[232:235],a[144:147],v[76:79]
T a[44:45],v220,16384
Dn v245,s[8:11],2048
s_cmp_lg_u32 s59,0
s_cbranch_scc1 L_mx2
L_mr2:
M v[76:79],a[248:251],a[148:151],v[76:79]
v_mov_b32 v205,v204
v_mov_b32 v197,v196
v_mov_b32 v201,v200
M v[108:111],a[248:251],a[156:159],v[108:111]
R a[84:87],v213,20480
v_permlane16_swap_b32 v204,v205
v_permlane16_swap_b32 v196,v197
M v[108:111],v[232:235],a[152:155],v[108:111]
Dn v246,s[8:11],3072
v_max_f32 v204,v204,v205
v_max_f32 v196,v196,v197
v_permlane16_swap_b32 v200,v201
M v[140:143],v[232:235],a[160:163],v[140:143]
s_add_u32 m0,s45,49152
v_mov_b32 v205,v204
v_mov_b32 v197,v196
v_max_f32 v200,v200,v201
M v[140:143],a[248:251],a[164:167],v[140:143]
s_add_u32 s20,s96,0
T a[88:89],v221,32768
T a[90:91],v221,36864
v_permlane32_swap_b32 v204,v205
v_permlane32_swap_b32 v196,v197
v_mov_b32 v201,v200
M v[80:83],a[252:255],a[144:147],v[80:83]
D v247,s[20:23],0
v_min_f32_e64 v204,-v204,-v205
v_min_f32_e64 v196,-v196,-v197
M v[80:83],a[216:219],a[148:151],v[80:83]
s_add_u32 s20,s96,7168
v_mov_b32 v205,v204
v_mov_b32 v206,v204
v_mov_b32 v207,v204
v_mov_b32 v197,v196
v_mov_b32 v198,v196
v_mov_b32 v199,v196
v_permlane32_swap_b32 v200,v201
M v[112:115],a[216:219],a[156:159],v[112:115]
T a[92:93],v221,40960
T a[94:95],v221,45056
v_min_f32_e64 v200,-v200,-v201
v_add_f32 v144,v144,v196
v_add_f32 v145,v145,v196
v_add_f32 v146,v146,v196
v_add_f32 v147,v147,v196
M v[112:115],a[252:255],a[152:155],v[112:115]
T a[36:37],v222,32768
D v247,s[20:23],1024
v_mov_b32 v201,v200
v_mov_b32 v202,v200
v_mov_b32 v203,v200
E v144
M v[160:163],a[220:223],a[128:131],v[204:207]
s_add_u32 s20,s96,14336
T a[38:39],v222,36864
E v145
E v146
E v147
v_add_f32 v148,v148,v200
M v[160:163],a[224:227],a[132:135],v[160:163]
T a[46:47],v220,20480
D v247,s[20:23],2048
C v164,v144,v145
C v165,v146,v147
v_add_f32 v149,v149,v200
v_add_f32 v150,v150,v200
v_add_f32 v151,v151,v200
M v[160:163],a[228:231],a[136:139],v[160:163]
s_add_u32 s20,s96,21504
E v148
E v149
E v150
E v151
M v[160:163],a[232:235],a[140:143],v[160:163]
T v[232:233],v220,24576
D v247,s[20:23],3072
C v168,v148,v149
C v169,v150,v151
M v[152:155],a[236:239],a[96:99],v[196:199]
s_add_u32 m0,s45,98304
T v[234:235],v220,28672
M v[152:155],a[240:243],a[100:103],v[152:155]
s_add_u32 s3,s65,262144
E v160
E v161
E v162
E v163
M v[152:155],a[244:247],a[104:107],v[152:155]
s_waitcnt lgkmcnt(2)
R a[248:251],v210,24576
C v208,v160,v161
C v209,v162,v163
M v[152:155],a[84:87],a[108:111],v[152:155]
s_add_u32 s12,s3,s51
ds_write_b64 v242,v[208:209] offset:0
M v[156:159],a[84:87],a[124:127],v[200:203]
R a[252:255],v211,24576
M v[156:159],a[244:247],a[120:123],v[156:159]
R a[216:219],v212,24576
M v[156:159],a[240:243],a[116:119],v[156:159]
R a[220:223],v213,24576
M v[156:159],a[236:239],a[112:115],v[156:159]
E v152
E v153
E v154
E v155
M v[84:87],a[88:91],a[144:147],v[84:87]
T a[224:225],v221,16384
C v166,v152,v153
C v167,v154,v155
M v[84:87],a[92:95],a[148:151],v[84:87]
E v156
E v157
E v158
E v159
M v[116:119],a[92:95],a[156:159],v[116:119]
T a[226:227],v221,20480
C v170,v156,v157
C v171,v158,v159
M v[116:119],a[88:91],a[152:155],v[116:119]
T a[228:229],v221,24576
M v[120:123],a[36:39],a[152:155],v[120:123]
s_waitcnt vmcnt(8) lgkmcnt(3)
s_barrier
T a[230:231],v221,28672
M v[120:123],a[40:43],a[156:159],v[120:123]
T a[232:233],v218,16384
M v[88:91],a[40:43],a[148:151],v[88:91]
T a[234:235],v218,20480
M v[88:91],a[36:39],a[144:147],v[88:91]
T a[236:237],v218,24576
M v[8:11],a[44:47],v[180:183],v[8:11]
T a[238:239],v218,28672
M v[8:11],v[232:235],v[188:191],v[8:11]
T a[240:241],v219,16384
M v[40:43],v[232:235],v[192:195],v[40:43]
T a[242:243],v219,20480
M v[40:43],a[44:47],v[184:187],v[40:43]
T a[244:245],v219,24576
M a[212:215],a[192:195],a[196:199],a[212:215]
T a[246:247],v219,28672
M a[212:215],a[192:195],a[200:203],a[212:215]
R a[84:87],v210,28672
M a[204:207],a[192:195],v[180:183],a[204:207]
R a[88:91],v211,28672
M a[204:207],a[192:195],v[188:191],a[204:207]
R a[92:95],v212,28672
M a[208:211],a[192:195],v[184:187],a[208:211]
R a[36:39],v213,28672
M a[208:211],a[192:195],v[192:195],a[208:211]
T a[40:41],v222,16384
v_accvgpr_read_b32 v253,a212
M v[144:147],a[248:251],a[96:99],v[196:199]
T a[42:43],v222,20480
M v[144:147],a[252:255],a[100:103],v[144:147]
T a[44:45],v222,24576
v_accvgpr_read_b32 v251,a204
M v[144:147],a[216:219],a[104:107],v[144:147]
v_add_f32 v250,v250,v251
v_accvgpr_read_b32 v252,a208
M v[144:147],a[220:223],a[108:111],v[144:147]
T a[46:47],v222,28672
v_add_f32 v250,v250,v252
v_rcp_f32 v251,v251
M v[148:151],a[220:223],a[124:127],v[200:203]
v_rcp_f32 v252,v252
v_add_f32 v250,v250,v253
v_mul_f32 v8,v251,v8
v_mul_f32 v9,v251,v9
v_mul_f32 v10,v251,v10
v_mul_f32 v11,v251,v11
M v[148:151],a[216:219],a[120:123],v[148:151]
v_rcp_f32 v253,v253
E v144
E v145
M v[148:151],a[252:255],a[116:119],v[148:151]
T v[232:233],v223,16384
C v172,v144,v145
M v[148:151],a[248:251],a[112:115],v[148:151]
s_waitcnt lgkmcnt(2)
T v[234:235],v223,20480
C v8,v8,v9
M v[12:15],a[224:227],v[180:183],v[12:15]
T a[248:249],v223,24576
C v9,v10,v11
M v[12:15],a[228:231],v[188:191],v[12:15]
T a[250:251],v223,28672
v_accvgpr_write_b32 a52,v8
M v[44:47],a[228:231],v[192:195],v[44:47]
T a[252:253],v224,16384
v_accvgpr_write_b32 a53,v9
M v[44:47],a[224:227],v[184:187],v[44:47]
T a[254:255],v224,20480
v_mul_f32 v40,v252,v40
M v[32:35],a[232:235],v[184:187],v[32:35]
T a[216:217],v224,24576
v_mul_f32 v12,v251,v12
M v[32:35],a[236:239],v[192:195],v[32:35]
T a[218:219],v224,28672
v_mul_f32 v13,v251,v13
M v[0:3],a[236:239],v[188:191],v[0:3]
T a[220:221],v225,16384
v_mul_f32 v14,v251,v14
M v[0:3],a[232:235],v[180:183],v[0:3]
T a[222:223],v225,20480
v_mul_f32 v15,v251,v15
M v[64:67],a[232:235],a[196:199],v[64:67]
T a[224:225],v225,24576
C v10,v12,v13
M v[64:67],a[236:239],a[200:203],v[64:67]
T a[226:227],v225,28672
C v11,v14,v15
M v[4:7],a[240:243],v[180:183],v[4:7]
R a[228:231],v214,32768
v_accvgpr_write_b32 a54,v10
M v[4:7],a[244:247],v[188:191],v[4:7]
R a[232:235],v215,32768
v_accvgpr_write_b32 a55,v11
M v[36:39],a[244:247],v[192:195],v[36:39]
R a[236:239],v216,32768
v_mul_f32 v41,v252,v41
M v[36:39],a[240:243],v[184:187],v[36:39]
E v146
M v[68:71],a[240:243],a[196:199],v[68:71]
R a[240:243],v217,32768
v_mul_f32 v42,v252,v42
M v[68:71],a[244:247],a[200:203],v[68:71]
R a[244:247],v210,32768
v_mul_f32 v43,v252,v43
M v[152:155],a[84:87],a[96:99],v[196:199]
E v147
M v[152:155],a[88:91],a[100:103],v[152:155]
R a[168:171],v226,32768
C v173,v146,v147
M v[152:155],a[92:95],a[104:107],v[152:155]
E v148
M v[152:155],a[36:39],a[108:111],v[152:155]
E v149
M v[156:159],a[36:39],a[124:127],v[200:203]
T a[36:37],v223,32768
C v176,v148,v149
M v[156:159],a[92:95],a[120:123],v[156:159]
R a[92:95],v213,32768
v_mul_f32 v44,v252,v44
M v[156:159],a[88:91],a[116:119],v[156:159]
R a[88:91],v212,32768
v_mul_f32 v45,v252,v45
M v[156:159],a[84:87],a[112:115],v[156:159]
R a[84:87],v211,32768
v_mul_f32 v46,v252,v46
M v[16:19],a[40:43],v[180:183],v[16:19]
s_waitcnt lgkmcnt(5)
T a[38:39],v223,36864
v_mul_f32 v47,v252,v47
M v[16:19],a[44:47],v[188:191],v[16:19]
E v150
M v[48:51],a[44:47],v[192:195],v[48:51]
T a[44:45],v224,32768
C v40,v40,v41
M v[48:51],a[40:43],v[184:187],v[48:51]
T a[40:41],v223,40960
C v41,v42,v43
M v[52:55],v[232:235],v[184:187],v[52:55]
T a[42:43],v223,45056
C v42,v44,v45
M v[52:55],a[248:251],v[192:195],v[52:55]
T a[46:47],v224,36864
C v43,v46,v47
M v[20:23],a[248:251],v[188:191],v[20:23]
E v151
M v[20:23],v[232:235],v[180:183],v[20:23]
T v[232:233],v224,40960
C v177,v150,v151
M v[24:27],a[252:255],v[180:183],v[24:27]
s_barrier
T v[234:235],v224,45056
Dn v254,s[12:15],0
E v152
E v153
E v154
M v[24:27],a[216:219],v[188:191],v[24:27]
T a[248:249],v225,32768
E v155
C v174,v152,v153
E v156
E v157
M v[56:59],a[216:219],v[192:195],v[56:59]
T a[250:251],v225,36864
Dn v255,s[12:15],1024
C v175,v154,v155
E v158
E v159
C v178,v156,v157
M v[56:59],a[252:255],v[184:187],v[56:59]
T a[252:253],v225,40960
C v179,v158,v159
v_accvgpr_write_b32 a68,v40
v_accvgpr_write_b32 a69,v41
v_accvgpr_write_b32 a70,v42
v_accvgpr_write_b32 a71,v43
v_mul_f32 v32,v252,v32
v_mul_f32 v33,v252,v33
M v[60:63],a[220:223],v[184:187],v[60:63]
T a[254:255],v225,45056
Dn v254,s[12:15],2048
v_mul_f32 v34,v252,v34
v_mul_f32 v35,v252,v35
v_mul_f32 v36,v252,v36
v_mul_f32 v37,v252,v37
v_mul_f32 v38,v252,v38
v_mul_f32 v39,v252,v39
M v[60:63],a[224:227],v[192:195],v[60:63]
R a[216:219],v210,36864
C v32,v32,v33
v_mul_f32 v0,v251,v0
v_mul_f32 v1,v251,v1
v_mul_f32 v2,v251,v2
v_mul_f32 v3,v251,v3
v_mul_f32 v4,v251,v4
v_mul_f32 v5,v251,v5
M v[28:31],a[224:227],v[188:191],v[28:31]
R a[224:227],v212,36864
Dn v255,s[12:15],3072
C v33,v34,v35
v_accvgpr_write_b32 a64,v32
v_mul_f32 v6,v251,v6
v_mul_f32 v7,v251,v7
C v0,v0,v1
v_mul_f32 v64,v253,v64
M v[28:31],a[220:223],v[180:183],v[28:31]
s_add_u32 m0,s45,16384
R a[220:223],v211,36864
C v34,v36,v37
C v35,v38,v39
v_accvgpr_write_b32 a65,v33
C v1,v2,v3
v_accvgpr_write_b32 a48,v0
v_mul_f32 v65,v253,v65
v_mul_f32 v66,v253,v66
M v[160:163],a[228:231],a[128:131],v[204:207]
s_add_u32 s8,s67,262144
R a[228:231],v213,36864
v_accvgpr_write_b32 a66,v34
v_accvgpr_write_b32 a67,v35
C v2,v4,v5
C v3,v6,v7
v_accvgpr_write_b32 a49,v1
v_mul_f32 v67,v253,v67
v_mul_f32 v68,v253,v68
M v[160:163],a[232:235],a[132:135],v[160:163]
T a[232:233],v218,49152
Dn v245,s[8:11],0
v_accvgpr_write_b32 a50,v2
v_accvgpr_write_b32 a51,v3
v_mul_f32 v69,v253,v69
v_mul_f32 v70,v253,v70
v_mul_f32 v71,v253,v71
C v64,v64,v65
M v[160:163],a[236:239],a[136:139],v[160:163]
T a[234:235],v218,53248
C v65,v66,v67
v_accvgpr_write_b32 a80,v64
v_mul_f32 v16,v251,v16
v_mul_f32 v17,v251,v17
v_mul_f32 v18,v251,v18
v_mul_f32 v19,v251,v19
v_mul_f32 v20,v251,v20
M v[160:163],a[240:243],a[140:143],v[160:163]
R a[172:175],v227,32768
Dn v246,s[8:11],1024
C v66,v68,v69
C v67,v70,v71
v_accvgpr_write_b32 a81,v65
v_mul_f32 v21,v251,v21
v_mul_f32 v22,v251,v22
v_mul_f32 v23,v251,v23
M v[144:147],a[244:247],a[96:99],v[196:199]
s_waitcnt lgkmcnt(3)
T a[236:237],v218,57344
v_accvgpr_write_b32 a82,v66
v_accvgpr_write_b32 a83,v67
C v16,v16,v17
v_mul_f32 v48,v252,v48
v_mul_f32 v49,v252,v49
v_mul_f32 v50,v252,v50
v_mul_f32 v51,v252,v51
M v[144:147],a[84:87],a[100:103],v[144:147]
T a[238:239],v218,61440
Dn v245,s[8:11],2048
C v17,v18,v19
v_accvgpr_write_b32 a56,v16
v_mul_f32 v52,v252,v52
v_mul_f32 v53,v252,v53
v_mul_f32 v54,v252,v54
v_mul_f32 v55,v252,v55
M v[144:147],a[88:91],a[104:107],v[144:147]
R a[180:183],v227,34816
C v18,v20,v21
C v19,v22,v23
v_accvgpr_write_b32 a57,v17
C v48,v48,v49
v_mul_f32 v56,v252,v56
v_mul_f32 v57,v252,v57
v_mul_f32 v58,v252,v58
M v[144:147],a[92:95],a[108:111],v[144:147]
R a[176:179],v226,34816
Dn v246,s[8:11],3072
v_accvgpr_write_b32 a58,v18
v_accvgpr_write_b32 a59,v19
C v49,v50,v51
v_accvgpr_write_b32 a72,v48
v_mul_f32 v59,v252,v59
M v[148:151],a[92:95],a[124:127],v[200:203]
s_add_u32 m0,s45,65536
R a[184:187],v228,6144
C v50,v52,v53
M v[148:151],a[88:91],a[120:123],v[148:151]
s_add_u32 s20,s97,0
R a[188:191],v229,6144
C v51,v54,v55
M v[148:151],a[84:87],a[116:119],v[148:151]
s_waitcnt lgkmcnt(4)
T a[240:241],v219,49152
D v247,s[20:23],0
M v[148:151],a[244:247],a[112:115],v[148:151]
s_add_u32 s20,s97,7168
T a[242:243],v219,53248
v_accvgpr_write_b32 a73,v49
M v[92:95],a[36:39],a[144:147],v[92:95]
T a[244:245],v219,57344
v_accvgpr_write_b32 a74,v50
M v[92:95],a[40:43],a[148:151],v[92:95]
T a[246:247],v219,61440
v_accvgpr_write_b32 a75,v51
M v[124:127],a[40:43],a[156:159],v[124:127]
T a[84:85],v220,0
v_mul_f32 v60,v252,v60
M v[124:127],a[36:39],a[152:155],v[124:127]
T a[86:87],v220,4096
D v247,s[20:23],1024
M v[128:131],a[44:47],a[152:155],v[128:131]
s_add_u32 s20,s97,14336
T a[88:89],v220,8192
v_mul_f32 v61,v252,v61
M v[128:131],v[232:235],a[156:159],v[128:131]
T a[90:91],v220,12288
v_mul_f32 v62,v252,v62
M v[96:99],v[232:235],a[148:151],v[96:99]
R a[92:95],v210,40960
v_mul_f32 v63,v252,v63
M v[96:99],a[44:47],a[144:147],v[96:99]
R a[36:39],v211,40960
C v56,v56,v57
M v[100:103],a[248:251],a[144:147],v[100:103]
s_waitcnt lgkmcnt(8)
R a[196:199],v243,0
D v247,s[20:23],2048
M v[100:103],a[252:255],a[148:151],v[100:103]
s_add_u32 s20,s97,21504
R a[200:203],v243,1024
C v57,v58,v59
M v[132:135],a[252:255],a[156:159],v[132:135]
R a[40:43],v212,40960
C v58,v60,v61
M v[132:135],a[248:251],a[152:155],v[132:135]
R a[44:47],v213,40960
C v59,v62,v63
M v[152:155],a[216:219],a[96:99],v[196:199]
T v[232:233],v221,0
v_accvgpr_write_b32 a76,v56
M v[152:155],a[220:223],a[100:103],v[152:155]
T v[234:235],v221,4096
D v247,s[20:23],3072
M v[152:155],a[224:227],a[104:107],v[152:155]
s_add_u32 m0,s45,114688
E v144
M v[152:155],a[228:231],a[108:111],v[152:155]
s_add_u32 s16,s40,768
E v145
M v[156:159],a[228:231],a[124:127],v[200:203]
E v146
M v[156:159],a[224:227],a[120:123],v[156:159]
E v147
M v[156:159],a[220:223],a[116:119],v[156:159]
T a[248:249],v221,8192
C v180,v144,v145
M v[156:159],a[216:219],a[112:115],v[156:159]
T a[250:251],v221,12288
C v181,v146,v147
M v[72:75],a[232:235],a[168:171],v[72:75]
T a[252:253],v218,0
v_accvgpr_write_b32 a77,v57
M v[72:75],a[236:239],a[172:175],v[72:75]
T a[254:255],v218,4096
v_accvgpr_write_b32 a78,v58
M v[104:107],a[236:239],a[180:183],v[104:107]
E v148
M v[104:107],a[232:235],a[176:179],v[104:107]
E v149
M v[136:139],a[232:235],a[184:187],v[136:139]
E v150
M v[136:139],a[236:239],a[188:191],v[136:139]
E v151
M v[76:79],a[240:243],a[168:171],v[76:79]
s_waitcnt lgkmcnt(4)
T a[216:217],v218,8192
C v184,v148,v149
M v[76:79],a[244:247],a[172:175],v[76:79]
T a[218:219],v218,12288
C v185,v150,v151
M v[108:111],a[244:247],a[180:183],v[108:111]
s_waitcnt vmcnt(9)
s_barrier
T a[220:221],v219,0
E v152
E v153
E v154
v_accvgpr_write_b32 a79,v59
M v[108:111],a[240:243],a[176:179],v[108:111]
T a[222:223],v219,4096
E v155
C v182,v152,v153
E v156
M v[140:143],a[240:243],a[184:187],v[140:143]
T a[224:225],v219,8192
C v183,v154,v155
M v[140:143],a[244:247],a[188:191],v[140:143]
T a[226:227],v219,12288
v_mul_f32 v24,v251,v24
M v[8:11],a[84:87],v[164:167],0
T a[228:229],v222,0
v_mul_f32 v25,v251,v25
M v[8:11],a[88:91],v[172:175],v[8:11]
T a[230:231],v222,4096
v_mul_f32 v26,v251,v26
M v[40:43],a[88:91],v[176:179],0
T a[232:233],v222,8192
v_mul_f32 v27,v251,v27
M v[40:43],a[84:87],v[168:171],v[40:43]
T a[234:235],v222,12288
v_mul_f32 v28,v251,v28
M v[144:147],a[92:95],a[96:99],v[196:199]
R a[236:239],v210,45056
v_mul_f32 v29,v251,v29
M v[144:147],a[36:39],a[100:103],v[144:147]
R a[240:243],v211,45056
D v230,s[16:19],0
M v[144:147],a[40:43],a[104:107],v[144:147]
R a[244:247],v212,45056
v_mul_f32 v30,v251,v30
M v[144:147],a[44:47],a[108:111],v[144:147]
R a[84:87],v213,45056
v_mul_f32 v31,v251,v31
M v[148:151],a[44:47],a[124:127],v[200:203]
T a[88:89],v223,0
C v24,v24,v25
M v[148:151],a[40:43],a[120:123],v[148:151]
T a[90:91],v223,4096
C v25,v26,v27
M v[148:151],a[36:39],a[116:119],v[148:151]
T a[36:37],v224,0
D v231,s[16:19],1024
M v[148:151],a[92:95],a[112:115],v[148:151]
s_add_u32 s16,s40,129792
T a[92:93],v223,8192
C v26,v28,v29
M v[12:15],v[232:235],v[164:167],0
L_pg12:
s_cmp_eq_u32 s47,1
s_cbranch_scc1 L_bkB14_0
s_waitcnt lgkmcnt(8)
T a[94:95],v223,12288
C v27,v30,v31
M v[12:15],a[248:251],v[172:175],v[12:15]
T a[38:39],v224,4096
v_accvgpr_write_b32 a60,v24
M v[44:47],a[248:251],v[176:179],0
E v157
M v[44:47],v[232:235],v[168:171],v[44:47]
T a[40:41],v224,8192
D v230,s[16:19],2048
M v[32:35],a[252:255],v[168:171],0
E v158
M v[32:35],a[216:219],v[176:179],v[32:35]
E v159
C v186,v156,v157
M v[0:3],a[216:219],v[172:175],0
T a[42:43],v224,12288
C v187,v158,v159
M v[0:3],a[252:255],v[164:167],v[0:3]
T a[44:45],v225,0
D v231,s[16:19],3072
M v[64:67],a[252:255],a[196:199],0
s_add_u32 m0,s46,155648
T a[46:47],v225,4096
v_accvgpr_write_b32 a61,v25
M v[64:67],a[216:219],a[200:203],v[64:67]
s_and_b32 s20,s98,0xffffff7f
T v[232:233],v225,8192
v_accvgpr_write_b32 a62,v26
M v[4:7],a[220:223],v[164:167],0
T v[234:235],v225,12288
v_accvgpr_write_b32 a63,v27
M v[4:7],a[224:227],v[172:175],v[4:7]
E v160
M v[36:39],a[224:227],v[176:179],0
R a[248:251],v214,0
D v240,s[20:23],0
M v[36:39],a[220:223],v[168:171],v[36:39]
s_add_u32 m0,s45,81920
E v161
M v[68:71],a[220:223],a[196:199],0
s_add_u32 s3,s66,262144
E v162
M v[68:71],a[224:227],a[200:203],v[68:71]
s_add_u32 s12,s3,s51
E v163
M v[16:19],a[228:231],v[164:167],0
C v208,v160,v161
C v209,v162,v163
M v[16:19],a[232:235],v[172:175],v[16:19]
R a[252:255],v215,0
v_xor_b32 v251,1024,v244
M v[48:51],a[232:235],v[176:179],0
ds_write_b64 v242,v[208:209] offset:2048
M v[48:51],a[228:231],v[168:171],v[48:51]
s_waitcnt lgkmcnt(3)
R a[216:219],v216,0
v_xor_b32 v252,2048,v244
M v[152:155],a[236:239],a[96:99],v[196:199]
R a[220:223],v217,0
v_xor_b32 v253,3072,v244
M v[152:155],a[240:243],a[100:103],v[152:155]
E v144
M v[152:155],a[244:247],a[104:107],v[152:155]
E v145
M v[152:155],a[84:87],a[108:111],v[152:155]
R a[224:227],v210,0
C v188,v144,v145
M v[156:159],a[84:87],a[124:127],v[200:203]
E v146
M v[156:159],a[244:247],a[120:123],v[156:159]
E v147
M v[156:159],a[240:243],a[116:119],v[156:159]
R a[228:231],v211,0
C v189,v146,v147
M v[156:159],a[236:239],a[112:115],v[156:159]
E v148
M v[20:23],a[88:91],v[164:167],0
E v149
M v[20:23],a[92:95],v[172:175],v[20:23]
R a[232:235],v212,0
C v192,v148,v149
M v[52:55],a[92:95],v[176:179],0
E v150
M v[52:55],a[88:91],v[168:171],v[52:55]
E v151
M v[56:59],a[36:39],v[168:171],0
R a[236:239],v213,0
C v193,v150,v151
M v[56:59],a[40:43],v[176:179],v[56:59]
E v152
M v[24:27],a[40:43],v[172:175],0
E v153
M v[24:27],a[36:39],v[164:167],v[24:27]
T a[240:241],v220,49152
C v190,v152,v153
M v[28:31],a[44:47],v[164:167],0
E v154
M v[28:31],v[232:235],v[172:175],v[28:31]
E v155
M v[60:63],v[232:235],v[176:179],0
s_waitcnt vmcnt(13) lgkmcnt(2)
s_barrier
T a[242:243],v220,53248
Dn v254,s[12:15],0
C v191,v154,v155
E v156
E v157
M v[60:63],a[44:47],v[168:171],v[60:63]
T a[244:245],v220,57344
E v158
E v159
C v194,v156,v157
M a[212:215],a[192:195],a[196:199],0
T a[246:247],v220,61440
Dn v255,s[12:15],1024
C v195,v158,v159
M a[212:215],a[192:195],a[200:203],a[212:215]
T a[84:85],v221,49152
M a[204:207],a[192:195],v[164:167],0
T a[86:87],v221,53248
M a[204:207],a[192:195],v[172:175],a[204:207]
T a[88:89],v221,57344
M a[208:211],a[192:195],v[168:171],0
T a[90:91],v221,61440
Dn v254,s[12:15],2048
M a[208:211],a[192:195],v[176:179],a[208:211]
T a[92:93],v222,49152
M v[160:163],a[248:251],a[128:131],v[204:207]
T a[94:95],v222,53248
M v[160:163],a[252:255],a[132:135],v[160:163]
T a[36:37],v222,57344
M v[160:163],a[216:219],a[136:139],v[160:163]
T a[38:39],v222,61440
M v[160:163],a[220:223],a[140:143],v[160:163]
R a[40:43],v210,4096
Dn v255,s[12:15],3072
M v[144:147],a[224:227],a[96:99],v[196:199]
s_add_u32 m0,s45,32768
R a[44:47],v211,4096
M v[144:147],a[228:231],a[100:103],v[144:147]
s_add_u32 s8,s68,262144
R v[232:235],v212,4096
M v[144:147],a[232:235],a[104:107],v[144:147]
s_waitcnt lgkmcnt(8)
E v160
E v161
E v162
E v163
M v[144:147],a[236:239],a[108:111],v[144:147]
R a[248:251],v213,4096
Dn v245,s[8:11],0
C v208,v160,v161
C v209,v162,v163
M v[148:151],a[236:239],a[124:127],v[200:203]
ds_write_b64 v242,v[208:209] offset:0
M v[148:151],a[232:235],a[120:123],v[148:151]
T a[252:253],v223,49152
M v[148:151],a[228:231],a[116:119],v[148:151]
E v144
E v145
E v146
E v147
M v[148:151],a[224:227],a[112:115],v[148:151]
T a[254:255],v223,53248
Dn v246,s[8:11],1024
C v164,v144,v145
C v165,v146,v147
M v[80:83],a[240:243],a[168:171],v[80:83]
T a[216:217],v223,57344
M v[80:83],a[244:247],a[172:175],v[80:83]
T a[218:219],v223,61440
M v[112:115],a[244:247],a[180:183],v[112:115]
E v148
E v149
E v150
E v151
M v[112:115],a[240:243],a[176:179],v[112:115]
T a[220:221],v224,49152
Dn v245,s[8:11],2048
C v168,v148,v149
C v169,v150,v151
M v[116:119],a[84:87],a[176:179],v[116:119]
s_waitcnt lgkmcnt(4)
T a[222:223],v224,53248
M v[116:119],a[88:91],a[180:183],v[116:119]
T a[224:225],v224,57344
M v[84:87],a[88:91],a[172:175],v[84:87]
T a[226:227],v224,61440
M v[84:87],a[84:87],a[168:171],v[84:87]
T a[228:229],v225,49152
Dn v246,s[8:11],3072
M v[88:91],a[92:95],a[168:171],v[88:91]
s_add_u32 m0,s45,131072
T a[230:231],v225,53248
M v[88:91],a[36:39],a[172:175],v[88:91]
s_add_u32 s16,s41,768
T a[232:233],v225,57344
M v[120:123],a[36:39],a[180:183],v[120:123]
T a[234:235],v225,61440
M v[120:123],a[92:95],a[176:179],v[120:123]
T a[236:237],v220,16384
M v[152:155],a[40:43],a[96:99],v[196:199]
T a[238:239],v220,20480
M v[152:155],a[44:47],a[100:103],v[152:155]
T a[240:241],v220,24576
M v[152:155],v[232:235],a[104:107],v[152:155]
T a[242:243],v220,28672
M v[152:155],a[248:251],a[108:111],v[152:155]
R a[244:247],v210,8192
M v[156:159],a[248:251],a[124:127],v[200:203]
R a[84:87],v211,8192
M v[156:159],v[232:235],a[120:123],v[156:159]
R a[196:199],v243,2048
M v[156:159],a[44:47],a[116:119],v[156:159]
R a[200:203],v243,3072
M v[156:159],a[40:43],a[112:115],v[156:159]
s_waitcnt lgkmcnt(8)
E v152
E v153
E v154
E v155
M v[92:95],a[252:255],a[168:171],v[92:95]
R a[88:91],v212,8192
C v166,v152,v153
C v167,v154,v155
M v[92:95],a[216:219],a[172:175],v[92:95]
E v156
E v157
E v158
E v159
M v[124:127],a[216:219],a[180:183],v[124:127]
R a[92:95],v213,8192
C v170,v156,v157
C v171,v158,v159
M v[124:127],a[252:255],a[176:179],v[124:127]
T a[36:37],v221,16384
M v[128:131],a[220:223],a[176:179],v[128:131]
T a[38:39],v221,20480
M v[128:131],a[224:227],a[180:183],v[128:131]
T a[40:41],v221,24576
M v[96:99],a[224:227],a[172:175],v[96:99]
T a[42:43],v221,28672
M v[96:99],a[220:223],a[168:171],v[96:99]
T a[44:45],v218,16384
M v[100:103],a[228:231],a[168:171],v[100:103]
s_waitcnt vmcnt(4) lgkmcnt(6)
s_barrier
T a[46:47],v218,20480
M v[100:103],a[232:235],a[172:175],v[100:103]
T v[232:233],v218,24576
M v[132:135],a[232:235],a[180:183],v[132:135]
T v[234:235],v218,28672
M v[132:135],a[228:231],a[176:179],v[132:135]
T a[248:249],v219,16384
M v[8:11],a[236:239],v[180:183],v[8:11]
T a[250:251],v219,20480
M v[8:11],a[240:243],v[188:191],v[8:11]
T a[252:253],v219,24576
M v[40:43],a[240:243],v[192:195],v[40:43]
T a[254:255],v219,28672
M v[40:43],a[236:239],v[184:187],v[40:43]
T a[216:217],v222,16384
M v[144:147],a[244:247],a[96:99],v[196:199]
T a[218:219],v222,20480
M v[144:147],a[84:87],a[100:103],v[144:147]
T a[220:221],v222,24576
M v[144:147],a[88:91],a[104:107],v[144:147]
s_waitcnt lgkmcnt(8)
T a[222:223],v222,28672
M v[144:147],a[92:95],a[108:111],v[144:147]
R a[224:227],v210,12288
M v[148:151],a[92:95],a[124:127],v[200:203]
R a[228:231],v211,12288
D v230,s[16:19],0
M v[148:151],a[88:91],a[120:123],v[148:151]
R a[232:235],v212,12288
M v[148:151],a[84:87],a[116:119],v[148:151]
R a[236:239],v213,12288
M v[148:151],a[244:247],a[112:115],v[148:151]
E v144
E v145
E v146
E v147
M v[12:15],a[36:39],v[180:183],v[12:15]
T a[240:241],v223,16384
D v231,s[16:19],1024
C v172,v144,v145
C v173,v146,v147
M v[12:15],a[40:43],v[188:191],v[12:15]
s_add_u32 s16,s41,129792
E v148
E v149
E v150
M v[44:47],a[40:43],v[192:195],v[44:47]
T a[242:243],v223,20480
C v176,v148,v149
M v[44:47],a[36:39],v[184:187],v[44:47]
T a[244:245],v223,24576
D v230,s[16:19],2048
M v[32:35],a[44:47],v[184:187],v[32:35]
s_waitcnt lgkmcnt(3)
E v151
M v[32:35],v[232:235],v[192:195],v[32:35]
T a[246:247],v223,28672
C v177,v150,v151
M v[0:3],v[232:235],v[188:191],v[0:3]
T a[84:85],v224,16384
M v[0:3],a[44:47],v[180:183],v[0:3]
T a[86:87],v224,20480
M v[64:67],a[44:47],a[196:199],v[64:67]
T a[88:89],v224,24576
D v231,s[16:19],3072
M v[64:67],v[232:235],a[200:203],v[64:67]
s_add_u32 m0,s45,98304
T a[90:91],v224,28672
M v[4:7],a[248:251],v[180:183],v[4:7]
s_add_u32 s3,s67,262144
T a[92:93],v225,16384
M v[4:7],a[252:255],v[188:191],v[4:7]
s_add_u32 s12,s3,s51
T a[94:95],v225,20480
M v[36:39],a[252:255],v[192:195],v[36:39]
T a[36:37],v225,24576
M v[36:39],a[248:251],v[184:187],v[36:39]
T a[38:39],v225,28672
M v[68:71],a[248:251],a[196:199],v[68:71]
R a[40:43],v214,16384
M v[68:71],a[252:255],a[200:203],v[68:71]
R a[44:47],v215,16384
M v[16:19],a[216:219],v[180:183],v[16:19]
R v[232:235],v216,16384
M v[16:19],a[220:223],v[188:191],v[16:19]
R a[248:251],v217,16384
M v[48:51],a[220:223],v[192:195],v[48:51]
R a[252:255],v210,16384
M v[48:51],a[216:219],v[184:187],v[48:51]
R a[216:219],v211,16384
M v[152:155],a[224:227],a[96:99],v[196:199]
R a[220:223],v212,16384
M v[152:155],a[228:231],a[100:103],v[152:155]
R a[144:147],v226,16384
M v[152:155],a[232:235],a[104:107],v[152:155]
R a[148:151],v227,16384
M v[152:155],a[236:239],a[108:111],v[152:155]
R a[156:159],v227,18432
M v[156:159],a[236:239],a[124:127],v[200:203]
R a[152:155],v226,18432
M v[156:159],a[232:235],a[120:123],v[156:159]
T a[232:233],v218,40960
M v[156:159],a[228:231],a[116:119],v[156:159]
T a[228:229],v218,32768
M v[156:159],a[224:227],a[112:115],v[156:159]
s_waitcnt lgkmcnt(8)
E v152
M v[20:23],a[240:243],v[180:183],v[20:23]
E v153
M v[20:23],a[244:247],v[188:191],v[20:23]
R a[224:227],v213,16384
C v174,v152,v153
M v[52:55],a[244:247],v[192:195],v[52:55]
E v154
M v[52:55],a[240:243],v[184:187],v[52:55]
E v155
M v[56:59],a[84:87],v[184:187],v[56:59]
T a[230:231],v218,36864
C v175,v154,v155
M v[56:59],a[88:91],v[192:195],v[56:59]
E v156
M v[24:27],a[88:91],v[188:191],v[24:27]
E v157
M v[24:27],a[84:87],v[180:183],v[24:27]
T a[234:235],v218,45056
C v178,v156,v157
M v[28:31],a[92:95],v[180:183],v[28:31]
E v158
M v[28:31],a[36:39],v[188:191],v[28:31]
E v159
M v[60:63],a[36:39],v[192:195],v[60:63]
s_barrier
R a[160:163],v228,0
Dn v254,s[12:15],0
C v179,v158,v159
M v[60:63],a[92:95],v[184:187],v[60:63]
R a[164:167],v229,0
M a[212:215],a[192:195],a[196:199],a[212:215]
T a[236:237],v219,32768
M a[212:215],a[192:195],a[200:203],a[212:215]
T a[238:239],v219,36864
M a[204:207],a[192:195],v[180:183],a[204:207]
T a[240:241],v219,40960
Dn v255,s[12:15],1024
M a[204:207],a[192:195],v[188:191],a[204:207]
T a[242:243],v219,45056
M a[208:211],a[192:195],v[184:187],a[208:211]
T a[244:245],v220,32768
M a[208:211],a[192:195],v[192:195],a[208:211]
T a[246:247],v220,36864
M v[160:163],a[40:43],a[128:131],v[204:207]
T a[84:85],v220,40960
M v[160:163],a[44:47],a[132:135],v[160:163]
T a[86:87],v220,45056
Dn v254,s[12:15],2048
M v[160:163],v[232:235],a[136:139],v[160:163]
T a[88:89],v221,32768
M v[160:163],a[248:251],a[140:143],v[160:163]
T a[90:91],v221,36864
M v[144:147],a[252:255],a[96:99],v[196:199]
s_waitcnt lgkmcnt(8)
T a[92:93],v221,40960
M v[144:147],a[216:219],a[100:103],v[144:147]
T a[94:95],v221,45056
M v[144:147],a[220:223],a[104:107],v[144:147]
R a[36:39],v210,20480
Dn v255,s[12:15],3072
M v[144:147],a[224:227],a[108:111],v[144:147]
s_add_u32 m0,s45,0
E v160
E v161
E v162
E v163
M v[148:151],a[224:227],a[124:127],v[200:203]
s_add_u32 s8,s69,262144
R a[40:43],v211,20480
C v208,v160,v161
C v209,v162,v163
M v[148:151],a[220:223],a[120:123],v[148:151]
R a[44:47],v212,20480
Dn v245,s[8:11],0
E v144
E v145
E v146
M v[148:151],a[216:219],a[116:119],v[148:151]
R v[232:235],v213,20480
E v147
C v180,v144,v145
M v[148:151],a[252:255],a[112:115],v[148:151]
T a[248:249],v222,32768
C v181,v146,v147
M v[72:75],a[228:231],a[144:147],v[72:75]
T a[250:251],v222,36864
Dn v246,s[8:11],1024
M v[72:75],a[232:235],a[148:151],v[72:75]
ds_write_b64 v242,v[208:209] offset:2048
M v[104:107],a[232:235],a[156:159],v[104:107]
E v148
E v149
E v150
E v151
M v[104:107],a[228:231],a[152:155],v[104:107]
T a[252:253],v222,40960
Dn v245,s[8:11],2048
C v184,v148,v149
C v185,v150,v151
M v[136:139],a[228:231],a[160:163],v[136:139]
T a[254:255],v222,45056
M v[136:139],a[232:235],a[164:167],v[136:139]
T a[216:217],v223,32768
M v[76:79],a[236:239],a[144:147],v[76:79]
s_waitcnt lgkmcnt(4)
T a[218:219],v223,36864
M v[76:79],a[240:243],a[148:151],v[76:79]
T a[220:221],v223,40960
Dn v246,s[8:11],3072
M v[108:111],a[240:243],a[156:159],v[108:111]
s_add_u32 m0,s45,49152
T a[222:223],v223,45056
M v[108:111],a[236:239],a[152:155],v[108:111]
s_add_u32 s20,s98,0
T a[224:225],v224,32768
M v[140:143],a[236:239],a[160:163],v[140:143]
T a[226:227],v224,36864
M v[140:143],a[240:243],a[164:167],v[140:143]
T a[228:229],v224,40960
M v[80:83],a[244:247],a[144:147],v[80:83]
T a[230:231],v224,45056
D v247,s[20:23],0
M v[80:83],a[84:87],a[148:151],v[80:83]
s_add_u32 s20,s98,7168
T a[232:233],v225,32768
M v[112:115],a[84:87],a[156:159],v[112:115]
T a[234:235],v225,36864
M v[112:115],a[244:247],a[152:155],v[112:115]
T a[236:237],v225,40960
M v[116:119],a[88:91],a[152:155],v[116:119]
T a[238:239],v225,45056
M v[116:119],a[92:95],a[156:159],v[116:119]
T a[240:241],v220,0
D v247,s[20:23],1024
M v[84:87],a[92:95],a[148:151],v[84:87]
s_add_u32 s20,s98,14336
T a[242:243],v220,4096
M v[84:87],a[88:91],a[144:147],v[84:87]
T a[244:245],v220,8192
M v[152:155],a[36:39],a[96:99],v[196:199]
T a[246:247],v220,12288
M v[152:155],a[40:43],a[100:103],v[152:155]
R a[84:87],v210,24576
M v[152:155],a[44:47],a[104:107],v[152:155]
R a[88:91],v211,24576
D v247,s[20:23],2048
M v[152:155],v[232:235],a[108:111],v[152:155]
s_add_u32 s20,s98,21504
R a[92:95],v212,24576
M v[156:159],v[232:235],a[124:127],v[200:203]
s_cmp_eq_u32 s44,0
s_cselect_b32 s55,0x01010101,0
T v[232:233],v218,0
M v[156:159],a[44:47],a[120:123],v[156:159]
T a[44:45],v221,8192
M v[156:159],a[40:43],a[116:119],v[156:159]
E v152
E v153
E v154
E v155
M v[156:159],a[36:39],a[112:115],v[156:159]
R a[36:39],v213,24576
D v247,s[20:23],3072
C v182,v152,v153
C v183,v154,v155
M v[88:91],a[248:251],a[144:147],v[88:91]
s_waitcnt lgkmcnt(5)
s_add_u32 m0,s45,114688
T a[40:41],v221,0
M v[88:91],a[252:255],a[148:151],v[88:91]
s_add_u32 s16,s42,768
E v156
E v157
E v158
E v159
M v[120:123],a[252:255],a[156:159],v[120:123]
T a[42:43],v221,4096
buffer_load_dwordx2 v[238:239],v237,s[84:87],0 offen sc1
C v186,v156,v157
C v187,v158,v159
M v[120:123],a[248:251],a[152:155],v[120:123]
T a[46:47],v221,12288
M v[124:127],a[216:219],a[152:155],v[124:127]
T v[234:235],v218,4096
M v[124:127],a[220:223],a[156:159],v[124:127]
T a[248:249],v218,8192
M v[92:95],a[220:223],a[148:151],v[92:95]
T a[250:251],v218,12288
M v[92:95],a[216:219],a[144:147],v[92:95]
R a[196:199],v243,0
M v[96:99],a[224:227],a[144:147],v[96:99]
s_mov_b32 s47,1
s_cmp_eq_u32 s44,0
s_cbranch_scc1 L_pg16
s_cmp_eq_u32 s44,1
s_cbranch_scc1 L_pg17
s_cmp_eq_u32 s44,2
s_cbranch_scc1 L_pg18
s_cmp_eq_u32 s44,3
s_cbranch_scc1 L_pg19
L_bkB19_0:
s_mov_b32 s47,0
s_waitcnt vmcnt(9)
s_barrier
R a[200:203],v243,1024
M v[96:99],a[228:231],a[148:151],v[96:99]
T a[252:253],v219,0
M v[128:131],a[228:231],a[156:159],v[128:131]
T a[254:255],v219,4096
M v[128:131],a[224:227],a[152:155],v[128:131]
L_pg13:
s_cmp_eq_u32 s47,1
s_cbranch_scc1 L_bkB14_0
T a[216:217],v219,8192
M v[132:135],a[232:235],a[152:155],v[132:135]
T a[218:219],v219,12288
M v[132:135],a[236:239],a[156:159],v[132:135]
T a[220:221],v222,0
M v[100:103],a[236:239],a[148:151],v[100:103]
T a[222:223],v222,4096
M v[100:103],a[232:235],a[144:147],v[100:103]
T a[224:225],v222,8192
M v[8:11],a[240:243],v[164:167],v[8:11]
T a[226:227],v222,12288
M v[8:11],a[244:247],v[172:175],v[8:11]
R a[228:231],v210,28672
M v[40:43],a[244:247],v[176:179],v[40:43]
R a[232:235],v211,28672
M v[40:43],a[240:243],v[168:171],v[40:43]
R a[236:239],v212,28672
M v[144:147],a[84:87],a[96:99],v[196:199]
s_waitcnt lgkmcnt(8)
R a[240:243],v213,28672
D v230,s[16:19],0
M v[144:147],a[88:91],a[100:103],v[144:147]
T a[244:245],v223,0
M v[144:147],a[92:95],a[104:107],v[144:147]
T a[246:247],v223,4096
M v[144:147],a[36:39],a[108:111],v[144:147]
R a[168:171],v226,32768
M v[148:151],a[36:39],a[124:127],v[200:203]
T a[36:37],v225,0
M v[148:151],a[92:95],a[120:123],v[148:151]
T a[92:93],v224,8192
D v231,s[16:19],1024
M v[148:151],a[88:91],a[116:119],v[148:151]
s_add_u32 s16,s42,129792
T a[88:89],v224,0
M v[148:151],a[84:87],a[112:115],v[148:151]
E v144
M v[12:15],a[40:43],v[164:167],v[12:15]
E v145
M v[12:15],a[44:47],v[172:175],v[12:15]
T a[84:85],v223,8192
C v188,v144,v145
M v[44:47],a[44:47],v[176:179],v[44:47]
T a[86:87],v223,12288
D v230,s[16:19],2048
M v[44:47],a[40:43],v[168:171],v[44:47]
E v146
M v[32:35],v[232:235],v[168:171],v[32:35]
E v147
M v[32:35],a[248:251],v[176:179],v[32:35]
T a[90:91],v224,4096
C v189,v146,v147
M v[0:3],a[248:251],v[172:175],v[0:3]
E v148
M v[0:3],v[232:235],v[164:167],v[0:3]
T a[94:95],v224,12288
D v231,s[16:19],3072
M v[64:67],v[232:235],a[196:199],v[64:67]
s_add_u32 m0,s45,81920
E v149
M v[64:67],a[248:251],a[200:203],v[64:67]
s_add_u32 s3,s68,262144
T a[38:39],v225,4096
C v192,v148,v149
M v[4:7],a[252:255],v[164:167],v[4:7]
s_waitcnt lgkmcnt(4)
E v150
M v[4:7],a[216:219],v[172:175],v[4:7]
s_add_u32 s12,s3,s51
E v151
M v[36:39],a[216:219],v[176:179],v[36:39]
T a[40:41],v225,8192
C v193,v150,v151
M v[36:39],a[252:255],v[168:171],v[36:39]
T a[42:43],v225,12288
M v[68:71],a[252:255],a[196:199],v[68:71]
R a[44:47],v214,32768
M v[68:71],a[216:219],a[200:203],v[68:71]
R v[232:235],v215,32768
M v[16:19],a[220:223],v[164:167],v[16:19]
R a[248:251],v216,32768
M v[16:19],a[224:227],v[172:175],v[16:19]
R a[252:255],v217,32768
M v[48:51],a[224:227],v[176:179],v[48:51]
R a[216:219],v210,32768
M v[48:51],a[220:223],v[168:171],v[48:51]
R a[220:223],v211,32768
M v[152:155],a[228:231],a[96:99],v[196:199]
R a[224:227],v212,32768
M v[152:155],a[232:235],a[100:103],v[152:155]
R a[172:175],v227,32768
M v[152:155],a[236:239],a[104:107],v[152:155]
R a[180:183],v227,34816
M v[152:155],a[240:243],a[108:111],v[152:155]
R a[176:179],v226,34816
M v[156:159],a[240:243],a[124:127],v[200:203]
R a[184:187],v228,2048
M v[156:159],a[236:239],a[120:123],v[156:159]
T a[236:237],v218,57344
M v[156:159],a[232:235],a[116:119],v[156:159]
T a[232:233],v218,49152
M v[156:159],a[228:231],a[112:115],v[156:159]
E v152
M v[20:23],a[244:247],v[164:167],v[20:23]
s_waitcnt lgkmcnt(7)
E v153
M v[20:23],a[84:87],v[172:175],v[20:23]
R a[228:231],v213,32768
C v190,v152,v153
M v[52:55],a[84:87],v[176:179],v[52:55]
E v154
M v[52:55],a[244:247],v[168:171],v[52:55]
E v155
M v[56:59],a[88:91],v[168:171],v[56:59]
T a[234:235],v218,53248
C v191,v154,v155
M v[56:59],a[92:95],v[176:179],v[56:59]
E v156
M v[24:27],a[92:95],v[172:175],v[24:27]
E v157
M v[24:27],a[88:91],v[164:167],v[24:27]
T a[238:239],v218,61440
C v194,v156,v157
M v[28:31],a[36:39],v[164:167],v[28:31]
E v158
M v[28:31],a[40:43],v[172:175],v[28:31]
E v159
M v[60:63],a[40:43],v[176:179],v[60:63]
s_barrier
R a[188:191],v229,2048
Dn v254,s[12:15],0
C v195,v158,v159
M v[60:63],a[36:39],v[168:171],v[60:63]
T a[240:241],v219,49152
M a[212:215],a[192:195],a[196:199],a[212:215]
T a[242:243],v219,53248
M a[212:215],a[192:195],a[200:203],a[212:215]
T a[244:245],v219,57344
M a[204:207],a[192:195],v[164:167],a[204:207]
T a[246:247],v219,61440
Dn v255,s[12:15],1024
M a[204:207],a[192:195],v[172:175],a[204:207]
T a[84:85],v220,49152
M a[208:211],a[192:195],v[168:171],a[208:211]
T a[86:87],v220,53248
M a[208:211],a[192:195],v[176:179],a[208:211]
T a[88:89],v220,57344
M v[160:163],a[44:47],a[128:131],v[204:207]
T a[90:91],v220,61440
M v[160:163],v[232:235],a[132:135],v[160:163]
T a[92:93],v221,49152
Dn v254,s[12:15],2048
M v[160:163],a[248:251],a[136:139],v[160:163]
T a[94:95],v221,53248
M v[160:163],a[252:255],a[140:143],v[160:163]
T a[36:37],v221,57344
M v[144:147],a[216:219],a[96:99],v[196:199]
T a[38:39],v221,61440
M v[144:147],a[220:223],a[100:103],v[144:147]
s_waitcnt lgkmcnt(8)
R a[40:43],v210,36864
M v[144:147],a[224:227],a[104:107],v[144:147]
R a[44:47],v211,36864
Dn v255,s[12:15],3072
M v[144:147],a[228:231],a[108:111],v[144:147]
s_add_u32 m0,s45,16384
E v160
E v161
E v162
E v163
M v[148:151],a[228:231],a[124:127],v[200:203]
s_add_u32 s8,s70,262144
R v[232:235],v212,36864
C v208,v160,v161
C v209,v162,v163
M v[148:151],a[224:227],a[120:123],v[148:151]
R a[248:251],v213,36864
Dn v245,s[8:11],0
E v144
E v145
E v146
M v[148:151],a[220:223],a[116:119],v[148:151]
T a[252:253],v222,49152
E v147
C v164,v144,v145
M v[148:151],a[216:219],a[112:115],v[148:151]
T a[254:255],v222,53248
C v165,v146,v147
M v[72:75],a[232:235],a[168:171],v[72:75]
T a[216:217],v222,57344
Dn v246,s[8:11],1024
M v[72:75],a[236:239],a[172:175],v[72:75]
ds_write_b64 v242,v[208:209] offset:0
M v[104:107],a[236:239],a[180:183],v[104:107]
E v148
E v149
E v150
E v151
M v[104:107],a[232:235],a[176:179],v[104:107]
T a[218:219],v222,61440
Dn v245,s[8:11],2048
C v168,v148,v149
C v169,v150,v151
M v[136:139],a[232:235],a[184:187],v[136:139]
T a[220:221],v223,49152
M v[136:139],a[236:239],a[188:191],v[136:139]
T a[222:223],v223,53248
M v[76:79],a[240:243],a[168:171],v[76:79]
T a[224:225],v223,57344
M v[76:79],a[244:247],a[172:175],v[76:79]
T a[226:227],v223,61440
Dn v246,s[8:11],3072
M v[108:111],a[244:247],a[180:183],v[108:111]
s_add_u32 m0,s45,65536
T a[228:229],v224,49152
M v[108:111],a[240:243],a[176:179],v[108:111]
s_add_u32 s20,s99,0
T a[230:231],v224,53248
M v[140:143],a[240:243],a[184:187],v[140:143]
T a[232:233],v224,57344
M v[140:143],a[244:247],a[188:191],v[140:143]
s_waitcnt lgkmcnt(7)
T a[234:235],v224,61440
M v[80:83],a[84:87],a[168:171],v[80:83]
T a[236:237],v225,49152
D v247,s[20:23],0
M v[80:83],a[88:91],a[172:175],v[80:83]
s_add_u32 s20,s99,7168
T a[238:239],v225,53248
M v[112:115],a[88:91],a[180:183],v[112:115]
T a[240:241],v225,57344
M v[112:115],a[84:87],a[176:179],v[112:115]
T a[242:243],v225,61440
M v[116:119],a[92:95],a[176:179],v[116:119]
T a[244:245],v220,16384
M v[116:119],a[36:39],a[180:183],v[116:119]
T a[246:247],v220,20480
D v247,s[20:23],1024
M v[84:87],a[36:39],a[172:175],v[84:87]
s_add_u32 s20,s99,14336
T a[84:85],v220,24576
M v[84:87],a[92:95],a[168:171],v[84:87]
T a[86:87],v220,28672
M v[152:155],a[40:43],a[96:99],v[196:199]
R a[88:91],v210,40960
M v[152:155],a[44:47],a[100:103],v[152:155]
R a[92:95],v211,40960
M v[152:155],v[232:235],a[104:107],v[152:155]
R a[36:39],v212,40960
D v247,s[20:23],2048
M v[152:155],a[248:251],a[108:111],v[152:155]
s_add_u32 s20,s99,21504
R a[196:199],v243,2048
M v[156:159],a[248:251],a[124:127],v[200:203]
T a[248:249],v218,16384
M v[156:159],v[232:235],a[120:123],v[156:159]
T v[232:233],v221,24576
M v[156:159],a[44:47],a[116:119],v[156:159]
T a[44:45],v221,16384
M v[156:159],a[40:43],a[112:115],v[156:159]
R a[40:43],v213,40960
D v247,s[20:23],3072
E v152
E v153
E v154
M v[88:91],a[252:255],a[168:171],v[88:91]
s_add_u32 m0,s45,131072
T a[46:47],v221,20480
E v155
C v166,v152,v153
v_add_u32 v247,s54,v247
M v[88:91],a[216:219],a[172:175],v[88:91]
s_add_u32 s16,s43,768
T v[234:235],v221,28672
C v167,v154,v155
E v156
E v157
E v158
M v[120:123],a[216:219],a[180:183],v[120:123]
T a[250:251],v218,20480
E v159
C v170,v156,v157
M v[120:123],a[252:255],a[176:179],v[120:123]
s_waitcnt lgkmcnt(3)
T a[252:253],v218,24576
C v171,v158,v159
M v[124:127],a[220:223],a[176:179],v[124:127]
T a[254:255],v218,28672
M v[124:127],a[224:227],a[180:183],v[124:127]
R a[200:203],v243,3072
M v[92:95],a[224:227],a[172:175],v[92:95]
T a[216:217],v219,16384
M v[92:95],a[220:223],a[168:171],v[92:95]
T a[218:219],v219,20480
M v[96:99],a[228:231],a[168:171],v[96:99]
s_mov_b32 s47,1
s_cmp_eq_u32 s44,0
s_cbranch_scc1 L_pg20
s_cmp_eq_u32 s44,1
s_cbranch_scc1 L_pg21
s_cmp_eq_u32 s44,2
s_cbranch_scc1 L_pg22
s_cmp_eq_u32 s44,3
s_cbranch_scc1 L_pg23
L_bkB20_0:
s_mov_b32 s47,0
s_waitcnt vmcnt(8)
s_barrier
v_and_b32 v238,v238,v239
v_cmp_eq_u32 vcc,s55,v238
s_cbranch_vccz L_spm
L_rtm:
M v[96:99],a[232:235],a[172:175],v[96:99]
T a[220:221],v219,24576
M v[128:131],a[232:235],a[180:183],v[128:131]
T a[222:223],v219,28672
M v[128:131],a[228:231],a[176:179],v[128:131]
T a[224:225],v222,16384
M v[132:135],a[236:239],a[176:179],v[132:135]
T a[226:227],v222,20480
M v[132:135],a[240:243],a[180:183],v[132:135]
T a[228:229],v222,24576
M v[100:103],a[240:243],a[172:175],v[100:103]
T a[230:231],v222,28672
M v[100:103],a[236:239],a[168:171],v[100:103]
R a[232:235],v210,45056
M v[8:11],a[244:247],v[180:183],v[8:11]
R a[236:239],v211,45056
M v[8:11],a[84:87],v[188:191],v[8:11]
R a[240:243],v212,45056
M v[40:43],a[84:87],v[192:195],v[40:43]
T a[84:85],v223,16384
M v[40:43],a[244:247],v[184:187],v[40:43]
R a[244:247],v213,45056
D v230,s[16:19],0
M v[144:147],a[88:91],a[96:99],v[196:199]
T a[86:87],v223,20480
M v[144:147],a[92:95],a[100:103],v[144:147]
R a[144:147],v226,16384
M v[144:147],a[36:39],a[104:107],v[144:147]
R a[148:151],v227,16384
M v[144:147],a[40:43],a[108:111],v[144:147]
R a[156:159],v227,18432
M v[148:151],a[40:43],a[124:127],v[200:203]
T a[40:41],v225,16384
D v231,s[16:19],1024
M v[148:151],a[36:39],a[120:123],v[148:151]
s_add_u32 s16,s43,129792
T a[36:37],v224,24576
M v[148:151],a[92:95],a[116:119],v[148:151]
E v144
M v[148:151],a[88:91],a[112:115],v[148:151]
s_waitcnt lgkmcnt(7)
E v145
M v[12:15],a[44:47],v[180:183],v[12:15]
T a[88:89],v223,24576
C v172,v144,v145
M v[12:15],v[232:235],v[188:191],v[12:15]
T a[90:91],v223,28672
D v230,s[16:19],2048
M v[44:47],v[232:235],v[192:195],v[44:47]
E v146
M v[44:47],a[44:47],v[184:187],v[44:47]
E v147
M v[32:35],a[248:251],v[184:187],v[32:35]
T a[92:93],v224,16384
C v173,v146,v147
M v[32:35],a[252:255],v[192:195],v[32:35]
E v148
M v[0:3],a[252:255],v[188:191],v[0:3]
T a[94:95],v224,20480
D v231,s[16:19],3072
M v[0:3],a[248:251],v[180:183],v[0:3]
s_add_u32 m0,s45,98304
E v149
M v[64:67],a[248:251],a[196:199],v[64:67]
s_add_u32 s3,s69,262144
T a[38:39],v224,28672
C v176,v148,v149
M v[64:67],a[252:255],a[200:203],v[64:67]
s_add_u32 s12,s3,s51
E v150
M v[4:7],a[216:219],v[180:183],v[4:7]
E v151
M v[4:7],a[220:223],v[188:191],v[4:7]
T a[42:43],v225,20480
C v177,v150,v151
M v[36:39],a[220:223],v[192:195],v[36:39]
T a[44:45],v225,24576
M v[36:39],a[216:219],v[184:187],v[36:39]
T a[46:47],v225,28672
M v[68:71],a[216:219],a[196:199],v[68:71]
R v[232:235],v214,0
M v[68:71],a[220:223],a[200:203],v[68:71]
R a[248:251],v215,0
M v[16:19],a[224:227],v[180:183],v[16:19]
R a[252:255],v216,0
M v[16:19],a[228:231],v[188:191],v[16:19]
R a[216:219],v217,0
M v[48:51],a[228:231],v[192:195],v[48:51]
R a[220:223],v210,0
M v[48:51],a[224:227],v[184:187],v[48:51]
R a[224:227],v211,0
M v[152:155],a[232:235],a[96:99],v[196:199]
R a[228:231],v212,0
M v[152:155],a[236:239],a[100:103],v[152:155]
R a[152:155],v226,18432
M v[152:155],a[240:243],a[104:107],v[152:155]
s_waitcnt lgkmcnt(8)
R a[160:163],v228,4096
M v[152:155],a[244:247],a[108:111],v[152:155]
R a[164:167],v229,4096
M v[156:159],a[244:247],a[124:127],v[200:203]
T a[244:245],v219,32768
M v[156:159],a[240:243],a[120:123],v[156:159]
T a[240:241],v218,40960
M v[156:159],a[236:239],a[116:119],v[156:159]
T a[236:237],v218,32768
M v[156:159],a[232:235],a[112:115],v[156:159]
E v152
M v[20:23],a[84:87],v[180:183],v[20:23]
E v153
M v[20:23],a[88:91],v[188:191],v[20:23]
R a[232:235],v213,0
C v174,v152,v153
M v[52:55],a[88:91],v[192:195],v[52:55]
E v154
M v[52:55],a[84:87],v[184:187],v[52:55]
E v155
M v[56:59],a[92:95],v[184:187],v[56:59]
T a[238:239],v218,36864
C v175,v154,v155
M v[56:59],a[36:39],v[192:195],v[56:59]
E v156
M v[24:27],a[36:39],v[188:191],v[24:27]
E v157
M v[24:27],a[92:95],v[180:183],v[24:27]
T a[242:243],v218,45056
C v178,v156,v157
M v[28:31],a[40:43],v[180:183],v[28:31]
E v158
M v[28:31],a[44:47],v[188:191],v[28:31]
E v159
M v[60:63],a[44:47],v[192:195],v[60:63]
s_barrier
T a[246:247],v219,36864
Dn v254,s[12:15],0
C v179,v158,v159
M v[60:63],a[40:43],v[184:187],v[60:63]
T a[84:85],v219,40960
M a[212:215],a[192:195],a[196:199],a[212:215]
T a[86:87],v219,45056
M a[212:215],a[192:195],a[200:203],a[212:215]
R a[88:91],v210,4096
M a[204:207],a[192:195],v[180:183],a[204:207]
R a[92:95],v211,4096
Dn v255,s[12:15],1024
M a[204:207],a[192:195],v[188:191],a[204:207]
R a[36:39],v212,4096
M a[208:211],a[192:195],v[184:187],a[208:211]
R a[40:43],v213,4096
M a[208:211],a[192:195],v[192:195],a[208:211]
s_waitcnt lgkmcnt(7)
T a[44:45],v220,32768
M v[160:163],v[232:235],a[128:131],v[204:207]
T a[46:47],v220,36864
M v[160:163],a[248:251],a[132:135],v[160:163]
T v[232:233],v220,40960
Dn v254,s[12:15],2048
M v[160:163],a[252:255],a[136:139],v[160:163]
T v[234:235],v220,45056
M v[160:163],a[216:219],a[140:143],v[160:163]
T a[248:249],v221,32768
M v[144:147],a[220:223],a[96:99],v[196:199]
T a[250:251],v221,36864
M v[144:147],a[224:227],a[100:103],v[144:147]
T a[252:253],v221,40960
M v[144:147],a[228:231],a[104:107],v[144:147]
T a[254:255],v221,45056
Dn v255,s[12:15],3072
M v[144:147],a[232:235],a[108:111],v[144:147]
s_add_u32 m0,s45,32768
E v160
E v161
E v162
E v163
M v[148:151],a[232:235],a[124:127],v[200:203]
s_add_u32 s8,s71,262144
T a[216:217],v222,32768
C v208,v160,v161
C v209,v162,v163
M v[148:151],a[228:231],a[120:123],v[148:151]
T a[218:219],v222,36864
Dn v245,s[8:11],0
E v144
E v145
E v146
M v[148:151],a[224:227],a[116:119],v[148:151]
T a[224:225],v220,0
E v147
C v180,v144,v145
M v[148:151],a[220:223],a[112:115],v[148:151]
T a[220:221],v222,40960
C v181,v146,v147
M v[72:75],a[236:239],a[144:147],v[72:75]
T a[222:223],v222,45056
Dn v246,s[8:11],1024
M v[72:75],a[240:243],a[148:151],v[72:75]
ds_write_b64 v242,v[208:209] offset:2048
M v[104:107],a[240:243],a[156:159],v[104:107]
E v148
E v149
E v150
E v151
M v[104:107],a[236:239],a[152:155],v[104:107]
T a[226:227],v220,4096
Dn v245,s[8:11],2048
C v184,v148,v149
C v185,v150,v151
M v[136:139],a[236:239],a[160:163],v[136:139]
T a[228:229],v220,8192
M v[136:139],a[240:243],a[164:167],v[136:139]
s_waitcnt lgkmcnt(4)
T a[230:231],v220,12288
M v[76:79],a[244:247],a[144:147],v[76:79]
R a[232:235],v210,8192
M v[76:79],a[84:87],a[148:151],v[76:79]
R a[236:239],v211,8192
Dn v246,s[8:11],3072
M v[108:111],a[84:87],a[156:159],v[108:111]
s_add_u32 m0,s45,81920
R a[196:199],v243,0
M v[108:111],a[244:247],a[152:155],v[108:111]
s_add_u32 s3,s70,262144
R a[200:203],v243,1024
M v[140:143],a[244:247],a[160:163],v[140:143]
s_add_u32 s12,s3,s51
R a[240:243],v212,8192
M v[140:143],a[84:87],a[164:167],v[140:143]
R a[244:247],v213,8192
M v[152:155],a[88:91],a[96:99],v[196:199]
T a[84:85],v221,0
M v[152:155],a[92:95],a[100:103],v[152:155]
T a[86:87],v221,4096
M v[152:155],a[36:39],a[104:107],v[152:155]
M v[152:155],a[40:43],a[108:111],v[152:155]
M v[156:159],a[40:43],a[124:127],v[200:203]
T a[40:41],v219,0
M v[156:159],a[36:39],a[120:123],v[156:159]
T a[36:37],v218,8192
M v[156:159],a[92:95],a[116:119],v[156:159]
T a[92:93],v218,0
M v[156:159],a[88:91],a[112:115],v[156:159]
T a[88:89],v221,8192
M v[80:83],a[44:47],a[144:147],v[80:83]
E v152
E v153
E v154
E v155
M v[80:83],v[232:235],a[148:151],v[80:83]
T a[90:91],v221,12288
C v182,v152,v153
C v183,v154,v155
M v[112:115],v[232:235],a[156:159],v[112:115]
L_pg14:
s_cmp_eq_u32 s47,1
s_cbranch_scc1 L_bkB14_0
E v156
E v157
E v158
E v159
M v[112:115],a[44:47],a[152:155],v[112:115]
T a[94:95],v218,4096
C v186,v156,v157
C v187,v158,v159
M v[116:119],a[248:251],a[152:155],v[116:119]
T a[38:39],v218,12288
M v[116:119],a[252:255],a[156:159],v[116:119]
T a[42:43],v219,4096
M v[84:87],a[252:255],a[148:151],v[84:87]
T a[44:45],v219,8192
M v[84:87],a[248:251],a[144:147],v[84:87]
T a[46:47],v219,12288
M v[88:91],a[216:219],a[144:147],v[88:91]
s_waitcnt vmcnt(5) lgkmcnt(5)
s_barrier
T v[232:233],v222,0
M v[88:91],a[220:223],a[148:151],v[88:91]
T v[234:235],v222,4096
M v[120:123],a[220:223],a[156:159],v[120:123]
T a[248:249],v222,8192
M v[120:123],a[216:219],a[152:155],v[120:123]
T a[250:251],v222,12288
M v[8:11],a[224:227],v[164:167],v[8:11]
R a[252:255],v210,12288
M v[8:11],a[228:231],v[172:175],v[8:11]
R a[216:219],v211,12288
M v[40:43],a[228:231],v[176:179],v[40:43]
R a[220:223],v212,12288
M v[40:43],a[224:227],v[168:171],v[40:43]
R a[224:227],v213,12288
M v[144:147],a[232:235],a[96:99],v[196:199]
T a[228:229],v223,0
M v[144:147],a[236:239],a[100:103],v[144:147]
T a[230:231],v223,4096
M v[144:147],a[240:243],a[104:107],v[144:147]
R a[168:171],v226,32768
M v[144:147],a[244:247],a[108:111],v[144:147]
R a[172:175],v227,32768
M v[148:151],a[244:247],a[124:127],v[200:203]
T a[244:245],v225,0
M v[148:151],a[240:243],a[120:123],v[148:151]
T a[240:241],v224,8192
M v[148:151],a[236:239],a[116:119],v[148:151]
T a[236:237],v224,0
M v[148:151],a[232:235],a[112:115],v[148:151]
E v144
E v145
E v146
E v147
M v[12:15],a[84:87],v[164:167],v[12:15]
T a[232:233],v223,8192
C v188,v144,v145
C v189,v146,v147
M v[12:15],a[88:91],v[172:175],v[12:15]
E v148
E v149
E v150
M v[44:47],a[88:91],v[176:179],v[44:47]
T a[234:235],v223,12288
C v192,v148,v149
M v[44:47],a[84:87],v[168:171],v[44:47]
s_waitcnt lgkmcnt(3)
E v151
M v[32:35],a[92:95],v[168:171],v[32:35]
T a[238:239],v224,4096
C v193,v150,v151
M v[32:35],a[36:39],v[176:179],v[32:35]
T a[242:243],v224,12288
M v[0:3],a[36:39],v[172:175],v[0:3]
T a[246:247],v225,4096
M v[0:3],a[92:95],v[164:167],v[0:3]
T a[84:85],v225,8192
M v[64:67],a[92:95],a[196:199],v[64:67]
T a[86:87],v225,12288
M v[64:67],a[36:39],a[200:203],v[64:67]
R a[88:91],v214,16384
M v[4:7],a[40:43],v[164:167],v[4:7]
R a[92:95],v215,16384
M v[4:7],a[44:47],v[172:175],v[4:7]
R a[36:39],v216,16384
M v[36:39],a[44:47],v[176:179],v[36:39]
R a[180:183],v227,34816
M v[36:39],a[40:43],v[168:171],v[36:39]
R a[176:179],v226,34816
v_subrev_u32 v227,159744,v243
M v[68:71],a[40:43],a[196:199],v[68:71]
R a[40:43],v217,16384
M v[68:71],a[44:47],a[200:203],v[68:71]
R a[44:47],v210,16384
M v[16:19],v[232:235],v[164:167],v[16:19]
R a[184:187],v228,6144
M v[16:19],a[248:251],v[172:175],v[16:19]
R a[188:191],v229,6144
v_lshrrev_b32 v228,6,v227
M v[48:51],a[248:251],v[176:179],v[48:51]
R a[248:251],v212,16384
v_bfe_u32 v229,v227,5,1
v_and_b32 v230,6,v228
M v[48:51],v[232:235],v[168:171],v[48:51]
R v[232:235],v211,16384
v_lshl_add_u32 v229,s44,1,v229
M v[152:155],a[252:255],a[96:99],v[196:199]
v_xor_b32 v229,v229,v230
M v[152:155],a[216:219],a[100:103],v[152:155]
v_lshlrev_b32 v229,4,v229
v_bfe_u32 v230,v227,4,1
M v[152:155],a[220:223],a[104:107],v[152:155]
v_lshl_add_u32 v229,v228,7,v229
M v[152:155],a[224:227],a[108:111],v[152:155]
v_lshl_add_u32 v229,v230,3,v229
M v[156:159],a[224:227],a[124:127],v[200:203]
T a[224:225],v224,32768
v_add_u32 v229,s45,v229
M v[156:159],a[220:223],a[120:123],v[156:159]
T a[220:221],v223,40960
v_add_u32 v226,81920,v229
M v[156:159],a[216:219],a[116:119],v[156:159]
T a[216:217],v223,32768
v_xor_b32 v227,4096,v226
M v[156:159],a[252:255],a[112:115],v[156:159]
R a[252:255],v213,16384
v_xor_b32 v228,8192,v226
M v[20:23],a[228:231],v[164:167],v[20:23]
s_waitcnt lgkmcnt(4)
T a[218:219],v223,36864
v_xor_b32 v229,12288,v226
M v[20:23],a[232:235],v[172:175],v[20:23]
T a[222:223],v223,45056
v_xor_b32 v230,32,v226
M v[52:55],a[232:235],v[176:179],v[52:55]
T a[226:227],v224,36864
v_xor_b32 v231,4128,v226
M v[52:55],a[228:231],v[168:171],v[52:55]
T a[228:229],v224,40960
v_xor_b32 v236,8256,v226
M v[56:59],a[236:239],v[168:171],v[56:59]
T a[230:231],v224,45056
v_xor_b32 v237,12352,v226
M v[56:59],a[240:243],v[176:179],v[56:59]
T a[232:233],v225,32768
v_xor_b32 v238,96,v226
M v[24:27],a[240:243],v[172:175],v[24:27]
T a[234:235],v225,36864
v_xor_b32 v239,4192,v226
M v[24:27],a[236:239],v[164:167],v[24:27]
T a[236:237],v225,40960
v_xor_b32 v240,8288,v226
M v[28:31],a[244:247],v[164:167],v[28:31]
T a[238:239],v225,45056
v_xor_b32 v241,12384,v226
M v[28:31],a[84:87],v[172:175],v[28:31]
E v152
M v[60:63],a[84:87],v[176:179],v[60:63]
s_waitcnt vmcnt(4)
s_barrier
R a[240:243],v210,20480
Dn v254,s[12:15],0
E v153
E v154
E v155
M v[60:63],a[244:247],v[168:171],v[60:63]
R a[244:247],v211,20480
C v190,v152,v153
C v191,v154,v155
E v156
E v157
M a[212:215],a[192:195],a[196:199],a[212:215]
R a[84:87],v212,20480
Dn v255,s[12:15],1024
E v158
E v159
C v194,v156,v157
M a[212:215],a[192:195],a[200:203],a[212:215]
R a[196:199],v243,2048
C v195,v158,v159
M a[204:207],a[192:195],v[164:167],a[204:207]
R a[200:203],v243,3072
M a[204:207],a[192:195],v[172:175],a[204:207]
Dn v254,s[12:15],2048
M a[208:211],a[192:195],v[168:171],a[208:211]
M a[208:211],a[192:195],v[176:179],a[208:211]
M v[160:163],a[88:91],a[128:131],v[204:207]
R a[88:91],v213,20480
M v[160:163],a[92:95],a[132:135],v[160:163]
T a[92:93],v218,49152
Dn v255,s[12:15],3072
M v[160:163],a[36:39],a[136:139],v[160:163]
s_add_u32 m0,s45,0
T a[94:95],v218,53248
M v[160:163],a[40:43],a[140:143],v[160:163]
s_add_u32 s8,s64,393216
T a[36:37],v218,57344
M v[144:147],a[44:47],a[96:99],v[196:199]
T a[38:39],v218,61440
M v[144:147],v[232:235],a[100:103],v[144:147]
T a[40:41],v219,49152
M v[144:147],a[248:251],a[104:107],v[144:147]
s_waitcnt lgkmcnt(6)
T a[42:43],v219,53248
Dn v245,s[8:11],0
M v[144:147],a[252:255],a[108:111],v[144:147]
E v160
E v161
E v162
E v163
M v[148:151],a[252:255],a[124:127],v[200:203]
R a[252:255],v210,24576
C v208,v160,v161
C v209,v162,v163
M v[148:151],a[248:251],a[120:123],v[148:151]
T a[248:249],v220,24576
Dn v246,s[8:11],1024
E v144
E v145
E v146
M v[148:151],v[232:235],a[116:119],v[148:151]
T v[232:233],v220,16384
E v147
C v164,v144,v145
M v[148:151],a[44:47],a[112:115],v[148:151]
T a[44:45],v219,57344
C v165,v146,v147
M v[92:95],a[216:219],a[144:147],v[92:95]
T a[46:47],v219,61440
Dn v245,s[8:11],2048
M v[92:95],a[220:223],a[148:151],v[92:95]
ds_write_b64 v242,v[208:209] offset:0
M v[124:127],a[220:223],a[156:159],v[124:127]
E v148
E v149
E v150
E v151
M v[124:127],a[216:219],a[152:155],v[124:127]
T v[234:235],v220,20480
Dn v246,s[8:11],3072
C v168,v148,v149
C v169,v150,v151
M v[128:131],a[224:227],a[152:155],v[128:131]
s_add_u32 m0,s45,98304
T a[250:251],v220,28672
M v[128:131],a[228:231],a[156:159],v[128:131]
s_add_u32 s3,s71,262144
R a[216:219],v211,24576
M v[96:99],a[228:231],a[148:151],v[96:99]
s_add_u32 s12,s3,s51
R a[220:223],v212,24576
M v[96:99],a[224:227],a[144:147],v[96:99]
R a[224:227],v213,24576
M v[100:103],a[232:235],a[144:147],v[100:103]
T a[228:229],v221,16384
M v[100:103],a[236:239],a[148:151],v[100:103]
T a[230:231],v221,20480
M v[132:135],a[236:239],a[156:159],v[132:135]
T a[236:237],v218,16384
M v[132:135],a[232:235],a[152:155],v[132:135]
T a[232:233],v221,24576
M v[152:155],a[240:243],a[96:99],v[196:199]
T a[234:235],v221,28672
M v[152:155],a[244:247],a[100:103],v[152:155]
T a[238:239],v218,20480
M v[152:155],a[84:87],a[104:107],v[152:155]
s_waitcnt lgkmcnt(8)
M v[152:155],a[88:91],a[108:111],v[152:155]
M v[156:159],a[88:91],a[124:127],v[200:203]
T a[88:89],v222,16384
M v[156:159],a[84:87],a[120:123],v[156:159]
T a[84:85],v219,24576
M v[156:159],a[244:247],a[116:119],v[156:159]
T a[244:245],v219,16384
M v[156:159],a[240:243],a[112:115],v[156:159]
T a[240:241],v218,24576
M v[72:75],a[92:95],a[168:171],v[72:75]
E v152
E v153
E v154
E v155
M v[72:75],a[36:39],a[172:175],v[72:75]
T a[242:243],v218,28672
C v166,v152,v153
C v167,v154,v155
M v[104:107],a[36:39],a[180:183],v[104:107]
E v156
E v157
E v158
E v159
M v[104:107],a[92:95],a[176:179],v[104:107]
T a[246:247],v219,20480
C v170,v156,v157
C v171,v158,v159
v_mul_f32 v72,s58,v72
v_mul_f32 v73,s58,v73
v_mul_f32 v74,s58,v74
v_mul_f32 v75,s58,v75
M v[136:139],a[92:95],a[184:187],v[136:139]
T a[86:87],v219,28672
C v72,v72,v73
v_mul_f32 v104,s58,v104
v_mul_f32 v105,s58,v105
v_mul_f32 v106,s58,v106
v_mul_f32 v107,s58,v107
M v[136:139],a[36:39],a[188:191],v[136:139]
T a[90:91],v222,20480
C v73,v74,v75
C v104,v104,v105
M v[76:79],a[40:43],a[168:171],v[76:79]
T a[92:93],v222,24576
C v105,v106,v107
M v[76:79],a[44:47],a[172:175],v[76:79]
T a[94:95],v222,28672
M v[108:111],a[44:47],a[180:183],v[108:111]
v_mul_f32 v136,s58,v136
v_mul_f32 v137,s58,v137
v_mul_f32 v138,s58,v138
v_mul_f32 v139,s58,v139
C v136,v136,v137
C v137,v138,v139
v_mul_f32 v76,s58,v76
v_mul_f32 v77,s58,v77
v_mul_f32 v78,s58,v78
v_mul_f32 v79,s58,v79
C v74,v76,v77
C v75,v78,v79
s_waitcnt vmcnt(6)
s_barrier
v_permlane16_swap_b32 v72,v74
v_permlane16_swap_b32 v73,v75
M v[108:111],a[40:43],a[176:179],v[108:111]
R a[36:39],v210,28672
v_accvgpr_write_b32 a144,v72
v_accvgpr_write_b32 a145,v73
v_accvgpr_write_b32 a146,v74
v_accvgpr_write_b32 a147,v75
M v[140:143],a[40:43],a[184:187],v[140:143]
R a[40:43],v211,28672
M v[140:143],a[44:47],a[188:191],v[140:143]
R a[44:47],v212,28672
v_mul_f32 v108,s58,v108
v_mul_f32 v109,s58,v109
v_mul_f32 v110,s58,v110
v_mul_f32 v111,s58,v111
M v[8:11],v[232:235],v[180:183],v[8:11]
C v106,v108,v109
C v107,v110,v111
M v[8:11],a[248:251],v[188:191],v[8:11]
v_mul_f32 v140,s58,v140
v_mul_f32 v141,s58,v141
v_mul_f32 v142,s58,v142
v_mul_f32 v143,s58,v143
M v[40:43],a[248:251],v[192:195],v[40:43]
T a[248:249],v223,16384
C v138,v140,v141
C v139,v142,v143
M v[40:43],v[232:235],v[184:187],v[40:43]
v_permlane16_swap_b32 v136,v138
M v[144:147],a[252:255],a[96:99],v[196:199]
v_permlane16_swap_b32 v137,v139
M v[144:147],a[216:219],a[100:103],v[144:147]
s_waitcnt lgkmcnt(2)
ds_write_b128 v244,v[136:139]
M v[144:147],a[220:223],a[104:107],v[144:147]
v_permlane16_swap_b32 v104,v106
M v[144:147],a[224:227],a[108:111],v[144:147]
R v[232:235],v213,28672
v_accvgpr_write_b32 a160,v104
M v[148:151],a[224:227],a[124:127],v[200:203]
T a[250:251],v223,20480
v_accvgpr_write_b32 a162,v106
M v[148:151],a[220:223],a[120:123],v[148:151]
v_permlane16_swap_b32 v105,v107
M v[148:151],a[216:219],a[116:119],v[148:151]
T a[216:217],v224,16384
v_accvgpr_write_b32 a161,v105
M v[148:151],a[252:255],a[112:115],v[148:151]
T a[252:253],v223,24576
v_accvgpr_write_b32 a163,v107
M v[12:15],a[228:231],v[180:183],v[12:15]
E v144
M v[12:15],a[232:235],v[188:191],v[12:15]
E v145
M v[44:47],a[232:235],v[192:195],v[44:47]
T a[254:255],v223,28672
C v172,v144,v145
M v[44:47],a[228:231],v[184:187],v[44:47]
E v146
M v[32:35],a[236:239],v[184:187],v[32:35]
E v147
M v[32:35],a[240:243],v[192:195],v[32:35]
T a[218:219],v224,20480
C v173,v146,v147
M v[0:3],a[240:243],v[188:191],v[0:3]
E v148
M v[0:3],a[236:239],v[180:183],v[0:3]
E v149
M v[64:67],a[236:239],a[196:199],v[64:67]
T a[220:221],v224,24576
C v176,v148,v149
M v[64:67],a[240:243],a[200:203],v[64:67]
E v150
M v[4:7],a[244:247],v[180:183],v[4:7]
E v151
M v[4:7],a[84:87],v[188:191],v[4:7]
T a[222:223],v224,28672
C v177,v150,v151
M v[36:39],a[84:87],v[192:195],v[36:39]
T a[224:225],v225,16384
M v[36:39],a[244:247],v[184:187],v[36:39]
T a[226:227],v225,20480
M v[68:71],a[244:247],a[196:199],v[68:71]
T a[228:229],v225,24576
M v[68:71],a[84:87],a[200:203],v[68:71]
T a[230:231],v225,28672
M v[16:19],a[88:91],v[180:183],v[16:19]
R a[232:235],v214,32768
M v[16:19],a[92:95],v[188:191],v[16:19]
R a[236:239],v215,32768
M v[48:51],a[92:95],v[192:195],v[48:51]
R a[240:243],v216,32768
M v[48:51],a[88:91],v[184:187],v[48:51]
R a[244:247],v217,32768
M v[152:155],a[36:39],a[96:99],v[196:199]
R a[84:87],v210,32768
M v[152:155],a[40:43],a[100:103],v[152:155]
s_waitcnt lgkmcnt(8)
R a[88:91],v211,32768
M v[152:155],a[44:47],a[104:107],v[152:155]
R a[92:95],v212,32768
M v[152:155],v[232:235],a[108:111],v[152:155]
M v[156:159],v[232:235],a[124:127],v[200:203]
T v[232:233],v221,49152
M v[156:159],a[44:47],a[120:123],v[156:159]
T a[44:45],v220,57344
M v[156:159],a[40:43],a[116:119],v[156:159]
T a[40:41],v220,49152
M v[156:159],a[36:39],a[112:115],v[156:159]
R a[36:39],v213,32768
M v[20:23],a[248:251],v[180:183],v[20:23]
E v152
M v[20:23],a[252:255],v[188:191],v[20:23]
E v153
M v[52:55],a[252:255],v[192:195],v[52:55]
T a[42:43],v220,53248
C v174,v152,v153
M v[52:55],a[248:251],v[184:187],v[52:55]
E v154
M v[56:59],a[216:219],v[184:187],v[56:59]
E v155
M v[56:59],a[220:223],v[192:195],v[56:59]
T a[46:47],v220,61440
C v175,v154,v155
M v[24:27],a[220:223],v[188:191],v[24:27]
E v156
M v[24:27],a[216:219],v[180:183],v[24:27]
s_waitcnt lgkmcnt(3)
E v157
M v[28:31],a[224:227],v[180:183],v[28:31]
T v[234:235],v221,53248
C v178,v156,v157
M v[28:31],a[228:231],v[188:191],v[28:31]
E v158
M v[60:63],a[228:231],v[192:195],v[60:63]
s_waitcnt vmcnt(4)
s_barrier
T a[248:249],v221,57344
Dn v254,s[12:15],0
E v159
M v[60:63],a[224:227],v[184:187],v[60:63]
T a[250:251],v221,61440
C v179,v158,v159
M a[212:215],a[192:195],a[196:199],a[212:215]
ds_write_b128 v244,a[32:35] offset:4096
M a[212:215],a[192:195],a[200:203],a[212:215]
T a[252:253],v222,49152
Dn v255,s[12:15],1024
M a[204:207],a[192:195],v[180:183],a[204:207]
ds_write_b128 v244,a[80:83] offset:8192
M a[204:207],a[192:195],v[188:191],a[204:207]
T a[254:255],v222,53248
M a[208:211],a[192:195],v[184:187],a[208:211]
T a[216:217],v222,57344
M a[208:211],a[192:195],v[192:195],a[208:211]
T a[218:219],v222,61440
Dn v254,s[12:15],2048
M v[160:163],a[232:235],a[128:131],v[204:207]
R a[220:223],v210,36864
M v[160:163],a[236:239],a[132:135],v[160:163]
R a[224:227],v211,36864
M v[160:163],a[240:243],a[136:139],v[160:163]
R a[228:231],v212,36864
M v[160:163],a[244:247],a[140:143],v[160:163]
R a[232:235],v213,36864
M v[144:147],a[84:87],a[96:99],v[196:199]
T a[236:237],v223,49152
Dn v255,s[12:15],3072
M v[144:147],a[88:91],a[100:103],v[144:147]
s_add_u32 m0,s45,16384
T a[238:239],v223,53248
M v[144:147],a[92:95],a[104:107],v[144:147]
s_waitcnt lgkmcnt(8)
E v160
E v161
E v162
E v163
M v[144:147],a[36:39],a[108:111],v[144:147]
s_add_u32 s8,s65,393216
T a[240:241],v223,57344
C v208,v160,v161
C v209,v162,v163
M v[148:151],a[36:39],a[124:127],v[200:203]
s_and_b32 s6,s6,0
T a[242:243],v223,61440
Dn v245,s[8:11],0
M v[148:151],a[92:95],a[120:123],v[148:151]
s_add_u32 s6,s6,s5
E v144
E v145
E v146
E v147
M v[148:151],a[88:91],a[116:119],v[148:151]
s_add_u32 s7,s6,1
T a[244:245],v224,49152
C v180,v144,v145
C v181,v146,v147
M v[148:151],a[84:87],a[112:115],v[148:151]
s_and_b32 s7,s7,7
T a[246:247],v224,53248
Dn v246,s[8:11],1024
M v[80:83],a[40:43],a[168:171],v[80:83]
s_lshl_b32 s7,s7,7
ds_write_b64 v242,v[208:209] offset:2048
M v[80:83],a[44:47],a[172:175],v[80:83]
s_add_u32 s72,s7,s52
T a[84:85],v224,57344
M v[112:115],a[44:47],a[180:183],v[112:115]
s_add_u32 s7,s6,2
E v148
E v149
E v150
E v151
M v[112:115],a[40:43],a[176:179],v[112:115]
s_and_b32 s7,s7,7
T a[86:87],v224,61440
Dn v245,s[8:11],2048
C v184,v148,v149
C v185,v150,v151
v_mul_f32 v80,s58,v80
v_mul_f32 v81,s58,v81
v_mul_f32 v82,s58,v82
v_mul_f32 v83,s58,v83
M v[116:119],v[232:235],a[176:179],v[116:119]
s_lshl_b32 s7,s7,7
T a[88:89],v225,49152
v_mul_f32 v112,s58,v112
v_mul_f32 v113,s58,v113
v_mul_f32 v114,s58,v114
v_mul_f32 v115,s58,v115
C v80,v80,v81
M v[116:119],a[248:251],a[180:183],v[116:119]
s_add_u32 s73,s7,s52
T a[90:91],v225,53248
Dn v246,s[8:11],3072
C v112,v112,v113
C v81,v82,v83
M v[84:87],a[248:251],a[172:175],v[84:87]
s_add_u32 s7,s6,3
T a[92:93],v225,57344
C v113,v114,v115
M v[84:87],v[232:235],a[168:171],v[84:87]
s_and_b32 s7,s7,7
T a[94:95],v225,61440
v_mul_f32 v116,s58,v116
v_mul_f32 v117,s58,v117
v_mul_f32 v118,s58,v118
v_mul_f32 v119,s58,v119
M v[88:91],a[252:255],a[168:171],v[88:91]
s_waitcnt lgkmcnt(4)
T a[36:37],v220,0
C v114,v116,v117
C v115,v118,v119
M v[88:91],a[216:219],a[172:175],v[88:91]
L_pg15:
s_cmp_eq_u32 s47,1
s_cbranch_scc1 L_bkB14_0
s_lshl_b32 s7,s7,7
T a[38:39],v220,4096
v_permlane16_swap_b32 v112,v114
v_mul_f32 v84,s58,v84
v_mul_f32 v85,s58,v85
v_mul_f32 v86,s58,v86
v_mul_f32 v87,s58,v87
M v[120:123],a[216:219],a[180:183],v[120:123]
s_add_u32 s74,s7,s52
T a[40:41],v220,8192
v_permlane16_swap_b32 v113,v115
v_accvgpr_write_b32 a164,v112
v_accvgpr_write_b32 a166,v114
C v82,v84,v85
C v83,v86,v87
v_mul_f32 v88,s58,v88
M v[120:123],a[252:255],a[176:179],v[120:123]
s_add_u32 s7,s6,4
T a[42:43],v220,12288
v_accvgpr_write_b32 a165,v113
v_accvgpr_write_b32 a167,v115
v_mul_f32 v89,s58,v89
v_mul_f32 v90,s58,v90
v_mul_f32 v91,s58,v91
v_permlane16_swap_b32 v80,v82
M v[152:155],a[220:223],a[96:99],v[196:199]
s_and_b32 s7,s7,7
R a[44:47],v210,40960
v_mul_f32 v120,s58,v120
v_mul_f32 v121,s58,v121
v_mul_f32 v122,s58,v122
v_mul_f32 v123,s58,v123
v_permlane16_swap_b32 v81,v83
C v88,v88,v89
M v[152:155],a[224:227],a[100:103],v[152:155]
s_lshl_b32 s7,s7,7
R v[232:235],v211,40960
C v120,v120,v121
C v89,v90,v91
v_accvgpr_write_b32 a148,v80
v_accvgpr_write_b32 a149,v81
v_accvgpr_write_b32 a150,v82
v_accvgpr_write_b32 a151,v83
M v[152:155],a[228:231],a[104:107],v[152:155]
s_add_u32 s75,s7,s52
R a[196:199],v243,0
C v121,v122,v123
M v[152:155],a[232:235],a[108:111],v[152:155]
s_add_u32 s7,s6,5
R a[200:203],v243,1024
M v[156:159],a[232:235],a[124:127],v[200:203]
s_and_b32 s7,s7,7
R a[248:251],v212,40960
M v[156:159],a[228:231],a[120:123],v[156:159]
s_lshl_b32 s7,s7,7
R a[252:255],v213,40960
M v[156:159],a[224:227],a[116:119],v[156:159]
s_add_u32 s76,s7,s52
E v152
E v153
E v154
E v155
M v[156:159],a[220:223],a[112:115],v[156:159]
s_add_u32 s7,s6,6
T a[216:217],v221,0
C v182,v152,v153
C v183,v154,v155
M v[92:95],a[236:239],a[168:171],v[92:95]
s_and_b32 s7,s7,7
T a[218:219],v221,4096
M v[92:95],a[240:243],a[172:175],v[92:95]
s_lshl_b32 s7,s7,7
E v156
E v157
E v158
E v159
M v[124:127],a[240:243],a[180:183],v[124:127]
s_add_u32 s77,s7,s52
T a[220:221],v221,8192
C v186,v156,v157
C v187,v158,v159
M v[124:127],a[236:239],a[176:179],v[124:127]
s_add_u32 s7,s6,7
T a[222:223],v221,12288
v_mul_f32 v92,s58,v92
v_mul_f32 v93,s58,v93
v_mul_f32 v94,s58,v94
v_mul_f32 v95,s58,v95
M v[128:131],a[244:247],a[176:179],v[128:131]
s_and_b32 s7,s7,7
T a[224:225],v218,0
C v90,v92,v93
C v91,v94,v95
M v[128:131],a[84:87],a[180:183],v[128:131]
s_lshl_b32 s7,s7,7
T a[226:227],v218,4096
v_mul_f32 v124,s58,v124
v_mul_f32 v125,s58,v125
v_mul_f32 v126,s58,v126
v_mul_f32 v127,s58,v127
M v[96:99],a[84:87],a[172:175],v[96:99]
s_add_u32 s78,s7,s52
T a[228:229],v218,8192
C v122,v124,v125
C v123,v126,v127
M v[96:99],a[244:247],a[168:171],v[96:99]
s_waitcnt lgkmcnt(5)
T a[230:231],v218,12288
v_mul_f32 v128,s58,v128
M v[100:103],a[88:91],a[168:171],v[100:103]
s_waitcnt vmcnt(7)
s_barrier
T a[232:233],v219,0
v_permlane16_swap_b32 v120,v122
v_permlane16_swap_b32 v121,v123
v_permlane16_swap_b32 v88,v90
v_mul_f32 v129,s58,v129
M v[100:103],a[92:95],a[172:175],v[100:103]
s_add_u32 s7,s6,8
T a[234:235],v219,4096
v_accvgpr_write_b32 a168,v120
v_accvgpr_write_b32 a169,v121
v_accvgpr_write_b32 a170,v122
v_accvgpr_write_b32 a171,v123
v_mul_f32 v96,s58,v96
v_mul_f32 v97,s58,v97
M v[132:135],a[92:95],a[180:183],v[132:135]
s_and_b32 s7,s7,7
T a[236:237],v219,8192
v_mul_f32 v98,s58,v98
M v[132:135],a[88:91],a[176:179],v[132:135]
s_lshl_b32 s7,s7,7
T a[238:239],v219,12288
v_mul_f32 v99,s58,v99
M v[8:11],a[36:39],v[164:167],v[8:11]
s_add_u32 s79,s7,s52
T a[240:241],v222,0
v_mul_f32 v100,s58,v100
M v[8:11],a[40:43],v[172:175],v[8:11]
s_add_u32 m0,s45,114688
T a[242:243],v222,4096
v_mul_f32 v101,s58,v101
M v[40:43],a[40:43],v[176:179],v[40:43]
s_add_u32 s24,s72,0
T a[244:245],v222,8192
v_mul_f32 v102,s58,v102
M v[40:43],a[36:39],v[168:171],v[40:43]
T a[246:247],v222,12288
v_mul_f32 v103,s58,v103
M v[144:147],a[44:47],a[96:99],v[196:199]
R a[84:87],v210,45056
C v96,v96,v97
M v[144:147],v[232:235],a[100:103],v[144:147]
R a[88:91],v211,45056
D v247,s[24:27],0
M v[144:147],a[248:251],a[104:107],v[144:147]
s_add_u32 s24,s72,7168
R a[92:95],v212,45056
C v97,v98,v99
M v[144:147],a[252:255],a[108:111],v[144:147]
R a[36:39],v213,45056
C v98,v100,v101
M v[148:151],a[252:255],a[124:127],v[200:203]
T a[40:41],v223,0
C v99,v102,v103
M v[148:151],a[248:251],a[120:123],v[148:151]
T a[42:43],v223,4096
v_mul_f32 v130,s58,v130
M v[148:151],v[232:235],a[116:119],v[148:151]
T v[232:233],v224,0
D v247,s[24:27],1024
M v[148:151],a[44:47],a[112:115],v[148:151]
s_add_u32 s24,s72,14336
T a[44:45],v223,8192
v_mul_f32 v131,s58,v131
M v[12:15],a[216:219],v[164:167],v[12:15]
s_waitcnt lgkmcnt(8)
T a[46:47],v223,12288
v_mul_f32 v132,s58,v132
M v[12:15],a[220:223],v[172:175],v[12:15]
T v[234:235],v224,4096
v_mul_f32 v133,s58,v133
M v[44:47],a[220:223],v[176:179],v[44:47]
T a[248:249],v224,8192
v_mul_f32 v134,s58,v134
M v[44:47],a[216:219],v[168:171],v[44:47]
T a[250:251],v224,12288
D v247,s[24:27],2048
M v[32:35],a[224:227],v[168:171],v[32:35]
s_add_u32 s24,s72,21504
T a[252:253],v225,0
v_mul_f32 v135,s58,v135
M v[32:35],a[228:231],v[176:179],v[32:35]
T a[254:255],v225,4096
v_accvgpr_write_b32 a152,v88
M v[0:3],a[228:231],v[172:175],v[0:3]
T a[216:217],v225,8192
v_accvgpr_write_b32 a154,v90
M v[0:3],a[224:227],v[164:167],v[0:3]
T a[218:219],v225,12288
C v128,v128,v129
M v[64:67],a[224:227],a[196:199],v[64:67]
R v[112:115],v210,0
D v247,s[24:27],3072
M v[64:67],a[228:231],a[200:203],v[64:67]
s_add_u32 m0,s45,81920
R v[116:119],v211,0
C v129,v130,v131
M v[4:7],a[232:235],v[164:167],v[4:7]
s_add_u32 s3,s64,393216
R v[120:123],v212,0
C v130,v132,v133
M v[4:7],a[236:239],v[172:175],v[4:7]
s_add_u32 s12,s3,s51
R v[124:127],v213,0
C v131,v134,v135
M v[36:39],a[236:239],v[176:179],v[36:39]
E v144
M v[36:39],a[232:235],v[168:171],v[36:39]
E v145
M v[68:71],a[232:235],a[196:199],v[68:71]
E v146
M v[68:71],a[236:239],a[200:203],v[68:71]
E v147
M v[16:19],a[240:243],v[164:167],v[16:19]
C v188,v144,v145
C v189,v146,v147
M v[16:19],a[244:247],v[172:175],v[16:19]
v_permlane16_swap_b32 v89,v91
M v[48:51],a[244:247],v[176:179],v[48:51]
v_accvgpr_write_b32 a153,v89
v_accvgpr_write_b32 a155,v91
M v[48:51],a[240:243],v[168:171],v[48:51]
s_waitcnt lgkmcnt(1)
v_permlane16_swap_b32 v96,v98
M v[152:155],a[84:87],a[96:99],v[196:199]
v_permlane16_swap_b32 v97,v99
M v[152:155],a[88:91],a[100:103],v[152:155]
v_accvgpr_write_b32 a156,v96
v_accvgpr_write_b32 a157,v97
M v[152:155],a[92:95],a[104:107],v[152:155]
v_accvgpr_write_b32 a158,v98
v_accvgpr_write_b32 a159,v99
M v[152:155],a[36:39],a[108:111],v[152:155]
v_permlane16_swap_b32 v128,v130
M v[156:159],a[36:39],a[124:127],v[200:203]
v_permlane16_swap_b32 v129,v131
M v[156:159],a[92:95],a[120:123],v[156:159]
E v148
M v[156:159],a[88:91],a[116:119],v[156:159]
E v149
M v[156:159],a[84:87],a[112:115],v[156:159]
E v150
M v[20:23],a[40:43],v[164:167],v[20:23]
E v151
M v[20:23],a[44:47],v[172:175],v[20:23]
v_accvgpr_write_b32 a172,v128
v_accvgpr_write_b32 a173,v129
M v[52:55],a[44:47],v[176:179],v[52:55]
v_accvgpr_write_b32 a174,v130
v_accvgpr_write_b32 a175,v131
M v[52:55],a[40:43],v[168:171],v[52:55]
R v[128:131],v214,0
C v192,v148,v149
M v[56:59],v[232:235],v[168:171],v[56:59]
R v[132:135],v215,0
C v193,v150,v151
M v[56:59],a[248:251],v[176:179],v[56:59]
E v152
M v[24:27],a[248:251],v[172:175],v[24:27]
E v153
M v[24:27],v[232:235],v[164:167],v[24:27]
E v154
M v[28:31],a[252:255],v[164:167],v[28:31]
E v155
M v[28:31],a[216:219],v[172:175],v[28:31]
E v156
M v[60:63],a[216:219],v[176:179],v[60:63]
s_waitcnt vmcnt(8)
s_barrier
R a[176:179],v244,0
Dn v254,s[12:15],0
E v157
E v158
E v159
M v[60:63],a[252:255],v[168:171],v[60:63]
R a[180:183],v251,0
R a[184:187],v252,0
C v190,v152,v153
C v191,v154,v155
C v194,v156,v157
C v195,v158,v159
v_xor_b32 v232,8224,v226
v_xor_b32 v233,12320,v226
M a[212:215],a[192:195],a[196:199],a[212:215]
R a[188:191],v253,0
Dn v255,s[12:15],1024
v_xor_b32 v251,1024,v244
v_xor_b32 v252,2048,v244
v_xor_b32 v234,64,v226
v_xor_b32 v235,4160,v226
M a[212:215],a[192:195],a[200:203],a[212:215]
R v[136:139],v216,0
v_xor_b32 v253,3072,v244
M a[204:207],a[192:195],v[164:167],a[204:207]
R v[140:143],v217,0
M a[204:207],a[192:195],v[172:175],a[204:207]
R a[132:135],v210,4096
M a[208:211],a[192:195],v[168:171],a[208:211]
R a[136:139],v211,4096
Dn v254,s[12:15],2048
M a[208:211],a[192:195],v[176:179],a[208:211]
R a[140:143],v212,4096
M v[144:147],v[112:115],a[144:147],0
R a[220:223],v213,4096
M v[144:147],v[116:119],a[148:151],v[144:147]
T a[224:225],v220,16384
M v[144:147],v[120:123],a[152:155],v[144:147]
s_waitcnt lgkmcnt(7)
T a[226:227],v220,20480
M v[144:147],v[124:127],a[156:159],v[144:147]
T a[228:229],v220,24576
Dn v255,s[12:15],3072
M v[148:151],v[124:127],a[172:175],0
s_add_u32 m0,s45,32768
T a[230:231],v220,28672
M v[148:151],v[120:123],a[168:171],v[148:151]
s_add_u32 s8,s66,393216
R a[196:199],v243,2048
M v[148:151],v[116:119],a[164:167],v[148:151]
R a[200:203],v243,3072
v_max3_f32 v196,v144,v145,v146
M v[148:151],v[112:115],a[160:163],v[148:151]
R a[232:235],v210,8192
v_max_f32 v196,v196,v147
M v[160:163],v[112:115],a[176:179],0
R a[236:239],v211,8192
Dn v245,s[8:11],0
M v[160:163],v[116:119],a[180:183],v[160:163]
R a[240:243],v212,8192
M v[160:163],v[120:123],a[184:187],v[160:163]
R a[244:247],v213,8192
v_max3_f32 v200,v148,v149,v150
M v[160:163],v[124:127],a[188:191],v[160:163]
T a[248:249],v221,16384
v_max_f32 v200,v200,v151
T a[250:251],v221,20480
R a[36:39],v251,4096
R a[40:43],v252,4096
R a[44:47],v253,4096
T a[252:253],v221,24576
v_xor_b32 v251,1024,v244
T a[254:255],v221,28672
v_max3_f32 v204,v160,v161,v162
v_xor_b32 v252,2048,v244
v_max_f32 v204,v204,v163
R a[84:87],v251,8192
s_cmp_lg_u32 s59,0
s_cbranch_scc1 L_mx3
L_mr3:
v_xor_b32 v253,3072,v244
v_mov_b32 v205,v204
v_mov_b32 v197,v196
v_mov_b32 v201,v200
v_permlane16_swap_b32 v204,v205
v_permlane16_swap_b32 v196,v197
v_max_f32 v204,v204,v205
v_max_f32 v196,v196,v197
v_mov_b32 v205,v204
v_mov_b32 v197,v196
v_permlane16_swap_b32 v200,v201
v_permlane32_swap_b32 v204,v205
v_permlane32_swap_b32 v196,v197
v_min_f32_e64 v204,-v204,-v205
v_min_f32_e64 v196,-v196,-v197
v_mov_b32 v205,v204
v_mov_b32 v206,v204
v_mov_b32 v207,v204
s_nop 1
M v[160:163],v[128:131],a[176:179],v[204:207]
Dn v246,s[8:11],1024
v_mov_b32 v197,v196
v_mov_b32 v198,v196
v_mov_b32 v199,v196
v_max_f32 v200,v200,v201
v_add_f32 v144,v144,v196
v_add_f32 v145,v145,v196
v_add_f32 v146,v146,v196
M v[160:163],v[132:135],a[180:183],v[160:163]
s_waitcnt lgkmcnt(0)
v_mov_b32 v201,v200
v_add_f32 v147,v147,v196
E v144
E v145
E v146
M v[160:163],v[136:139],a[184:187],v[160:163]
Dn v245,s[8:11],2048
v_permlane32_swap_b32 v200,v201
E v147
C v164,v144,v145
M v[160:163],v[140:143],a[188:191],v[160:163]
v_min_f32_e64 v200,-v200,-v201
C v165,v146,v147
M v[152:155],a[132:135],a[144:147],v[196:199]
v_mov_b32 v201,v200
v_mov_b32 v202,v200
v_mov_b32 v203,v200
v_add_f32 v148,v148,v200
v_add_f32 v149,v149,v200
v_add_f32 v150,v150,v200
v_add_f32 v151,v151,v200
M v[152:155],a[136:139],a[148:151],v[152:155]
R a[88:91],v252,8192
Dn v246,s[8:11],3072
E v148
E v149
E v150
M v[152:155],a[140:143],a[152:155],v[152:155]
s_add_u32 m0,s45,131072
R a[92:95],v253,8192
E v151
C v168,v148,v149
E v160
E v161
M v[152:155],a[220:223],a[156:159],v[152:155]
s_add_u32 s24,s72,131072
T a[216:217],v218,16384
C v169,v150,v151
E v162
E v163
C v208,v160,v161
M v[156:159],a[220:223],a[172:175],v[200:203]
T a[218:219],v218,20480
C v209,v162,v163
M v[156:159],a[140:143],a[168:171],v[156:159]
E v152
E v153
E v154
E v155
M v[156:159],a[136:139],a[164:167],v[156:159]
T v[112:113],v218,24576
C v166,v152,v153
C v167,v154,v155
M v[156:159],a[132:135],a[160:163],v[156:159]
ds_write_b64 v242,v[208:209] offset:0
M v[8:11],a[224:227],v[180:183],v[8:11]
T v[114:115],v218,28672
M v[8:11],a[228:231],v[188:191],v[8:11]
T v[116:117],v219,16384
M v[40:43],a[228:231],v[192:195],v[40:43]
T v[118:119],v219,20480
M v[40:43],a[224:227],v[184:187],v[40:43]
E v156
E v157
E v158
E v159
M a[212:215],a[192:195],a[196:199],a[212:215]
T v[120:121],v219,24576
C v170,v156,v157
C v171,v158,v159
M a[212:215],a[192:195],a[200:203],a[212:215]
T v[122:123],v219,28672
M a[204:207],a[192:195],v[180:183],a[204:207]
R v[124:127],v210,12288
M a[204:207],a[192:195],v[188:191],a[204:207]
R v[128:131],v211,12288
M a[208:211],a[192:195],v[184:187],a[208:211]
R v[132:135],v212,12288
M a[208:211],a[192:195],v[192:195],a[208:211]
R v[136:139],v213,12288
v_accvgpr_read_b32 v253,a212
M v[144:147],a[232:235],a[144:147],v[196:199]
s_waitcnt vmcnt(7) lgkmcnt(6)
s_barrier
T v[140:141],v222,16384
v_accvgpr_read_b32 v251,a204
M v[144:147],a[236:239],a[148:151],v[144:147]
v_add_f32 v250,v250,v251
v_accvgpr_read_b32 v252,a208
M v[144:147],a[240:243],a[152:155],v[144:147]
T v[142:143],v222,20480
v_add_f32 v250,v250,v252
v_rcp_f32 v251,v251
M v[144:147],a[244:247],a[156:159],v[144:147]
v_rcp_f32 v252,v252
v_add_f32 v250,v250,v253
v_mul_f32 v8,v251,v8
v_mul_f32 v9,v251,v9
v_mul_f32 v10,v251,v10
v_mul_f32 v11,v251,v11
M v[148:151],a[244:247],a[172:175],v[200:203]
v_rcp_f32 v253,v253
C v8,v8,v9
v_mul_f32 v40,v252,v40
v_mul_f32 v41,v252,v41
v_mul_f32 v42,v252,v42
v_mul_f32 v43,v252,v43
M v[148:151],a[240:243],a[168:171],v[148:151]
T a[132:133],v222,24576
E v144
E v145
E v146
C v9,v10,v11
M v[148:151],a[236:239],a[164:167],v[148:151]
T a[134:135],v222,28672
E v147
C v172,v144,v145
v_accvgpr_write_b32 a100,v8
v_accvgpr_write_b32 a101,v9
C v40,v40,v41
M v[148:151],a[232:235],a[160:163],v[148:151]
T a[136:137],v223,16384
D v247,s[24:27],0
C v173,v146,v147
C v41,v42,v43
v_accvgpr_write_b32 a116,v40
M v[12:15],a[248:251],v[180:183],v[12:15]
s_add_u32 s24,s72,138240
T a[138:139],v223,20480
v_accvgpr_write_b32 a117,v41
M v[12:15],a[252:255],v[188:191],v[12:15]
E v148
E v149
E v150
E v151
M v[44:47],a[252:255],v[192:195],v[44:47]
T a[140:141],v223,24576
D v247,s[24:27],1024
C v176,v148,v149
C v177,v150,v151
M v[44:47],a[248:251],v[184:187],v[44:47]
s_add_u32 s24,s72,145408
T a[142:143],v223,28672
v_mul_f32 v12,v251,v12
v_mul_f32 v13,v251,v13
v_mul_f32 v14,v251,v14
v_mul_f32 v15,v251,v15
M v[32:35],a[216:219],v[184:187],v[32:35]
T a[220:221],v224,16384
C v10,v12,v13
C v11,v14,v15
M v[32:35],v[112:115],v[192:195],v[32:35]
T a[222:223],v224,20480
D v247,s[24:27],2048
v_accvgpr_write_b32 a102,v10
v_accvgpr_write_b32 a103,v11
v_mul_f32 v44,v252,v44
v_mul_f32 v45,v252,v45
v_mul_f32 v46,v252,v46
v_mul_f32 v47,v252,v47
M v[0:3],v[112:115],v[188:191],v[0:3]
s_add_u32 s24,s72,152576
T a[224:225],v224,24576
C v42,v44,v45
C v43,v46,v47
v_mul_f32 v32,v252,v32
v_mul_f32 v33,v252,v33
v_mul_f32 v34,v252,v34
v_mul_f32 v35,v252,v35
M v[0:3],a[216:219],v[180:183],v[0:3]
T a[226:227],v224,28672
D v247,s[24:27],3072
v_accvgpr_write_b32 a118,v42
v_accvgpr_write_b32 a119,v43
C v32,v32,v33
M v[64:67],a[216:219],a[196:199],v[64:67]
s_add_u32 m0,s45,98304
T a[228:229],v225,16384
C v33,v34,v35
v_accvgpr_write_b32 a112,v32
M v[64:67],v[112:115],a[200:203],v[64:67]
s_add_u32 s3,s65,393216
T a[230:231],v225,20480
v_accvgpr_write_b32 a113,v33
v_mul_f32 v0,v251,v0
v_mul_f32 v1,v251,v1
v_mul_f32 v2,v251,v2
v_mul_f32 v3,v251,v3
M v[4:7],v[116:119],v[180:183],v[4:7]
s_waitcnt lgkmcnt(4)
T a[232:233],v225,24576
C v0,v0,v1
M v[4:7],v[120:123],v[188:191],v[4:7]
s_add_u32 s12,s3,s51
T a[234:235],v225,28672
C v1,v2,v3
v_accvgpr_write_b32 a96,v0
v_mul_f32 v64,v253,v64
v_mul_f32 v65,v253,v65
v_mul_f32 v66,v253,v66
v_mul_f32 v67,v253,v67
M v[36:39],v[120:123],v[192:195],v[36:39]
R a[236:239],v214,16384
v_mul_f32 v4,v251,v4
v_mul_f32 v5,v251,v5
v_mul_f32 v6,v251,v6
v_mul_f32 v7,v251,v7
v_accvgpr_write_b32 a97,v1
C v64,v64,v65
M v[36:39],v[116:119],v[184:187],v[36:39]
R a[240:243],v215,16384
C v2,v4,v5
M v[68:71],v[116:119],a[196:199],v[68:71]
R a[244:247],v216,16384
C v3,v6,v7
M v[68:71],v[120:123],a[200:203],v[68:71]
R a[248:251],v217,16384
v_accvgpr_write_b32 a98,v2
M v[152:155],v[124:127],a[144:147],v[196:199]
R a[252:255],v210,16384
v_mul_f32 v36,v252,v36
M v[152:155],v[128:131],a[148:151],v[152:155]
R a[216:219],v211,16384
v_mul_f32 v37,v252,v37
M v[152:155],v[132:135],a[152:155],v[152:155]
R v[112:115],v212,16384
v_mul_f32 v38,v252,v38
M v[152:155],v[136:139],a[156:159],v[152:155]
R v[116:119],v213,16384
v_mul_f32 v39,v252,v39
M v[156:159],v[136:139],a[172:175],v[200:203]
L_pg16:
s_cmp_eq_u32 s47,1
s_cbranch_scc1 L_bkB19_0
T v[120:121],v226,32768
C v34,v36,v37
M v[156:159],v[132:135],a[168:171],v[156:159]
T v[122:123],v226,34816
C v35,v38,v39
M v[156:159],v[128:131],a[164:167],v[156:159]
T v[128:129],v228,32768
v_accvgpr_write_b32 a114,v34
M v[156:159],v[124:127],a[160:163],v[156:159]
T v[124:125],v227,32768
v_accvgpr_write_b32 a115,v35
M v[16:19],v[140:143],v[180:183],v[16:19]
T v[126:127],v227,34816
v_accvgpr_write_b32 a99,v3
M v[16:19],a[132:135],v[188:191],v[16:19]
T v[130:131],v228,34816
v_mul_f32 v68,v253,v68
M v[48:51],a[132:135],v[192:195],v[48:51]
T v[132:133],v229,32768
v_mul_f32 v69,v253,v69
M v[48:51],v[140:143],v[184:187],v[48:51]
T v[134:135],v229,34816
v_mul_f32 v70,v253,v70
M v[52:55],a[136:139],v[184:187],v[52:55]
R v[136:139],v210,20480
v_mul_f32 v71,v253,v71
M v[52:55],a[140:143],v[192:195],v[52:55]
R v[140:143],v211,20480
C v65,v66,v67
M v[20:23],a[140:143],v[188:191],v[20:23]
R a[132:135],v212,20480
C v66,v68,v69
M v[20:23],a[136:139],v[180:183],v[20:23]
R a[136:139],v213,20480
C v67,v70,v71
M v[24:27],a[220:223],v[180:183],v[24:27]
s_waitcnt vmcnt(8) lgkmcnt(7)
s_barrier
T a[140:141],v230,32768
Dn v254,s[12:15],0
E v152
E v153
E v154
M v[24:27],a[224:227],v[188:191],v[24:27]
T a[142:143],v230,34816
E v155
C v174,v152,v153
E v156
E v157
M v[56:59],a[224:227],v[192:195],v[56:59]
Dn v255,s[12:15],1024
C v175,v154,v155
E v158
E v159
C v178,v156,v157
v_accvgpr_write_b32 a128,v64
M v[56:59],a[220:223],v[184:187],v[56:59]
T a[220:221],v231,32768
C v179,v158,v159
v_accvgpr_write_b32 a129,v65
v_accvgpr_write_b32 a130,v66
v_accvgpr_write_b32 a131,v67
v_mul_f32 v16,v251,v16
v_mul_f32 v17,v251,v17
v_mul_f32 v18,v251,v18
M v[60:63],a[228:231],v[184:187],v[60:63]
T a[222:223],v231,34816
Dn v254,s[12:15],2048
v_mul_f32 v19,v251,v19
v_mul_f32 v20,v251,v20
v_mul_f32 v21,v251,v21
v_mul_f32 v22,v251,v22
v_mul_f32 v23,v251,v23
C v16,v16,v17
M v[60:63],a[232:235],v[192:195],v[60:63]
T a[224:225],v232,32768
C v17,v18,v19
v_accvgpr_write_b32 a104,v16
v_mul_f32 v48,v252,v48
v_mul_f32 v49,v252,v49
v_mul_f32 v50,v252,v50
v_mul_f32 v51,v252,v51
v_mul_f32 v52,v252,v52
M v[28:31],a[232:235],v[188:191],v[28:31]
T a[226:227],v232,34816
Dn v255,s[12:15],3072
C v18,v20,v21
C v19,v22,v23
v_accvgpr_write_b32 a105,v17
v_mul_f32 v53,v252,v53
v_mul_f32 v54,v252,v54
v_mul_f32 v55,v252,v55
M v[28:31],a[228:231],v[180:183],v[28:31]
s_add_u32 m0,s45,0
T a[228:229],v233,32768
v_accvgpr_write_b32 a106,v18
v_accvgpr_write_b32 a107,v19
C v48,v48,v49
v_mul_f32 v56,v252,v56
v_mul_f32 v57,v252,v57
v_mul_f32 v58,v252,v58
v_mul_f32 v59,v252,v59
M v[160:163],a[236:239],a[176:179],v[204:207]
s_add_u32 s8,s67,393216
T a[230:231],v233,34816
C v49,v50,v51
v_accvgpr_write_b32 a120,v48
v_mul_f32 v60,v252,v60
v_mul_f32 v61,v252,v61
v_mul_f32 v62,v252,v62
v_mul_f32 v63,v252,v63
C v56,v56,v57
M v[160:163],a[240:243],a[180:183],v[160:163]
T a[232:233],v234,32768
Dn v245,s[8:11],0
C v50,v52,v53
C v51,v54,v55
v_accvgpr_write_b32 a121,v49
C v57,v58,v59
v_accvgpr_write_b32 a124,v56
v_mul_f32 v24,v251,v24
M v[160:163],a[244:247],a[184:187],v[160:163]
T a[234:235],v234,34816
v_accvgpr_write_b32 a122,v50
v_accvgpr_write_b32 a123,v51
C v58,v60,v61
C v59,v62,v63
v_accvgpr_write_b32 a125,v57
v_mul_f32 v25,v251,v25
v_mul_f32 v26,v251,v26
M v[160:163],a[248:251],a[188:191],v[160:163]
T a[236:237],v235,32768
Dn v246,s[8:11],1024
v_accvgpr_write_b32 a126,v58
v_accvgpr_write_b32 a127,v59
v_mul_f32 v27,v251,v27
v_mul_f32 v28,v251,v28
v_mul_f32 v29,v251,v29
v_mul_f32 v30,v251,v30
M v[144:147],a[252:255],a[144:147],v[196:199]
T a[238:239],v235,34816
v_mul_f32 v31,v251,v31
C v24,v24,v25
E v160
E v161
M v[144:147],a[216:219],a[148:151],v[144:147]
T a[240:241],v236,32768
Dn v245,s[8:11],2048
C v25,v26,v27
v_accvgpr_write_b32 a108,v24
M v[144:147],v[112:115],a[152:155],v[144:147]
T a[242:243],v236,34816
C v26,v28,v29
M v[144:147],v[116:119],a[156:159],v[144:147]
T a[244:245],v237,32768
C v27,v30,v31
M v[148:151],v[116:119],a[172:175],v[200:203]
T a[246:247],v237,34816
v_accvgpr_write_b32 a109,v25
M v[148:151],v[112:115],a[168:171],v[148:151]
T a[248:249],v220,0
Dn v246,s[8:11],3072
M v[148:151],a[216:219],a[164:167],v[148:151]
s_add_u32 m0,s45,81920
T a[250:251],v220,4096
v_accvgpr_write_b32 a110,v26
M v[148:151],a[252:255],a[160:163],v[148:151]
s_add_u32 s3,s66,393216
T a[252:253],v220,8192
v_accvgpr_write_b32 a111,v27
M v[72:75],v[120:123],a[0:3],0
s_add_u32 s12,s3,s51
T a[254:255],v220,12288
C v208,v160,v161
M v[72:75],v[124:127],a[4:7],v[72:75]
s_waitcnt lgkmcnt(7)
R a[216:219],v210,24576
v_xor_b32 v251,1024,v244
M v[72:75],v[128:131],a[8:11],v[72:75]
R v[112:115],v211,24576
v_xor_b32 v252,2048,v244
M v[72:75],v[132:135],a[12:15],v[72:75]
R a[196:199],v243,0
v_xor_b32 v253,3072,v244
M v[88:91],v[132:135],a[28:31],0
E v144
M v[88:91],v[128:131],a[24:27],v[88:91]
E v145
M v[88:91],v[124:127],a[20:23],v[88:91]
R a[200:203],v243,1024
C v180,v144,v145
M v[88:91],v[120:123],a[16:19],v[88:91]
E v146
M v[104:107],v[120:123],a[32:35],0
E v147
M v[104:107],v[124:127],a[36:39],v[104:107]
R v[116:119],v212,24576
C v181,v146,v147
M v[104:107],v[128:131],a[40:43],v[104:107]
E v148
M v[104:107],v[132:135],a[44:47],v[104:107]
E v149
M v[152:155],v[136:139],a[144:147],v[196:199]
R v[120:123],v213,24576
C v184,v148,v149
M v[152:155],v[140:143],a[148:151],v[152:155]
E v150
M v[152:155],a[132:135],a[152:155],v[152:155]
E v151
M v[152:155],a[136:139],a[156:159],v[152:155]
T v[124:125],v221,0
C v185,v150,v151
M v[156:159],a[136:139],a[172:175],v[200:203]
E v162
M v[156:159],a[132:135],a[168:171],v[156:159]
E v163
M v[156:159],v[140:143],a[164:167],v[156:159]
T v[126:127],v221,4096
C v209,v162,v163
M v[156:159],v[136:139],a[160:163],v[156:159]
E v152
M v[76:79],a[140:143],a[0:3],0
E v153
M v[76:79],a[220:223],a[4:7],v[76:79]
T v[128:129],v221,8192
C v182,v152,v153
M v[76:79],a[224:227],a[8:11],v[76:79]
E v154
M v[76:79],a[228:231],a[12:15],v[76:79]
E v155
M v[92:95],a[228:231],a[28:31],0
T v[130:131],v221,12288
C v183,v154,v155
M v[92:95],a[224:227],a[24:27],v[92:95]
E v156
M v[92:95],a[220:223],a[20:23],v[92:95]
E v157
M v[92:95],a[140:143],a[16:19],v[92:95]
T v[132:133],v218,0
C v186,v156,v157
M v[96:99],a[232:235],a[16:19],0
E v158
M v[96:99],a[236:239],a[20:23],v[96:99]
s_waitcnt lgkmcnt(3)
E v159
M v[96:99],a[240:243],a[24:27],v[96:99]
T v[134:135],v218,4096
C v187,v158,v159
M v[96:99],a[244:247],a[28:31],v[96:99]
ds_write_b64 v242,v[208:209] offset:2048
M v[80:83],a[244:247],a[12:15],0
s_waitcnt vmcnt(7)
s_barrier
T v[136:137],v218,8192
M v[80:83],a[240:243],a[8:11],v[80:83]
T v[138:139],v218,12288
M v[80:83],a[236:239],a[4:7],v[80:83]
T v[140:141],v219,0
M v[80:83],a[232:235],a[0:3],v[80:83]
T v[142:143],v219,4096
M v[8:11],a[248:251],v[164:167],0
T a[132:133],v219,8192
M v[8:11],a[252:255],v[172:175],v[8:11]
T a[134:135],v219,12288
M v[40:43],a[252:255],v[176:179],0
T a[136:137],v222,0
M v[40:43],a[248:251],v[168:171],v[40:43]
T a[138:139],v222,4096
M v[144:147],a[216:219],a[144:147],v[196:199]
T a[140:141],v222,8192
M v[144:147],v[112:115],a[148:151],v[144:147]
T a[142:143],v222,12288
M v[144:147],v[116:119],a[152:155],v[144:147]
R a[220:223],v210,28672
M v[144:147],v[120:123],a[156:159],v[144:147]
R a[224:227],v211,28672
M v[148:151],v[120:123],a[172:175],v[200:203]
R a[228:231],v212,28672
M v[148:151],v[116:119],a[168:171],v[148:151]
R a[232:235],v213,28672
M v[148:151],v[112:115],a[164:167],v[148:151]
T a[236:237],v223,0
M v[148:151],a[216:219],a[160:163],v[148:151]
E v144
E v145
E v146
E v147
M v[12:15],v[124:127],v[164:167],0
s_waitcnt lgkmcnt(5)
T a[238:239],v223,4096
C v188,v144,v145
C v189,v146,v147
M v[12:15],v[128:131],v[172:175],v[12:15]
E v148
E v149
E v150
M v[44:47],v[128:131],v[176:179],0
T a[240:241],v223,8192
C v192,v148,v149
M v[44:47],v[124:127],v[168:171],v[44:47]
E v151
M v[32:35],v[132:135],v[168:171],0
T a[242:243],v223,12288
C v193,v150,v151
M v[32:35],v[136:139],v[176:179],v[32:35]
T a[244:245],v224,0
M v[0:3],v[136:139],v[172:175],0
T a[246:247],v224,4096
M v[0:3],v[132:135],v[164:167],v[0:3]
T a[248:249],v224,8192
M v[64:67],v[132:135],a[196:199],0
T a[250:251],v224,12288
M v[64:67],v[136:139],a[200:203],v[64:67]
T a[252:253],v225,0
M v[4:7],v[140:143],v[164:167],0
T a[254:255],v225,4096
M v[4:7],a[132:135],v[172:175],v[4:7]
T a[216:217],v225,8192
M v[36:39],a[132:135],v[176:179],0
T a[218:219],v225,12288
M v[36:39],v[140:143],v[168:171],v[36:39]
R v[112:115],v214,32768
M v[68:71],v[140:143],a[196:199],0
R v[116:119],v215,32768
M v[68:71],a[132:135],a[200:203],v[68:71]
R v[120:123],v216,32768
M v[16:19],a[136:139],v[164:167],0
R v[124:127],v217,32768
M v[16:19],a[140:143],v[172:175],v[16:19]
R v[128:131],v210,32768
M v[48:51],a[140:143],v[176:179],0
R v[132:135],v211,32768
M v[48:51],a[136:139],v[168:171],v[48:51]
s_waitcnt lgkmcnt(8)
R v[136:139],v212,32768
M v[152:155],a[220:223],a[144:147],v[196:199]
R v[140:143],v213,32768
M v[152:155],a[224:227],a[148:151],v[152:155]
T a[132:133],v238,32768
M v[152:155],a[228:231],a[152:155],v[152:155]
T a[134:135],v238,34816
M v[152:155],a[232:235],a[156:159],v[152:155]
T a[136:137],v239,32768
M v[156:159],a[232:235],a[172:175],v[200:203]
T a[138:139],v239,34816
M v[156:159],a[228:231],a[168:171],v[156:159]
T a[140:141],v240,32768
M v[156:159],a[224:227],a[164:167],v[156:159]
T a[142:143],v240,34816
M v[156:159],a[220:223],a[160:163],v[156:159]
E v152
M v[20:23],a[236:239],v[164:167],0
E v153
M v[20:23],a[240:243],v[172:175],v[20:23]
T a[220:221],v241,32768
C v190,v152,v153
M v[52:55],a[240:243],v[176:179],0
E v154
M v[52:55],a[236:239],v[168:171],v[52:55]
E v155
M v[56:59],a[244:247],v[168:171],0
T a[222:223],v241,34816
C v191,v154,v155
M v[56:59],a[248:251],v[176:179],v[56:59]
E v156
M v[24:27],a[248:251],v[172:175],0
E v157
M v[24:27],a[244:247],v[164:167],v[24:27]
R a[224:227],v210,36864
C v194,v156,v157
M v[28:31],a[252:255],v[164:167],0
s_waitcnt lgkmcnt(3)
E v158
M v[28:31],a[216:219],v[172:175],v[28:31]
E v159
M v[60:63],a[216:219],v[176:179],0
s_waitcnt vmcnt(4)
s_barrier
R a[228:231],v211,36864
Dn v254,s[12:15],0
C v195,v158,v159
M v[60:63],a[252:255],v[168:171],v[60:63]
ds_write_b128 v244,a[128:131] offset:0
M a[212:215],a[192:195],a[196:199],0
R a[232:235],v212,36864
M a[212:215],a[192:195],a[200:203],a[212:215]
R a[236:239],v213,36864
M a[204:207],a[192:195],v[164:167],0
T a[240:241],v226,49152
Dn v255,s[12:15],1024
M a[204:207],a[192:195],v[172:175],a[204:207]
T a[242:243],v226,51200
M a[208:211],a[192:195],v[168:171],0
T a[244:245],v227,49152
M a[208:211],a[192:195],v[176:179],a[208:211]
T a[246:247],v227,51200
M v[160:163],v[112:115],a[176:179],v[204:207]
T a[248:249],v228,49152
M v[160:163],v[116:119],a[180:183],v[160:163]
T a[250:251],v228,51200
Dn v254,s[12:15],2048
M v[160:163],v[120:123],a[184:187],v[160:163]
T a[252:253],v229,49152
M v[160:163],v[124:127],a[188:191],v[160:163]
T a[254:255],v229,51200
M v[144:147],v[128:131],a[144:147],v[196:199]
T a[216:217],v220,16384
M v[144:147],v[132:135],a[148:151],v[144:147]
T a[218:219],v220,20480
M v[144:147],v[136:139],a[152:155],v[144:147]
T v[112:113],v220,24576
Dn v255,s[12:15],3072
M v[144:147],v[140:143],a[156:159],v[144:147]
s_add_u32 m0,s45,16384
E v160
E v161
E v162
E v163
M v[148:151],v[140:143],a[172:175],v[200:203]
s_add_u32 s8,s68,393216
T v[114:115],v220,28672
C v208,v160,v161
C v209,v162,v163
M v[148:151],v[136:139],a[168:171],v[148:151]
R v[116:119],v210,40960
Dn v245,s[8:11],0
E v144
E v145
E v146
M v[148:151],v[132:135],a[164:167],v[148:151]
R v[120:123],v211,40960
E v147
C v164,v144,v145
M v[148:151],v[128:131],a[160:163],v[148:151]
R v[124:127],v212,40960
C v165,v146,v147
M v[84:87],a[132:135],a[0:3],0
R v[128:131],v213,40960
Dn v246,s[8:11],1024
M v[84:87],a[136:139],a[4:7],v[84:87]
ds_write_b64 v242,v[208:209] offset:0
M v[84:87],a[140:143],a[8:11],v[84:87]
s_waitcnt lgkmcnt(5)
E v148
E v149
E v150
E v151
M v[84:87],a[220:223],a[12:15],v[84:87]
T v[132:133],v221,16384
Dn v245,s[8:11],2048
C v168,v148,v149
C v169,v150,v151
M v[100:103],a[220:223],a[28:31],0
T v[134:135],v221,20480
M v[100:103],a[140:143],a[24:27],v[100:103]
T v[136:137],v221,24576
M v[100:103],a[136:139],a[20:23],v[100:103]
T v[138:139],v221,28672
M v[100:103],a[132:135],a[16:19],v[100:103]
R a[196:199],v243,2048
Dn v246,s[8:11],3072
M v[152:155],a[224:227],a[144:147],v[196:199]
s_add_u32 m0,s45,114688
R a[200:203],v243,3072
M v[152:155],a[228:231],a[148:151],v[152:155]
s_add_u32 s24,s73,0
T v[140:141],v218,16384
M v[152:155],a[232:235],a[152:155],v[152:155]
T v[142:143],v218,20480
M v[152:155],a[236:239],a[156:159],v[152:155]
T a[132:133],v218,24576
M v[156:159],a[236:239],a[172:175],v[200:203]
T a[134:135],v218,28672
M v[156:159],a[232:235],a[168:171],v[156:159]
T a[136:137],v219,16384
M v[156:159],a[228:231],a[164:167],v[156:159]
T a[138:139],v219,20480
M v[156:159],a[224:227],a[160:163],v[156:159]
E v152
E v153
E v154
E v155
M v[72:75],a[240:243],a[48:51],v[72:75]
T a[140:141],v219,24576
C v166,v152,v153
C v167,v154,v155
M v[72:75],a[244:247],a[52:55],v[72:75]
E v156
E v157
E v158
E v159
M v[72:75],a[248:251],a[56:59],v[72:75]
T a[142:143],v219,28672
C v170,v156,v157
C v171,v158,v159
M v[72:75],a[252:255],a[60:63],v[72:75]
T a[220:221],v222,16384
M v[88:91],a[252:255],a[76:79],v[88:91]
T a[222:223],v222,20480
M v[88:91],a[248:251],a[72:75],v[88:91]
T a[224:225],v222,24576
M v[88:91],a[244:247],a[68:71],v[88:91]
T a[226:227],v222,28672
M v[88:91],a[240:243],a[64:67],v[88:91]
R a[228:231],v210,45056
M v[104:107],a[240:243],a[80:83],v[104:107]
R a[232:235],v211,45056
M v[104:107],a[244:247],a[84:87],v[104:107]
R a[236:239],v212,45056
M v[104:107],a[248:251],a[88:91],v[104:107]
R a[240:243],v213,45056
M v[104:107],a[252:255],a[92:95],v[104:107]
T a[244:245],v223,16384
M v[8:11],a[216:219],v[180:183],v[8:11]
T a[246:247],v223,20480
M v[8:11],v[112:115],v[188:191],v[8:11]
T a[248:249],v223,24576
M v[40:43],v[112:115],v[192:195],v[40:43]
T a[250:251],v223,28672
M v[40:43],a[216:219],v[184:187],v[40:43]
s_waitcnt lgkmcnt(8)
T a[252:253],v224,16384
M v[144:147],v[116:119],a[144:147],v[196:199]
s_waitcnt vmcnt(7)
s_barrier
T a[254:255],v224,20480
M v[144:147],v[120:123],a[148:151],v[144:147]
T a[216:217],v224,24576
M v[144:147],v[124:127],a[152:155],v[144:147]
T a[218:219],v224,28672
M v[144:147],v[128:131],a[156:159],v[144:147]
T v[112:113],v225,16384
M v[148:151],v[128:131],a[172:175],v[200:203]
T v[114:115],v225,20480
M v[148:151],v[124:127],a[168:171],v[148:151]
M v[148:151],v[120:123],a[164:167],v[148:151]
M v[148:151],v[116:119],a[160:163],v[148:151]
T v[116:117],v225,24576
M v[12:15],v[132:135],v[180:183],v[12:15]
E v144
E v145
E v146
E v147
M v[12:15],v[136:139],v[188:191],v[12:15]
T v[118:119],v225,28672
C v172,v144,v145
C v173,v146,v147
M v[44:47],v[136:139],v[192:195],v[44:47]
D v247,s[24:27],0
E v148
E v149
E v150
M v[44:47],v[132:135],v[184:187],v[44:47]
s_add_u32 s24,s73,7168
E v151
C v176,v148,v149
M v[32:35],v[140:143],v[184:187],v[32:35]
C v177,v150,v151
M v[32:35],a[132:135],v[192:195],v[32:35]
D v247,s[24:27],1024
M v[0:3],a[132:135],v[188:191],v[0:3]
s_add_u32 s24,s73,14336
M v[0:3],v[140:143],v[180:183],v[0:3]
M v[64:67],v[140:143],a[196:199],v[64:67]
M v[64:67],a[132:135],a[200:203],v[64:67]
D v247,s[24:27],2048
M v[4:7],a[136:139],v[180:183],v[4:7]
s_add_u32 s24,s73,21504
M v[4:7],a[140:143],v[188:191],v[4:7]
M v[36:39],a[140:143],v[192:195],v[36:39]
M v[36:39],a[136:139],v[184:187],v[36:39]
D v247,s[24:27],3072
M v[68:71],a[136:139],a[196:199],v[68:71]
s_add_u32 m0,s45,98304
M v[68:71],a[140:143],a[200:203],v[68:71]
L_pg17:
s_cmp_eq_u32 s47,1
s_cbranch_scc1 L_bkB19_0
s_add_u32 s3,s67,393216
M v[16:19],a[220:223],v[180:183],v[16:19]
s_add_u32 s12,s3,s51
M v[16:19],a[224:227],v[188:191],v[16:19]
M v[48:51],a[224:227],v[192:195],v[48:51]
R a[224:227],v215,0
M v[48:51],a[220:223],v[184:187],v[48:51]
s_waitcnt lgkmcnt(1)
R a[220:223],v214,0
M v[152:155],a[228:231],a[144:147],v[196:199]
M v[152:155],a[232:235],a[148:151],v[152:155]
M v[152:155],a[236:239],a[152:155],v[152:155]
M v[152:155],a[240:243],a[156:159],v[152:155]
M v[156:159],a[240:243],a[172:175],v[200:203]
R a[240:243],v211,0
M v[156:159],a[236:239],a[168:171],v[156:159]
R a[236:239],v210,0
M v[156:159],a[232:235],a[164:167],v[156:159]
R a[232:235],v217,0
M v[156:159],a[228:231],a[160:163],v[156:159]
R a[228:231],v216,0
M v[20:23],a[244:247],v[180:183],v[20:23]
E v152
E v153
E v154
E v155
M v[20:23],a[248:251],v[188:191],v[20:23]
C v174,v152,v153
C v175,v154,v155
M v[52:55],a[248:251],v[192:195],v[52:55]
E v156
E v157
E v158
E v159
M v[52:55],a[244:247],v[184:187],v[52:55]
R a[244:247],v212,0
C v178,v156,v157
C v179,v158,v159
M v[56:59],a[252:255],v[184:187],v[56:59]
R a[248:251],v213,0
M v[56:59],a[216:219],v[192:195],v[56:59]
M v[24:27],a[216:219],v[188:191],v[24:27]
T a[216:217],v231,49152
M v[24:27],a[252:255],v[180:183],v[24:27]
T a[252:253],v230,49152
M v[28:31],v[112:115],v[180:183],v[28:31]
T a[254:255],v230,51200
M v[28:31],v[116:119],v[188:191],v[28:31]
T a[218:219],v231,51200
M v[60:63],v[116:119],v[192:195],v[60:63]
s_waitcnt vmcnt(8)
s_barrier
R a[132:135],v251,0
Dn v254,s[12:15],0
M v[60:63],v[112:115],v[184:187],v[60:63]
R a[136:139],v252,0
M a[212:215],a[192:195],a[196:199],a[212:215]
R a[140:143],v253,0
M a[212:215],a[192:195],a[200:203],a[212:215]
R a[196:199],v243,0
M a[204:207],a[192:195],v[180:183],a[204:207]
R a[200:203],v243,1024
M a[204:207],a[192:195],v[188:191],a[204:207]
Dn v255,s[12:15],1024
M a[208:211],a[192:195],v[184:187],a[208:211]
M a[208:211],a[192:195],v[192:195],a[208:211]
s_waitcnt lgkmcnt(5)
M v[160:163],a[220:223],a[176:179],v[204:207]
T a[220:221],v232,49152
T a[222:223],v232,51200
M v[160:163],a[224:227],a[180:183],v[160:163]
T a[224:225],v233,49152
Dn v254,s[12:15],2048
M v[160:163],a[228:231],a[184:187],v[160:163]
T a[226:227],v233,51200
T a[228:229],v234,49152
M v[160:163],a[232:235],a[188:191],v[160:163]
T a[230:231],v234,51200
M v[144:147],a[236:239],a[144:147],v[196:199]
T a[232:233],v235,49152
T a[234:235],v235,51200
M v[144:147],a[240:243],a[148:151],v[144:147]
M v[144:147],a[244:247],a[152:155],v[144:147]
Dn v255,s[12:15],3072
M v[144:147],a[248:251],a[156:159],v[144:147]
s_add_u32 m0,s45,32768
E v160
E v161
E v162
E v163
M v[148:151],a[248:251],a[172:175],v[200:203]
s_add_u32 s8,s69,393216
R a[248:251],v211,4096
C v208,v160,v161
C v209,v162,v163
M v[148:151],a[244:247],a[168:171],v[148:151]
R a[244:247],v210,4096
Dn v245,s[8:11],0
E v144
E v145
E v146
M v[148:151],a[240:243],a[164:167],v[148:151]
T a[240:241],v237,49152
T a[242:243],v237,51200
E v147
C v180,v144,v145
M v[148:151],a[236:239],a[160:163],v[148:151]
T a[236:237],v236,49152
Dn v246,s[8:11],1024
C v181,v146,v147
M v[76:79],a[252:255],a[48:51],v[76:79]
T a[238:239],v236,51200
M v[76:79],a[216:219],a[52:55],v[76:79]
s_waitcnt lgkmcnt(6)
ds_write_b64 v242,v[208:209] offset:2048
M v[76:79],a[220:223],a[56:59],v[76:79]
E v148
E v149
E v150
E v151
M v[76:79],a[224:227],a[60:63],v[76:79]
Dn v245,s[8:11],2048
C v184,v148,v149
C v185,v150,v151
M v[92:95],a[224:227],a[76:79],v[92:95]
T a[224:225],v239,49152
M v[92:95],a[220:223],a[72:75],v[92:95]
T a[220:221],v238,49152
M v[92:95],a[216:219],a[68:71],v[92:95]
R a[216:219],v213,4096
T a[222:223],v238,51200
M v[92:95],a[252:255],a[64:67],v[92:95]
R a[252:255],v212,4096
Dn v246,s[8:11],3072
M v[96:99],a[228:231],a[64:67],v[96:99]
s_add_u32 m0,s45,131072
T a[226:227],v239,51200
M v[96:99],a[232:235],a[68:71],v[96:99]
s_waitcnt lgkmcnt(6)
s_add_u32 s24,s72,262144
M v[96:99],a[236:239],a[72:75],v[96:99]
M v[96:99],a[240:243],a[76:79],v[96:99]
M v[80:83],a[240:243],a[60:63],v[80:83]
T a[240:241],v220,8192
M v[80:83],a[236:239],a[56:59],v[80:83]
T a[236:237],v220,0
T a[238:239],v220,4096
M v[80:83],a[232:235],a[52:55],v[80:83]
T a[232:233],v241,49152
M v[80:83],a[228:231],a[48:51],v[80:83]
T a[228:229],v240,49152
T a[230:231],v240,51200
M v[152:155],a[244:247],a[144:147],v[196:199]
T a[234:235],v241,51200
M v[152:155],a[248:251],a[148:151],v[152:155]
s_waitcnt lgkmcnt(7)
T a[242:243],v220,12288
M v[152:155],a[252:255],a[152:155],v[152:155]
M v[152:155],a[216:219],a[156:159],v[152:155]
M v[156:159],a[216:219],a[172:175],v[200:203]
R a[216:219],v213,8192
M v[156:159],a[252:255],a[168:171],v[156:159]
R a[252:255],v212,8192
M v[156:159],a[248:251],a[164:167],v[156:159]
R a[248:251],v211,8192
M v[156:159],a[244:247],a[160:163],v[156:159]
R a[244:247],v210,8192
M v[84:87],a[220:223],a[48:51],v[84:87]
E v152
E v153
E v154
E v155
M v[84:87],a[224:227],a[52:55],v[84:87]
s_waitcnt lgkmcnt(4)
C v182,v152,v153
C v183,v154,v155
M v[84:87],a[228:231],a[56:59],v[84:87]
E v156
E v157
E v158
E v159
M v[84:87],a[232:235],a[60:63],v[84:87]
C v186,v156,v157
C v187,v158,v159
M v[100:103],a[232:235],a[76:79],v[100:103]
s_mov_b32 s47,1
s_cmp_eq_u32 s44,0
s_cbranch_scc1 L_pg24
s_cmp_eq_u32 s44,1
s_cbranch_scc1 L_pg25
L_bkB27_0:
s_mov_b32 s47,0
s_waitcnt vmcnt(7)
s_barrier
T a[232:233],v218,8192
M v[100:103],a[228:231],a[72:75],v[100:103]
T a[228:229],v218,0
M v[100:103],a[224:227],a[68:71],v[100:103]
T a[224:225],v221,8192
T a[226:227],v221,12288
M v[100:103],a[220:223],a[64:67],v[100:103]
T a[220:221],v221,0
M v[8:11],a[236:239],v[164:167],v[8:11]
T a[222:223],v221,4096
T a[230:231],v218,4096
M v[8:11],a[240:243],v[172:175],v[8:11]
T a[234:235],v218,12288
M v[40:43],a[240:243],v[176:179],v[40:43]
T a[240:241],v219,8192
M v[40:43],a[236:239],v[168:171],v[40:43]
s_waitcnt lgkmcnt(9)
T a[236:237],v219,0
M v[144:147],a[244:247],a[144:147],v[196:199]
T a[238:239],v219,4096
M v[144:147],a[248:251],a[148:151],v[144:147]
T a[242:243],v219,12288
M v[144:147],a[252:255],a[152:155],v[144:147]
M v[144:147],a[216:219],a[156:159],v[144:147]
M v[148:151],a[216:219],a[172:175],v[200:203]
R a[216:219],v211,12288
D v247,s[24:27],0
M v[148:151],a[252:255],a[168:171],v[148:151]
s_add_u32 s24,s72,269312
R a[252:255],v210,12288
M v[148:151],a[248:251],a[164:167],v[148:151]
T a[248:249],v222,8192
M v[148:151],a[244:247],a[160:163],v[148:151]
s_waitcnt lgkmcnt(6)
T a[244:245],v222,0
T a[246:247],v222,4096
E v144
E v145
E v146
M v[12:15],a[220:223],v[164:167],v[12:15]
T a[250:251],v222,12288
D v247,s[24:27],1024
E v147
C v188,v144,v145
M v[12:15],a[224:227],v[172:175],v[12:15]
s_add_u32 s24,s72,276480
C v189,v146,v147
E v148
E v149
M v[44:47],a[224:227],v[176:179],v[44:47]
R a[224:227],v213,12288
C v192,v148,v149
M v[44:47],a[220:223],v[168:171],v[44:47]
R a[220:223],v212,12288
D v247,s[24:27],2048
M v[32:35],a[228:231],v[168:171],v[32:35]
s_add_u32 s24,s72,283648
E v150
M v[32:35],a[232:235],v[176:179],v[32:35]
E v151
M v[0:3],a[232:235],v[172:175],v[0:3]
C v193,v150,v151
M v[0:3],a[228:231],v[164:167],v[0:3]
M v[64:67],a[228:231],a[196:199],v[64:67]
T a[228:229],v223,0
D v247,s[24:27],3072
M v[64:67],a[232:235],a[200:203],v[64:67]
s_waitcnt lgkmcnt(3)
s_add_u32 m0,s45,81920
T a[230:231],v223,4096
M v[4:7],a[236:239],v[164:167],v[4:7]
s_add_u32 s3,s68,393216
T a[232:233],v223,8192
M v[4:7],a[240:243],v[172:175],v[4:7]
s_add_u32 s12,s3,s51
T a[234:235],v223,12288
M v[36:39],a[240:243],v[176:179],v[36:39]
M v[36:39],a[236:239],v[168:171],v[36:39]
M v[68:71],a[236:239],a[196:199],v[68:71]
T a[236:237],v224,0
M v[68:71],a[240:243],a[200:203],v[68:71]
T a[238:239],v224,4096
M v[16:19],a[244:247],v[164:167],v[16:19]
T a[240:241],v224,8192
T a[242:243],v224,12288
M v[16:19],a[248:251],v[172:175],v[16:19]
M v[48:51],a[248:251],v[176:179],v[48:51]
T a[248:249],v225,8192
M v[48:51],a[244:247],v[168:171],v[48:51]
T a[244:245],v225,0
T a[246:247],v225,4096
M v[152:155],a[252:255],a[144:147],v[196:199]
T a[250:251],v225,12288
M v[152:155],a[216:219],a[148:151],v[152:155]
s_waitcnt lgkmcnt(8)
M v[152:155],a[220:223],a[152:155],v[152:155]
M v[152:155],a[224:227],a[156:159],v[152:155]
M v[156:159],a[224:227],a[172:175],v[200:203]
R a[224:227],v217,16384
M v[156:159],a[220:223],a[168:171],v[156:159]
R a[220:223],v216,16384
M v[156:159],a[216:219],a[164:167],v[156:159]
R a[216:219],v215,16384
M v[156:159],a[252:255],a[160:163],v[156:159]
R a[252:255],v214,16384
M v[20:23],a[228:231],v[164:167],v[20:23]
E v152
M v[20:23],a[232:235],v[172:175],v[20:23]
E v153
M v[52:55],a[232:235],v[176:179],v[52:55]
R a[232:235],v211,16384
C v190,v152,v153
M v[52:55],a[228:231],v[168:171],v[52:55]
s_waitcnt lgkmcnt(5)
E v154
M v[56:59],a[236:239],v[168:171],v[56:59]
E v155
M v[56:59],a[240:243],v[176:179],v[56:59]
R a[228:231],v210,16384
C v191,v154,v155
M v[24:27],a[240:243],v[172:175],v[24:27]
E v156
M v[24:27],a[236:239],v[164:167],v[24:27]
R a[236:239],v212,16384
M v[28:31],a[244:247],v[164:167],v[28:31]
E v157
M v[28:31],a[248:251],v[172:175],v[28:31]
R a[240:243],v213,16384
C v194,v156,v157
M v[60:63],a[248:251],v[176:179],v[60:63]
s_waitcnt vmcnt(8)
s_barrier
T a[248:249],v227,32768
Dn v254,s[12:15],0
E v158
E v159
M v[60:63],a[244:247],v[168:171],v[60:63]
T a[244:245],v226,32768
C v195,v158,v159
M a[212:215],a[192:195],a[196:199],a[212:215]
T a[246:247],v226,34816
M a[212:215],a[192:195],a[200:203],a[212:215]
T a[250:251],v227,34816
M a[204:207],a[192:195],v[164:167],a[204:207]
R a[196:199],v243,2048
Dn v255,s[12:15],1024
M a[204:207],a[192:195],v[172:175],a[204:207]
R a[200:203],v243,3072
M a[208:211],a[192:195],v[168:171],a[208:211]
M a[208:211],a[192:195],v[176:179],a[208:211]
s_waitcnt lgkmcnt(6)
M v[160:163],a[252:255],a[176:179],v[204:207]
T a[252:253],v228,32768
T a[254:255],v228,34816
M v[160:163],a[216:219],a[180:183],v[160:163]
T a[216:217],v229,32768
Dn v254,s[12:15],2048
M v[160:163],a[220:223],a[184:187],v[160:163]
T a[218:219],v229,34816
M v[160:163],a[224:227],a[188:191],v[160:163]
T a[220:221],v230,32768
M v[144:147],a[228:231],a[144:147],v[196:199]
T a[222:223],v230,34816
M v[144:147],a[232:235],a[148:151],v[144:147]
T a[224:225],v231,32768
M v[144:147],a[236:239],a[152:155],v[144:147]
T a[226:227],v231,34816
Dn v255,s[12:15],3072
M v[144:147],a[240:243],a[156:159],v[144:147]
s_add_u32 m0,s45,0
E v160
E v161
E v162
E v163
M v[148:151],a[240:243],a[172:175],v[200:203]
s_add_u32 s8,s70,393216
R a[240:243],v211,20480
C v208,v160,v161
C v209,v162,v163
M v[148:151],a[236:239],a[168:171],v[148:151]
R a[236:239],v210,20480
Dn v245,s[8:11],0
E v144
E v145
E v146
M v[148:151],a[232:235],a[164:167],v[148:151]
T a[232:233],v233,32768
T a[234:235],v233,34816
E v147
C v164,v144,v145
M v[148:151],a[228:231],a[160:163],v[148:151]
s_waitcnt lgkmcnt(4)
T a[228:229],v232,32768
Dn v246,s[8:11],1024
C v165,v146,v147
M v[108:111],a[244:247],a[0:3],0
ds_write_b64 v242,v[208:209] offset:0
M v[108:111],a[248:251],a[4:7],v[108:111]
T a[230:231],v232,34816
M v[108:111],a[252:255],a[8:11],v[108:111]
E v148
E v149
E v150
E v151
M v[108:111],a[216:219],a[12:15],v[108:111]
Dn v245,s[8:11],2048
C v168,v148,v149
C v169,v150,v151
M v[124:127],a[216:219],a[28:31],0
M v[124:127],a[252:255],a[24:27],v[124:127]
M v[124:127],a[248:251],a[20:23],v[124:127]
M v[124:127],a[244:247],a[16:19],v[124:127]
Dn v246,s[8:11],3072
M v[140:143],a[244:247],a[32:35],0
s_add_u32 m0,s45,114688
R a[244:247],v212,20480
M v[140:143],a[248:251],a[36:39],v[140:143]
s_add_u32 s24,s73,131072
R a[248:251],v213,20480
M v[140:143],a[252:255],a[40:43],v[140:143]
T a[252:253],v234,32768
T a[254:255],v234,34816
M v[140:143],a[216:219],a[44:47],v[140:143]
T a[216:217],v235,32768
M v[112:115],a[220:223],a[0:3],0
T a[218:219],v235,34816
M v[112:115],a[224:227],a[4:7],v[112:115]
s_waitcnt lgkmcnt(6)
M v[112:115],a[228:231],a[8:11],v[112:115]
M v[112:115],a[232:235],a[12:15],v[112:115]
M v[128:131],a[232:235],a[28:31],0
T a[232:233],v239,32768
M v[128:131],a[228:231],a[24:27],v[128:131]
T a[228:229],v238,32768
M v[128:131],a[224:227],a[20:23],v[128:131]
T a[224:225],v237,32768
T a[226:227],v237,34816
M v[128:131],a[220:223],a[16:19],v[128:131]
T a[220:221],v236,32768
T a[222:223],v236,34816
M v[152:155],a[236:239],a[144:147],v[196:199]
T a[230:231],v238,34816
M v[152:155],a[240:243],a[148:151],v[152:155]
s_waitcnt lgkmcnt(7)
T a[234:235],v239,34816
M v[152:155],a[244:247],a[152:155],v[152:155]
M v[152:155],a[248:251],a[156:159],v[152:155]
M v[156:159],a[248:251],a[172:175],v[200:203]
T a[248:249],v220,24576
M v[156:159],a[244:247],a[168:171],v[156:159]
T a[244:245],v220,16384
M v[156:159],a[240:243],a[164:167],v[156:159]
T a[240:241],v241,32768
T a[242:243],v241,34816
M v[156:159],a[236:239],a[160:163],v[156:159]
T a[236:237],v240,32768
T a[238:239],v240,34816
E v152
E v153
E v154
M v[116:119],a[252:255],a[0:3],0
T a[246:247],v220,20480
E v155
C v166,v152,v153
M v[116:119],a[216:219],a[4:7],v[116:119]
s_waitcnt lgkmcnt(7)
T a[250:251],v220,28672
C v167,v154,v155
E v156
E v157
E v158
M v[116:119],a[220:223],a[8:11],v[116:119]
E v159
C v170,v156,v157
M v[116:119],a[224:227],a[12:15],v[116:119]
C v171,v158,v159
M v[132:135],a[224:227],a[28:31],0
R a[224:227],v213,24576
M v[132:135],a[220:223],a[24:27],v[132:135]
R a[220:223],v212,24576
M v[132:135],a[216:219],a[20:23],v[132:135]
R a[216:219],v211,24576
M v[132:135],a[252:255],a[16:19],v[132:135]
R a[252:255],v210,24576
M v[136:139],a[228:231],a[16:19],0
s_waitcnt vmcnt(7) lgkmcnt(4)
s_barrier
M v[136:139],a[232:235],a[20:23],v[136:139]
M v[136:139],a[236:239],a[24:27],v[136:139]
M v[136:139],a[240:243],a[28:31],v[136:139]
M v[120:123],a[240:243],a[12:15],0
T a[240:241],v218,24576
M v[120:123],a[236:239],a[8:11],v[120:123]
T a[236:237],v218,16384
M v[120:123],a[232:235],a[4:7],v[120:123]
T a[232:233],v221,24576
T a[234:235],v221,28672
M v[120:123],a[228:231],a[0:3],v[120:123]
T a[228:229],v221,16384
M v[8:11],a[244:247],v[180:183],v[8:11]
T a[230:231],v221,20480
T a[238:239],v218,20480
M v[8:11],a[248:251],v[188:191],v[8:11]
T a[242:243],v218,28672
M v[40:43],a[248:251],v[192:195],v[40:43]
T a[248:249],v219,24576
M v[40:43],a[244:247],v[184:187],v[40:43]
s_waitcnt lgkmcnt(9)
T a[244:245],v219,16384
M v[144:147],a[252:255],a[144:147],v[196:199]
T a[246:247],v219,20480
D v247,s[24:27],0
M v[144:147],a[216:219],a[148:151],v[144:147]
s_add_u32 s24,s73,138240
T a[250:251],v219,28672
M v[144:147],a[220:223],a[152:155],v[144:147]
M v[144:147],a[224:227],a[156:159],v[144:147]
M v[148:151],a[224:227],a[172:175],v[200:203]
R a[224:227],v211,28672
M v[148:151],a[220:223],a[168:171],v[148:151]
R a[220:223],v210,28672
D v247,s[24:27],1024
M v[148:151],a[216:219],a[164:167],v[148:151]
s_add_u32 s24,s73,145408
T a[216:217],v222,24576
M v[148:151],a[252:255],a[160:163],v[148:151]
s_waitcnt lgkmcnt(6)
T a[252:253],v222,16384
T a[254:255],v222,20480
M v[12:15],a[228:231],v[180:183],v[12:15]
E v144
M v[12:15],a[232:235],v[188:191],v[12:15]
E v145
M v[44:47],a[232:235],v[192:195],v[44:47]
T a[218:219],v222,28672
D v247,s[24:27],2048
M v[44:47],a[228:231],v[184:187],v[44:47]
s_add_u32 s24,s73,152576
R a[228:231],v212,28672
C v172,v144,v145
M v[32:35],a[236:239],v[184:187],v[32:35]
E v146
M v[32:35],a[240:243],v[192:195],v[32:35]
E v147
M v[0:3],a[240:243],v[188:191],v[0:3]
R a[232:235],v213,28672
C v173,v146,v147
M v[0:3],a[236:239],v[180:183],v[0:3]
D v247,s[24:27],3072
M v[64:67],a[236:239],a[196:199],v[64:67]
s_add_u32 m0,s45,98304
E v148
M v[64:67],a[240:243],a[200:203],v[64:67]
s_waitcnt lgkmcnt(3)
E v149
M v[4:7],a[244:247],v[180:183],v[4:7]
s_add_u32 s3,s69,393216
T a[236:237],v223,16384
C v176,v148,v149
M v[4:7],a[248:251],v[188:191],v[4:7]
s_add_u32 s12,s3,s51
T a[238:239],v223,20480
M v[36:39],a[248:251],v[192:195],v[36:39]
T a[240:241],v223,24576
T a[242:243],v223,28672
M v[36:39],a[244:247],v[184:187],v[36:39]
E v150
M v[68:71],a[244:247],a[196:199],v[68:71]
T a[244:245],v224,16384
M v[68:71],a[248:251],a[200:203],v[68:71]
T a[246:247],v224,20480
M v[16:19],a[252:255],v[180:183],v[16:19]
L_pg18:
s_cmp_eq_u32 s47,1
s_cbranch_scc1 L_bkB19_0
s_waitcnt lgkmcnt(6)
T a[248:249],v224,24576
T a[250:251],v224,28672
M v[16:19],a[216:219],v[188:191],v[16:19]
E v151
M v[48:51],a[216:219],v[192:195],v[48:51]
T a[216:217],v225,24576
C v177,v150,v151
M v[48:51],a[252:255],v[184:187],v[48:51]
T a[252:253],v225,16384
T a[254:255],v225,20480
M v[152:155],a[220:223],a[144:147],v[196:199]
T a[218:219],v225,28672
M v[152:155],a[224:227],a[148:151],v[152:155]
M v[152:155],a[228:231],a[152:155],v[152:155]
M v[152:155],a[232:235],a[156:159],v[152:155]
M v[156:159],a[232:235],a[172:175],v[200:203]
R a[232:235],v217,32768
M v[156:159],a[228:231],a[168:171],v[156:159]
R a[228:231],v216,32768
M v[156:159],a[224:227],a[164:167],v[156:159]
R a[224:227],v215,32768
M v[156:159],a[220:223],a[160:163],v[156:159]
s_waitcnt lgkmcnt(6)
R a[220:223],v214,32768
M v[20:23],a[236:239],v[180:183],v[20:23]
E v152
M v[20:23],a[240:243],v[188:191],v[20:23]
E v153
M v[52:55],a[240:243],v[192:195],v[52:55]
R a[240:243],v211,32768
C v174,v152,v153
M v[52:55],a[236:239],v[184:187],v[52:55]
E v154
M v[56:59],a[244:247],v[184:187],v[56:59]
E v155
M v[56:59],a[248:251],v[192:195],v[56:59]
R a[236:239],v210,32768
C v175,v154,v155
M v[24:27],a[248:251],v[188:191],v[24:27]
E v156
M v[24:27],a[244:247],v[180:183],v[24:27]
s_waitcnt lgkmcnt(3)
R a[244:247],v212,32768
M v[28:31],a[252:255],v[180:183],v[28:31]
E v157
M v[28:31],a[216:219],v[188:191],v[28:31]
R a[248:251],v213,32768
C v178,v156,v157
M v[60:63],a[216:219],v[192:195],v[60:63]
s_waitcnt vmcnt(8)
s_barrier
T a[216:217],v227,49152
Dn v254,s[12:15],0
E v158
E v159
M v[60:63],a[252:255],v[184:187],v[60:63]
T a[252:253],v226,49152
C v179,v158,v159
M a[212:215],a[192:195],a[196:199],a[212:215]
T a[254:255],v226,51200
M a[212:215],a[192:195],a[200:203],a[212:215]
T a[218:219],v227,51200
M a[204:207],a[192:195],v[180:183],a[204:207]
R a[196:199],v243,0
Dn v255,s[12:15],1024
M a[204:207],a[192:195],v[188:191],a[204:207]
R a[200:203],v243,1024
M a[208:211],a[192:195],v[184:187],a[208:211]
M a[208:211],a[192:195],v[192:195],a[208:211]
s_waitcnt lgkmcnt(6)
M v[160:163],a[220:223],a[176:179],v[204:207]
T a[220:221],v228,49152
T a[222:223],v228,51200
M v[160:163],a[224:227],a[180:183],v[160:163]
T a[224:225],v229,49152
Dn v254,s[12:15],2048
M v[160:163],a[228:231],a[184:187],v[160:163]
T a[226:227],v229,51200
M v[160:163],a[232:235],a[188:191],v[160:163]
T a[228:229],v230,49152
M v[144:147],a[236:239],a[144:147],v[196:199]
T a[230:231],v230,51200
M v[144:147],a[240:243],a[148:151],v[144:147]
T a[232:233],v231,49152
M v[144:147],a[244:247],a[152:155],v[144:147]
T a[234:235],v231,51200
Dn v255,s[12:15],3072
M v[144:147],a[248:251],a[156:159],v[144:147]
s_add_u32 m0,s45,16384
E v160
E v161
E v162
E v163
M v[148:151],a[248:251],a[172:175],v[200:203]
s_add_u32 s8,s71,393216
R a[248:251],v211,36864
C v208,v160,v161
C v209,v162,v163
M v[148:151],a[244:247],a[168:171],v[148:151]
R a[244:247],v210,36864
Dn v245,s[8:11],0
E v144
E v145
E v146
M v[148:151],a[240:243],a[164:167],v[148:151]
T a[240:241],v233,49152
T a[242:243],v233,51200
E v147
C v180,v144,v145
M v[148:151],a[236:239],a[160:163],v[148:151]
s_waitcnt lgkmcnt(4)
T a[236:237],v232,49152
Dn v246,s[8:11],1024
C v181,v146,v147
M v[72:75],a[252:255],a[96:99],v[72:75]
ds_write_b64 v242,v[208:209] offset:2048
M v[72:75],a[216:219],a[100:103],v[72:75]
T a[238:239],v232,51200
M v[72:75],a[220:223],a[104:107],v[72:75]
E v148
E v149
E v150
E v151
M v[72:75],a[224:227],a[108:111],v[72:75]
Dn v245,s[8:11],2048
C v184,v148,v149
C v185,v150,v151
M v[88:91],a[224:227],a[124:127],v[88:91]
v_subrev_u32 v245,147456,v244
M v[88:91],a[220:223],a[120:123],v[88:91]
v_lshl_add_u32 v245,v245,1,s53
M v[88:91],a[216:219],a[116:119],v[88:91]
M v[88:91],a[252:255],a[112:115],v[88:91]
Dn v246,s[8:11],3072
M v[104:107],a[252:255],a[128:131],v[104:107]
s_add_u32 m0,s45,49152
R a[252:255],v212,36864
M v[104:107],a[216:219],a[132:135],v[104:107]
s_add_u32 s24,s74,0
R a[216:219],v213,36864
M v[104:107],a[220:223],a[136:139],v[104:107]
T a[220:221],v234,49152
T a[222:223],v234,51200
M v[104:107],a[224:227],a[140:143],v[104:107]
T a[224:225],v235,49152
D v247,s[24:27],0
M v[76:79],a[228:231],a[96:99],v[76:79]
s_add_u32 s24,s74,7168
T a[226:227],v235,51200
M v[76:79],a[232:235],a[100:103],v[76:79]
s_waitcnt lgkmcnt(6)
M v[76:79],a[236:239],a[104:107],v[76:79]
M v[76:79],a[240:243],a[108:111],v[76:79]
M v[92:95],a[240:243],a[124:127],v[92:95]
T a[240:241],v239,49152
D v247,s[24:27],1024
M v[92:95],a[236:239],a[120:123],v[92:95]
s_add_u32 s24,s74,14336
T a[236:237],v238,49152
M v[92:95],a[232:235],a[116:119],v[92:95]
T a[232:233],v237,49152
T a[234:235],v237,51200
M v[92:95],a[228:231],a[112:115],v[92:95]
T a[228:229],v236,49152
T a[230:231],v236,51200
M v[152:155],a[244:247],a[144:147],v[196:199]
T a[238:239],v238,51200
M v[152:155],a[248:251],a[148:151],v[152:155]
s_waitcnt lgkmcnt(7)
T a[242:243],v239,51200
D v247,s[24:27],2048
M v[152:155],a[252:255],a[152:155],v[152:155]
s_add_u32 s24,s74,21504
M v[152:155],a[216:219],a[156:159],v[152:155]
M v[156:159],a[216:219],a[172:175],v[200:203]
T a[216:217],v220,8192
M v[156:159],a[252:255],a[168:171],v[156:159]
T a[252:253],v220,0
M v[156:159],a[248:251],a[164:167],v[156:159]
T a[248:249],v241,49152
D v247,s[24:27],3072
M v[156:159],a[244:247],a[160:163],v[156:159]
s_add_u32 m0,s45,131072
T a[244:245],v240,49152
T a[246:247],v240,51200
E v152
E v153
E v154
M v[80:83],a[220:223],a[96:99],v[80:83]
s_add_u32 s24,s73,262144
T a[250:251],v241,51200
E v155
C v182,v152,v153
M v[80:83],a[224:227],a[100:103],v[80:83]
s_waitcnt lgkmcnt(6)
T a[254:255],v220,4096
T a[218:219],v220,12288
C v183,v154,v155
E v156
E v157
M v[80:83],a[228:231],a[104:107],v[80:83]
E v158
E v159
C v186,v156,v157
M v[80:83],a[232:235],a[108:111],v[80:83]
C v187,v158,v159
M v[96:99],a[232:235],a[124:127],v[96:99]
R a[232:235],v213,40960
M v[96:99],a[228:231],a[120:123],v[96:99]
R a[228:231],v212,40960
M v[96:99],a[224:227],a[116:119],v[96:99]
R a[224:227],v211,40960
M v[96:99],a[220:223],a[112:115],v[96:99]
R a[220:223],v210,40960
M v[100:103],a[236:239],a[112:115],v[100:103]
s_waitcnt vmcnt(11) lgkmcnt(4)
s_barrier
M v[100:103],a[240:243],a[116:119],v[100:103]
M v[100:103],a[244:247],a[120:123],v[100:103]
M v[100:103],a[248:251],a[124:127],v[100:103]
M v[84:87],a[248:251],a[108:111],v[84:87]
T a[248:249],v218,8192
M v[84:87],a[244:247],a[104:107],v[84:87]
T a[244:245],v218,0
M v[84:87],a[240:243],a[100:103],v[84:87]
T a[240:241],v221,8192
T a[242:243],v221,12288
M v[84:87],a[236:239],a[96:99],v[84:87]
T a[236:237],v221,0
M v[8:11],a[252:255],v[164:167],v[8:11]
T a[238:239],v221,4096
T a[246:247],v218,4096
M v[8:11],a[216:219],v[172:175],v[8:11]
T a[250:251],v218,12288
M v[40:43],a[216:219],v[176:179],v[40:43]
T a[216:217],v219,8192
M v[40:43],a[252:255],v[168:171],v[40:43]
s_waitcnt lgkmcnt(9)
T a[252:253],v219,0
M v[144:147],a[220:223],a[144:147],v[196:199]
T a[254:255],v219,4096
D v247,s[24:27],0
M v[144:147],a[224:227],a[148:151],v[144:147]
s_add_u32 s24,s73,269312
T a[218:219],v219,12288
M v[144:147],a[228:231],a[152:155],v[144:147]
M v[144:147],a[232:235],a[156:159],v[144:147]
M v[148:151],a[232:235],a[172:175],v[200:203]
R a[232:235],v211,45056
M v[148:151],a[228:231],a[168:171],v[148:151]
R a[228:231],v210,45056
D v247,s[24:27],1024
M v[148:151],a[224:227],a[164:167],v[148:151]
s_add_u32 s24,s73,276480
T a[224:225],v222,8192
M v[148:151],a[220:223],a[160:163],v[148:151]
s_waitcnt lgkmcnt(6)
T a[220:221],v222,0
T a[222:223],v222,4096
M v[12:15],a[236:239],v[164:167],v[12:15]
E v144
M v[12:15],a[240:243],v[172:175],v[12:15]
E v145
M v[44:47],a[240:243],v[176:179],v[44:47]
T a[226:227],v222,12288
D v247,s[24:27],2048
M v[44:47],a[236:239],v[168:171],v[44:47]
s_add_u32 s24,s73,283648
R a[236:239],v212,45056
C v188,v144,v145
M v[32:35],a[244:247],v[168:171],v[32:35]
E v146
M v[32:35],a[248:251],v[176:179],v[32:35]
E v147
M v[0:3],a[248:251],v[172:175],v[0:3]
R a[240:243],v213,45056
C v189,v146,v147
M v[0:3],a[244:247],v[164:167],v[0:3]
D v247,s[24:27],3072
M v[64:67],a[244:247],a[196:199],v[64:67]
s_add_u32 m0,s45,81920
E v148
M v[64:67],a[248:251],a[200:203],v[64:67]
s_waitcnt lgkmcnt(3)
E v149
M v[4:7],a[252:255],v[164:167],v[4:7]
s_add_u32 s3,s70,393216
T a[244:245],v223,0
C v192,v148,v149
M v[4:7],a[216:219],v[172:175],v[4:7]
s_add_u32 s12,s3,s51
T a[246:247],v223,4096
M v[36:39],a[216:219],v[176:179],v[36:39]
T a[248:249],v223,8192
T a[250:251],v223,12288
M v[36:39],a[252:255],v[168:171],v[36:39]
E v150
M v[68:71],a[252:255],a[196:199],v[68:71]
T a[252:253],v224,0
M v[68:71],a[216:219],a[200:203],v[68:71]
T a[254:255],v224,4096
M v[16:19],a[220:223],v[164:167],v[16:19]
s_waitcnt lgkmcnt(6)
T a[216:217],v224,8192
T a[218:219],v224,12288
M v[16:19],a[224:227],v[172:175],v[16:19]
E v151
M v[48:51],a[224:227],v[176:179],v[48:51]
T a[224:225],v225,8192
C v193,v150,v151
M v[48:51],a[220:223],v[168:171],v[48:51]
T a[220:221],v225,0
T a[222:223],v225,4096
M v[152:155],a[228:231],a[144:147],v[196:199]
T a[226:227],v225,12288
M v[152:155],a[232:235],a[148:151],v[152:155]
M v[152:155],a[236:239],a[152:155],v[152:155]
M v[152:155],a[240:243],a[156:159],v[152:155]
M v[156:159],a[240:243],a[172:175],v[200:203]
R a[240:243],v217,0
M v[156:159],a[236:239],a[168:171],v[156:159]
R a[236:239],v216,0
M v[156:159],a[232:235],a[164:167],v[156:159]
R a[232:235],v215,0
M v[156:159],a[228:231],a[160:163],v[156:159]
s_waitcnt lgkmcnt(6)
R a[228:231],v214,0
M v[20:23],a[244:247],v[164:167],v[20:23]
E v152
M v[20:23],a[248:251],v[172:175],v[20:23]
E v153
M v[52:55],a[248:251],v[176:179],v[52:55]
R a[248:251],v211,0
C v190,v152,v153
M v[52:55],a[244:247],v[168:171],v[52:55]
E v156
M v[56:59],a[252:255],v[168:171],v[56:59]
E v157
M v[56:59],a[216:219],v[176:179],v[56:59]
R a[244:247],v210,0
C v194,v156,v157
M v[24:27],a[216:219],v[172:175],v[24:27]
E v158
M v[24:27],a[252:255],v[164:167],v[24:27]
s_waitcnt lgkmcnt(3)
R a[252:255],v212,0
M v[28:31],a[220:223],v[164:167],v[28:31]
E v159
M v[28:31],a[224:227],v[172:175],v[28:31]
R a[216:219],v213,0
C v195,v158,v159
M v[60:63],a[224:227],v[176:179],v[60:63]
s_waitcnt vmcnt(12)
s_barrier
R a[224:227],v211,4096
Dn v254,s[12:15],0
E v154
E v155
M v[60:63],a[220:223],v[168:171],v[60:63]
R a[220:223],v210,4096
C v191,v154,v155
M a[212:215],a[192:195],a[196:199],a[212:215]
R a[196:199],v243,2048
M a[212:215],a[192:195],a[200:203],a[212:215]
R a[200:203],v243,3072
M a[204:207],a[192:195],v[164:167],a[204:207]
Dn v255,s[12:15],1024
M a[204:207],a[192:195],v[172:175],a[204:207]
M a[208:211],a[192:195],v[168:171],a[208:211]
M a[208:211],a[192:195],v[176:179],a[208:211]
s_waitcnt lgkmcnt(4)
M v[160:163],a[228:231],a[176:179],v[204:207]
R a[228:231],v212,4096
Dn v254,s[12:15],2048
M v[160:163],a[232:235],a[180:183],v[160:163]
R a[232:235],v213,4096
M v[160:163],a[236:239],a[184:187],v[160:163]
T a[236:237],v220,16384
M v[160:163],a[240:243],a[188:191],v[160:163]
T a[238:239],v220,20480
M v[144:147],a[244:247],a[144:147],v[196:199]
T a[240:241],v220,24576
T a[242:243],v220,28672
M v[144:147],a[248:251],a[148:151],v[144:147]
Dn v255,s[12:15],3072
M v[144:147],a[252:255],a[152:155],v[144:147]
s_add_u32 m0,s45,32768
M v[144:147],a[216:219],a[156:159],v[144:147]
s_add_u32 s24,s72,393216
E v160
E v161
E v162
E v163
M v[148:151],a[216:219],a[172:175],v[200:203]
R a[216:219],v213,8192
D v247,s[24:27],0
C v208,v160,v161
C v209,v162,v163
M v[148:151],a[252:255],a[168:171],v[148:151]
s_add_u32 s24,s72,400384
E v144
E v145
E v146
E v147
M v[148:151],a[248:251],a[164:167],v[148:151]
R a[248:251],v211,8192
R a[252:255],v212,8192
C v164,v144,v145
C v165,v146,v147
M v[148:151],a[244:247],a[160:163],v[148:151]
s_waitcnt lgkmcnt(3)
R a[244:247],v210,8192
D v247,s[24:27],1024
M v[156:159],a[220:223],a[160:163],v[200:203]
s_add_u32 s24,s72,407552
ds_write_b64 v242,v[208:209] offset:0
M v[156:159],a[224:227],a[164:167],v[156:159]
M v[156:159],a[228:231],a[168:171],v[156:159]
E v148
E v149
E v150
E v151
M v[156:159],a[232:235],a[172:175],v[156:159]
D v247,s[24:27],2048
C v168,v148,v149
C v169,v150,v151
M v[152:155],a[232:235],a[156:159],v[196:199]
s_add_u32 s24,s72,414720
T a[232:233],v218,24576
M v[152:155],a[228:231],a[152:155],v[152:155]
s_lshr_b32 s3,s2,4
T a[228:229],v218,16384
M v[152:155],a[224:227],a[148:151],v[152:155]
s_lshl_b32 s3,s3,15
T a[224:225],v221,24576
T a[226:227],v221,28672
E v156
E v157
E v158
M v[152:155],a[220:223],a[144:147],v[152:155]
s_add_u32 s7,s3,s52
T a[220:221],v221,16384
D v247,s[24:27],3072
E v159
C v170,v156,v157
M v[8:11],a[236:239],v[180:183],v[8:11]
s_add_u32 s24,s7,0
T a[222:223],v221,20480
T a[230:231],v218,20480
C v171,v158,v159
M v[8:11],a[240:243],v[188:191],v[8:11]
E v152
E v153
E v154
E v155
M v[40:43],a[240:243],v[192:195],v[40:43]
T a[234:235],v218,28672
C v166,v152,v153
C v167,v154,v155
M v[40:43],a[236:239],v[184:187],v[40:43]
s_waitcnt lgkmcnt(4)
T a[236:237],v219,16384
M v[144:147],a[244:247],a[144:147],v[196:199]
T a[238:239],v219,20480
M v[144:147],a[248:251],a[148:151],v[144:147]
T a[240:241],v219,24576
M v[144:147],a[252:255],a[152:155],v[144:147]
T a[242:243],v219,28672
M v[144:147],a[216:219],a[156:159],v[144:147]
M v[148:151],a[216:219],a[172:175],v[200:203]
s_waitcnt vmcnt(16) lgkmcnt(5)
s_barrier
R a[216:219],v211,12288
buffer_load_dword v246,v245,s[24:27],0 offen
M v[148:151],a[252:255],a[168:171],v[148:151]
s_add_u32 s24,s7,8192
R a[252:255],v210,12288
M v[148:151],a[248:251],a[164:167],v[148:151]
E v144
E v145
E v146
E v147
M v[148:151],a[244:247],a[160:163],v[148:151]
T a[244:245],v222,16384
buffer_load_dword v246,v245,s[24:27],0 offen
C v172,v144,v145
C v173,v146,v147
M v[12:15],a[220:223],v[180:183],v[12:15]
s_add_u32 s24,s7,16384
T a[246:247],v222,20480
T a[248:249],v222,24576
M v[12:15],a[224:227],v[188:191],v[12:15]
E v148
E v149
E v150
E v151
M v[44:47],a[224:227],v[192:195],v[44:47]
T a[250:251],v222,28672
buffer_load_dword v246,v245,s[24:27],0 offen
C v176,v148,v149
C v177,v150,v151
M v[44:47],a[220:223],v[184:187],v[44:47]
s_add_u32 s24,s7,24576
R a[220:223],v212,12288
M v[32:35],a[228:231],v[184:187],v[32:35]
s_waitcnt lgkmcnt(5)
s_add_u32 m0,s45,98304
R a[224:227],v213,12288
M v[32:35],a[232:235],v[192:195],v[32:35]
s_add_u32 s3,s71,393216
M v[0:3],a[232:235],v[188:191],v[0:3]
s_add_u32 s12,s3,s51
buffer_load_dword v246,v245,s[24:27],0 offen
M v[0:3],a[228:231],v[180:183],v[0:3]
M v[64:67],a[228:231],a[196:199],v[64:67]
T a[228:229],v223,16384
M v[64:67],a[232:235],a[200:203],v[64:67]
T a[230:231],v223,20480
M v[4:7],a[236:239],v[180:183],v[4:7]
T a[232:233],v223,24576
M v[4:7],a[240:243],v[188:191],v[4:7]
T a[234:235],v223,28672
M v[36:39],a[240:243],v[192:195],v[36:39]
M v[36:39],a[236:239],v[184:187],v[36:39]
M v[68:71],a[236:239],a[196:199],v[68:71]
T a[236:237],v224,16384
M v[68:71],a[240:243],a[200:203],v[68:71]
s_waitcnt lgkmcnt(5)
T a[238:239],v224,20480
M v[16:19],a[244:247],v[180:183],v[16:19]
T a[240:241],v224,24576
T a[242:243],v224,28672
M v[16:19],a[248:251],v[188:191],v[16:19]
M v[48:51],a[248:251],v[192:195],v[48:51]
T a[248:249],v225,24576
M v[48:51],a[244:247],v[184:187],v[48:51]
T a[244:245],v225,16384
T a[246:247],v225,20480
M v[152:155],a[252:255],a[144:147],v[196:199]
T a[250:251],v225,28672
M v[152:155],a[216:219],a[148:151],v[152:155]
M v[152:155],a[220:223],a[152:155],v[152:155]
M v[152:155],a[224:227],a[156:159],v[152:155]
M v[156:159],a[224:227],a[172:175],v[200:203]
R a[224:227],v217,16384
M v[156:159],a[220:223],a[168:171],v[156:159]
R a[220:223],v216,16384
v_subrev_u32 v217,81920,v233
M v[156:159],a[216:219],a[164:167],v[156:159]
R a[216:219],v215,16384
v_subrev_u32 v216,81920,v232
M v[156:159],a[252:255],a[160:163],v[156:159]
s_waitcnt lgkmcnt(6)
R a[252:255],v214,16384
E v152
E v153
E v154
v_subrev_u32 v215,81920,v231
M v[20:23],a[228:231],v[180:183],v[20:23]
E v155
C v174,v152,v153
v_subrev_u32 v214,81920,v230
M v[20:23],a[232:235],v[188:191],v[20:23]
E v156
E v157
E v158
E v159
M v[52:55],a[232:235],v[192:195],v[52:55]
L_pg19:
s_cmp_eq_u32 s47,1
s_cbranch_scc1 L_bkB19_0
R a[232:235],v211,16384
C v178,v156,v157
C v179,v158,v159
C v175,v154,v155
M v[52:55],a[228:231],v[184:187],v[52:55]
R a[228:231],v210,16384
M v[56:59],a[236:239],v[184:187],v[56:59]
M v[56:59],a[240:243],v[192:195],v[56:59]
M v[24:27],a[240:243],v[188:191],v[24:27]
R a[240:243],v213,16384
M v[24:27],a[236:239],v[180:183],v[24:27]
s_waitcnt lgkmcnt(3)
R a[236:239],v212,16384
M v[28:31],a[244:247],v[180:183],v[28:31]
M v[28:31],a[248:251],v[188:191],v[28:31]
M v[60:63],a[248:251],v[192:195],v[60:63]
s_waitcnt vmcnt(8)
s_barrier
R a[248:251],v211,20480
Dn v254,s[12:15],0
M v[60:63],a[244:247],v[184:187],v[60:63]
R a[244:247],v210,20480
M a[212:215],a[192:195],a[196:199],a[212:215]
R a[196:199],v243,0
M a[212:215],a[192:195],a[200:203],a[212:215]
R a[200:203],v243,1024
M a[204:207],a[192:195],v[180:183],a[204:207]
M a[204:207],a[192:195],v[188:191],a[204:207]
Dn v255,s[12:15],1024
M a[208:211],a[192:195],v[184:187],a[208:211]
M a[208:211],a[192:195],v[192:195],a[208:211]
M v[160:163],a[252:255],a[176:179],v[204:207]
R a[252:255],v212,20480
M v[160:163],a[216:219],a[180:183],v[160:163]
R a[216:219],v213,20480
Dn v254,s[12:15],2048
M v[160:163],a[220:223],a[184:187],v[160:163]
T a[220:221],v220,0
v_xor_b32 v254,1024,v244
M v[160:163],a[224:227],a[188:191],v[160:163]
s_waitcnt lgkmcnt(4)
T a[222:223],v220,4096
v_subrev_u32 v207,159744,v243
M v[144:147],a[228:231],a[144:147],v[196:199]
T a[224:225],v220,8192
T a[226:227],v220,12288
M v[144:147],a[232:235],a[148:151],v[144:147]
v_lshrrev_b32 v205,2,v207
v_mov_b32 v206,1
M v[144:147],a[236:239],a[152:155],v[144:147]
Dn v255,s[12:15],3072
M v[144:147],a[240:243],a[156:159],v[144:147]
s_add_u32 m0,s45,0
E v160
M v[148:151],a[240:243],a[172:175],v[200:203]
s_add_u32 s24,s73,393216
R a[240:243],v213,24576
v_xor_b32 v255,2048,v244
M v[148:151],a[236:239],a[168:171],v[148:151]
E v161
M v[148:151],a[232:235],a[164:167],v[148:151]
R a[232:235],v211,24576
D v247,s[24:27],0
M v[148:151],a[228:231],a[160:163],v[148:151]
s_add_u32 s24,s73,400384
R a[228:231],v210,24576
R a[236:239],v212,24576
M v[156:159],a[244:247],a[160:163],v[200:203]
E v144
M v[156:159],a[248:251],a[164:167],v[156:159]
s_waitcnt lgkmcnt(4)
E v145
M v[156:159],a[252:255],a[168:171],v[156:159]
E v146
M v[156:159],a[216:219],a[172:175],v[156:159]
D v247,s[24:27],1024
C v180,v144,v145
M v[152:155],a[216:219],a[156:159],v[196:199]
s_add_u32 s24,s73,407552
E v147
M v[152:155],a[252:255],a[152:155],v[152:155]
T a[252:253],v218,0
C v181,v146,v147
M v[152:155],a[248:251],a[148:151],v[152:155]
T a[248:249],v221,8192
T a[250:251],v221,12288
M v[152:155],a[244:247],a[144:147],v[152:155]
T a[244:245],v221,0
D v247,s[24:27],2048
M v[8:11],a[220:223],v[164:167],v[8:11]
s_add_u32 s24,s73,414720
T a[246:247],v221,4096
T a[254:255],v218,4096
M v[8:11],a[224:227],v[172:175],v[8:11]
T a[216:217],v218,8192
C v208,v160,v161
M v[40:43],a[224:227],v[176:179],v[40:43]
E v148
M v[40:43],a[220:223],v[168:171],v[40:43]
s_waitcnt lgkmcnt(7)
T a[218:219],v218,12288
M v[144:147],a[228:231],a[144:147],v[196:199]
T a[220:221],v219,0
D v247,s[24:27],3072
M v[144:147],a[232:235],a[148:151],v[144:147]
s_add_u32 m0,s45,16384
E v149
M v[144:147],a[236:239],a[152:155],v[144:147]
s_waitcnt lgkmcnt(4)
s_barrier
E v150
M v[144:147],a[240:243],a[156:159],v[144:147]
s_add_u32 s24,s74,131072
E v151
C v184,v148,v149
C v185,v150,v151
M v[148:151],a[240:243],a[172:175],v[200:203]
T a[222:223],v219,4096
T a[224:225],v219,8192
M v[148:151],a[236:239],a[168:171],v[148:151]
E v152
M v[148:151],a[232:235],a[164:167],v[148:151]
T a[226:227],v219,12288
M v[148:151],a[228:231],a[160:163],v[148:151]
T a[228:229],v222,0
T a[230:231],v222,4096
M v[12:15],a[244:247],v[164:167],v[12:15]
E v153
M v[12:15],a[248:251],v[172:175],v[12:15]
T a[232:233],v222,8192
T a[234:235],v222,12288
M v[44:47],a[248:251],v[176:179],v[44:47]
R a[236:239],v210,28672
C v182,v152,v153
M v[44:47],a[244:247],v[168:171],v[44:47]
s_waitcnt lgkmcnt(8)
R a[240:243],v211,28672
v_subrev_u32 v210,81920,v226
M v[32:35],a[252:255],v[168:171],v[32:35]
R a[244:247],v212,28672
v_subrev_u32 v211,81920,v227
M v[32:35],a[216:219],v[176:179],v[32:35]
R a[248:251],v213,28672
v_subrev_u32 v212,81920,v228
M v[0:3],a[216:219],v[172:175],v[0:3]
E v154
M v[0:3],a[252:255],v[164:167],v[0:3]
E v155
M v[64:67],a[252:255],a[196:199],v[64:67]
T a[252:253],v223,0
C v183,v154,v155
M v[64:67],a[216:219],a[200:203],v[64:67]
s_waitcnt lgkmcnt(7)
T a[254:255],v223,4096
v_subrev_u32 v213,81920,v229
M v[4:7],a[220:223],v[164:167],v[4:7]
E v156
M v[4:7],a[224:227],v[172:175],v[4:7]
E v157
M v[36:39],a[224:227],v[176:179],v[36:39]
T a[216:217],v223,8192
T a[218:219],v223,12288
M v[36:39],a[220:223],v[168:171],v[36:39]
E v158
M v[68:71],a[220:223],a[196:199],v[68:71]
T a[220:221],v224,0
C v186,v156,v157
M v[68:71],a[224:227],a[200:203],v[68:71]
T a[222:223],v224,4096
M v[16:19],a[228:231],v[164:167],v[16:19]
s_waitcnt lgkmcnt(6)
E v159
M v[16:19],a[232:235],v[172:175],v[16:19]
T a[224:225],v224,8192
C v187,v158,v159
M v[48:51],a[232:235],v[176:179],v[48:51]
T a[226:227],v224,12288
M v[48:51],a[228:231],v[168:171],v[48:51]
T a[228:229],v225,0
T a[230:231],v225,4096
M v[152:155],a[236:239],a[144:147],v[196:199]
E v162
M v[152:155],a[240:243],a[148:151],v[152:155]
T a[232:233],v225,8192
T a[234:235],v225,12288
M v[152:155],a[244:247],a[152:155],v[152:155]
E v163
M v[152:155],a[248:251],a[156:159],v[152:155]
E v144
M v[156:159],a[248:251],a[172:175],v[200:203]
T a[248:249],v233,32768
C v209,v162,v163
M v[156:159],a[244:247],a[168:171],v[156:159]
ds_write_b64 v242,v[208:209] offset:2048
M v[156:159],a[240:243],a[164:167],v[156:159]
T a[240:241],v231,32768
v_lshl_add_u32 v242,s44,2,v243
M v[156:159],a[236:239],a[160:163],v[156:159]
s_waitcnt lgkmcnt(6)
T a[236:237],v230,32768
v_xor_b32 v209,3072,v244
M v[20:23],a[252:255],v[164:167],v[20:23]
T a[238:239],v230,34816
v_lshrrev_b32 v201,1,v207
M v[20:23],a[216:219],v[172:175],v[20:23]
T a[242:243],v231,34816
v_bfe_u32 v203,v207,4,4
M v[52:55],a[216:219],v[176:179],v[52:55]
T a[244:245],v232,32768
v_lshlrev_b32 v203,11,v203
M v[52:55],a[252:255],v[168:171],v[52:55]
s_waitcnt vmcnt(4) lgkmcnt(5)
s_barrier
T a[246:247],v232,34816
D v247,s[24:27],0
M v[56:59],a[220:223],v[168:171],v[56:59]
s_add_u32 s24,s74,138240
E v145
M v[56:59],a[224:227],v[176:179],v[56:59]
T a[250:251],v233,34816
C v188,v144,v145
M v[24:27],a[224:227],v[172:175],v[24:27]
E v146
M v[24:27],a[220:223],v[164:167],v[24:27]
T v[144:145],v218,16384
D v247,s[24:27],1024
M v[28:31],a[228:231],v[164:167],v[28:31]
s_add_u32 s24,s74,145408
E v147
M v[28:31],a[232:235],v[172:175],v[28:31]
E v148
M v[60:63],a[232:235],v[176:179],v[60:63]
E v149
M v[60:63],a[228:231],v[168:171],v[60:63]
D v247,s[24:27],2048
C v189,v146,v147
M a[212:215],a[192:195],a[196:199],a[212:215]
s_add_u32 s24,s74,152576
R a[196:199],v243,2048
C v192,v148,v149
M a[212:215],a[192:195],a[200:203],a[212:215]
E v150
M a[204:207],a[192:195],v[164:167],a[204:207]
T v[164:165],v226,32768
T v[166:167],v226,34816
M a[204:207],a[192:195],v[172:175],a[204:207]
T v[172:173],v228,32768
T v[174:175],v228,34816
D v247,s[24:27],3072
M a[208:211],a[192:195],v[168:171],a[208:211]
s_add_u32 m0,s45,81920
T v[168:169],v227,32768
T v[170:171],v227,34816
M a[208:211],a[192:195],v[176:179],a[208:211]
s_waitcnt lgkmcnt(4)
T v[176:177],v229,32768
T v[178:179],v229,34816
M v[108:111],v[164:167],a[48:51],v[108:111]
s_waitcnt lgkmcnt(2)
E v151
M v[108:111],v[168:171],a[52:55],v[108:111]
s_add_u32 s24,s74,262144
R a[200:203],v243,3072
C v193,v150,v151
M v[108:111],v[172:175],a[56:59],v[108:111]
s_waitcnt lgkmcnt(1)
T v[146:147],v218,20480
D v247,s[24:27],0
M v[108:111],v[176:179],a[60:63],v[108:111]
s_add_u32 s24,s74,269312
E v152
M v[124:127],v[176:179],a[76:79],v[124:127]
E v153
M v[124:127],v[172:175],a[72:75],v[124:127]
T v[148:149],v218,24576
C v190,v152,v153
M v[124:127],v[168:171],a[68:71],v[124:127]
T v[150:151],v218,28672
D v247,s[24:27],1024
M v[124:127],v[164:167],a[64:67],v[124:127]
s_add_u32 s24,s74,276480
E v154
M v[140:143],v[164:167],a[80:83],v[140:143]
E v155
M v[140:143],v[168:171],a[84:87],v[140:143]
T v[152:153],v219,16384
C v191,v154,v155
M v[140:143],v[172:175],a[88:91],v[140:143]
T v[154:155],v219,20480
D v247,s[24:27],2048
M v[140:143],v[176:179],a[92:95],v[140:143]
s_add_u32 s24,s74,283648
E v156
M v[112:115],a[236:239],a[48:51],v[112:115]
s_and_b32 s3,s28,0x1fffff
E v157
M v[112:115],a[240:243],a[52:55],v[112:115]
s_sub_u32 s7,s28,s3
E v158
M v[112:115],a[244:247],a[56:59],v[112:115]
s_add_u32 s48,s48,s7
D v247,s[24:27],3072
C v194,v156,v157
M v[112:115],a[248:251],a[60:63],v[112:115]
s_add_u32 s49,s49,s7
E v159
M v[128:131],a[248:251],a[76:79],v[128:131]
s_add_u32 s30,s3,18432
T v[156:157],v219,24576
C v195,v158,v159
M v[128:131],a[244:247],a[72:75],v[128:131]
s_mov_b32 s9,s29
T v[158:159],v219,28672
v_subrev_u32 v218,81920,v234
M v[128:131],a[240:243],a[68:71],v[128:131]
s_mov_b32 s10,s30
T v[160:161],v220,16384
v_subrev_u32 v219,81920,v235
M v[128:131],a[236:239],a[64:67],v[128:131]
s_mul_i32 s7,s44,4608
T v[162:163],v220,20480
M a[204:207],a[192:195],v[180:183],a[204:207]
s_add_u32 s36,s7,s3
T a[252:253],v220,24576
M a[204:207],a[192:195],v[188:191],a[204:207]
s_mov_b32 s58,0xffff0000
T a[254:255],v220,28672
v_mov_b32 v208,s36
M a[208:211],a[192:195],v[184:187],a[208:211]
s_add_u32 m0,s45,98304
T a[216:217],v221,16384
v_subrev_u32 v220,81920,v236
M a[208:211],a[192:195],v[192:195],a[208:211]
s_add_u32 s24,s74,393216
T a[218:219],v221,20480
v_add_u32 v200,v207,v208
M a[212:215],a[192:195],a[196:199],a[212:215]
s_waitcnt lgkmcnt(8)
T a[220:221],v221,24576
v_accvgpr_read_b32 v251,a204
M a[212:215],a[192:195],a[200:203],a[212:215]
T a[222:223],v221,28672
v_add_f32 v250,v250,v251
M v[0:3],v[144:147],v[180:183],v[0:3]
T a[224:225],v222,16384
v_accvgpr_read_b32 v252,a208
M v[0:3],v[148:151],v[188:191],v[0:3]
T a[226:227],v222,20480
v_add_f32 v250,v250,v252
M v[32:35],v[148:151],v[192:195],v[32:35]
T a[228:229],v222,24576
v_accvgpr_read_b32 v253,a212
M v[32:35],v[144:147],v[184:187],v[32:35]
T a[230:231],v222,28672
v_add_f32 v250,v250,v253
M v[64:67],v[144:147],a[196:199],v[64:67]
T a[232:233],v223,16384
v_subrev_u32 v221,81920,v237
M v[64:67],v[148:151],a[200:203],v[64:67]
T a[234:235],v223,20480
v_subrev_u32 v222,81920,v238
M v[4:7],v[152:155],v[180:183],v[4:7]
s_waitcnt lgkmcnt(8)
T v[164:165],v223,24576
v_add_u32 v201,v201,v208
M v[4:7],v[156:159],v[188:191],v[4:7]
T v[166:167],v223,28672
v_add_u32 v201,4096,v201
M v[36:39],v[156:159],v[192:195],v[36:39]
T v[168:169],v224,16384
v_subrev_u32 v223,81920,v239
M v[36:39],v[152:155],v[184:187],v[36:39]
T v[170:171],v224,20480
v_lshrrev_b32 v208,8,v207
M v[68:71],v[152:155],a[196:199],v[68:71]
T v[172:173],v224,24576
v_lshlrev_b32 v204,3,v208
M v[68:71],v[156:159],a[200:203],v[68:71]
T v[174:175],v224,28672
v_lshrrev_b32 v208,9,v207
M v[8:11],v[160:163],v[180:183],v[8:11]
T v[176:177],v225,16384
v_subrev_u32 v224,81920,v240
M v[8:11],a[252:255],v[188:191],v[8:11]
T v[178:179],v225,20480
v_lshl_add_u32 v205,v208,20,v205
M v[40:43],a[252:255],v[192:195],v[40:43]
T a[236:237],v225,24576
v_bfe_u32 v208,v207,4,4
M v[40:43],v[160:163],v[184:187],v[40:43]
T a[238:239],v225,28672
v_lshl_add_u32 v204,s44,5,v204
M v[44:47],a[216:219],v[184:187],v[44:47]
s_waitcnt lgkmcnt(8)
T a[240:241],v234,32768
v_subrev_u32 v225,81920,v241
M v[44:47],a[220:223],v[192:195],v[44:47]
T a[242:243],v234,34816
v_add_u32 v204,v204,v203
M v[12:15],a[220:223],v[188:191],v[12:15]
T a[244:245],v235,32768
v_add_u32 v204,262144,v204
M v[12:15],a[216:219],v[180:183],v[12:15]
T a[246:247],v235,34816
M v[16:19],a[224:227],v[180:183],v[16:19]
T a[248:249],v236,32768
M v[16:19],a[228:231],v[188:191],v[16:19]
T a[250:251],v236,34816
M v[48:51],a[228:231],v[192:195],v[48:51]
T v[144:145],v237,32768
T v[146:147],v237,34816
M v[48:51],a[224:227],v[184:187],v[48:51]
v_rcp_f32 v251,v251
M v[52:55],a[232:235],v[184:187],v[52:55]
T v[148:149],v238,32768
v_mul_f32 v0,v251,v0
M v[52:55],v[164:167],v[192:195],v[52:55]
T v[150:151],v238,34816
v_mul_f32 v1,v251,v1
M v[20:23],v[164:167],v[188:191],v[20:23]
T v[152:153],v239,32768
v_mul_f32 v2,v251,v2
M v[20:23],a[232:235],v[180:183],v[20:23]
s_waitcnt lgkmcnt(8)
T v[154:155],v239,34816
v_mul_f32 v3,v251,v3
M v[24:27],v[168:171],v[180:183],v[24:27]
T v[156:157],v240,32768
v_mul_f32 v4,v251,v4
M v[24:27],v[172:175],v[188:191],v[24:27]
T v[158:159],v240,34816
v_mul_f32 v5,v251,v5
M v[56:59],v[172:175],v[192:195],v[56:59]
T v[160:161],v241,32768
T v[162:163],v241,34816
M v[56:59],v[168:171],v[184:187],v[56:59]
T a[252:253],v226,49152
v_mul_f32 v6,v251,v6
M v[60:63],v[176:179],v[184:187],v[60:63]
T a[254:255],v226,51200
v_mul_f32 v7,v251,v7
M v[60:63],a[236:239],v[192:195],v[60:63]
T a[216:217],v227,49152
C v0,v0,v1
M v[28:31],a[236:239],v[188:191],v[28:31]
T a[218:219],v227,51200
C v1,v2,v3
M v[28:31],v[176:179],v[180:183],v[28:31]
T a[220:221],v228,49152
C v2,v4,v5
M v[116:119],a[240:243],a[48:51],v[116:119]
s_waitcnt lgkmcnt(5)
s_barrier
T a[222:223],v228,51200
D v247,s[24:27],0
M v[116:119],a[244:247],a[52:55],v[116:119]
s_add_u32 s24,s74,400384
v_rcp_f32 v252,v252
M v[116:119],a[248:251],a[56:59],v[116:119]
T a[224:225],v229,49152
T a[226:227],v229,51200
M v[116:119],v[144:147],a[60:63],v[116:119]
v_rcp_f32 v253,v253
M v[132:135],v[144:147],a[76:79],v[132:135]
T a[228:229],v230,49152
D v247,s[24:27],1024
M v[132:135],a[248:251],a[72:75],v[132:135]
s_add_u32 s24,s74,407552
T a[230:231],v230,51200
v_mul_f32 v64,v253,v64
M v[132:135],a[244:247],a[68:71],v[132:135]
T a[232:233],v231,49152
v_mul_f32 v65,v253,v65
M v[132:135],a[240:243],a[64:67],v[132:135]
T a[234:235],v231,51200
v_mul_f32 v66,v253,v66
M v[136:139],v[148:151],a[64:67],v[136:139]
T a[236:237],v232,49152
D v247,s[24:27],2048
M v[136:139],v[152:155],a[68:71],v[136:139]
s_add_u32 s24,s74,414720
T a[238:239],v232,51200
v_mul_f32 v67,v253,v67
M v[136:139],v[156:159],a[72:75],v[136:139]
T a[240:241],v233,49152
v_mul_f32 v68,v253,v68
M v[136:139],v[160:163],a[76:79],v[136:139]
T a[242:243],v233,51200
v_mul_f32 v69,v253,v69
M v[120:123],v[160:163],a[60:63],v[120:123]
T a[244:245],v234,49152
D v247,s[24:27],3072
M v[120:123],v[156:159],a[56:59],v[120:123]
s_add_u32 m0,s45,114688
T a[246:247],v234,51200
v_mul_f32 v70,v253,v70
M v[120:123],v[152:155],a[52:55],v[120:123]
s_add_u32 s24,s75,0
T a[248:249],v235,49152
v_mul_f32 v71,v253,v71
M v[120:123],v[148:151],a[48:51],v[120:123]
s_waitcnt lgkmcnt(8)
T a[250:251],v235,51200
C v64,v64,v65
M v[108:111],a[252:255],a[96:99],v[108:111]
T a[192:193],v210,49152
D v247,s[24:27],0
M v[108:111],a[216:219],a[100:103],v[108:111]
s_add_u32 m0,s45,114688
T a[194:195],v210,51200
C v65,v66,v67
M v[108:111],a[220:223],a[104:107],v[108:111]
s_add_u32 s24,s75,7168
T a[196:197],v211,49152
C v66,v68,v69
M v[108:111],a[224:227],a[108:111],v[108:111]
C v67,v70,v71
v_accvgpr_write_b32 a176,v64
M v[124:127],a[224:227],a[124:127],v[124:127]
v_accvgpr_write_b32 a177,v65
v_accvgpr_write_b32 a178,v66
M v[124:127],a[220:223],a[120:123],v[124:127]
T a[198:199],v211,51200
v_accvgpr_write_b32 a179,v67
M v[124:127],a[216:219],a[116:119],v[124:127]
ds_write_b128 v244,a[176:179] offset:0
M v[124:127],a[252:255],a[112:115],v[124:127]
ds_write_b32 v242,v250
M v[140:143],a[252:255],a[128:131],v[140:143]
T a[252:253],v236,49152
T a[254:255],v236,51200
M v[140:143],a[216:219],a[132:135],v[140:143]
T a[216:217],v237,49152
C v3,v6,v7
M v[140:143],a[220:223],a[136:139],v[140:143]
T a[218:219],v237,51200
T a[220:221],v238,49152
M v[140:143],a[224:227],a[140:143],v[140:143]
T a[222:223],v238,51200
D v247,s[24:27],1024
M v[112:115],a[228:231],a[96:99],v[112:115]
s_waitcnt lgkmcnt(9)
T a[224:225],v239,49152
T a[226:227],v239,51200
M v[112:115],a[232:235],a[100:103],v[112:115]
s_add_u32 m0,s45,114688
T a[200:201],v212,49152
v_accvgpr_write_b32 a144,v0
M v[112:115],a[236:239],a[104:107],v[112:115]
s_add_u32 s24,s75,14336
T a[202:203],v212,51200
v_accvgpr_write_b32 a145,v1
M v[112:115],a[240:243],a[108:111],v[112:115]
T a[204:205],v213,49152
v_accvgpr_write_b32 a146,v2
M v[128:131],a[240:243],a[124:127],v[128:131]
T a[206:207],v213,51200
v_accvgpr_write_b32 a147,v3
M v[128:131],a[236:239],a[120:123],v[128:131]
T a[208:209],v214,49152
v_mul_f32 v8,v251,v8
M v[128:131],a[232:235],a[116:119],v[128:131]
L_pg20:
s_cmp_eq_u32 s47,1
s_cbranch_scc1 L_bkB20_0
T a[232:233],v241,49152
T a[234:235],v241,51200
M v[128:131],a[228:231],a[112:115],v[128:131]
T a[228:229],v240,49152
D v247,s[24:27],2048
M v[132:135],a[244:247],a[112:115],v[132:135]
s_add_u32 m0,s45,114688
T a[230:231],v240,51200
v_mul_f32 v9,v251,v9
M v[132:135],a[248:251],a[116:119],v[132:135]
s_waitcnt lgkmcnt(9)
T a[210:211],v214,51200
v_mul_f32 v10,v251,v10
M v[132:135],a[252:255],a[120:123],v[132:135]
s_add_u32 s24,s75,21504
T a[212:213],v215,49152
v_mul_f32 v11,v251,v11
M v[132:135],a[216:219],a[124:127],v[132:135]
T a[214:215],v215,51200
v_mul_f32 v12,v251,v12
M v[116:119],a[216:219],a[108:111],v[116:119]
T a[236:237],v216,49152
v_mul_f32 v13,v251,v13
M v[116:119],a[252:255],a[104:107],v[116:119]
T a[238:239],v216,51200
v_mul_f32 v14,v251,v14
M v[116:119],a[248:251],a[100:103],v[116:119]
s_waitcnt lgkmcnt(5)
s_barrier
T a[240:241],v217,49152
v_mul_f32 v15,v251,v15
M v[116:119],a[244:247],a[96:99],v[116:119]
T a[242:243],v217,51200
D v247,s[24:27],3072
M v[120:123],a[220:223],a[96:99],v[120:123]
s_add_u32 m0,s45,131072
T a[244:245],v218,49152
C v8,v8,v9
M v[120:123],a[224:227],a[100:103],v[120:123]
s_add_u32 s24,s75,131072
T a[246:247],v218,51200
C v9,v10,v11
M v[120:123],a[228:231],a[104:107],v[120:123]
T a[248:249],v219,49152
C v10,v12,v13
M v[120:123],a[232:235],a[108:111],v[120:123]
T a[250:251],v219,51200
C v11,v14,v15
M v[136:139],a[232:235],a[124:127],v[136:139]
T a[252:253],v220,49152
v_accvgpr_write_b32 a148,v8
M v[136:139],a[228:231],a[120:123],v[136:139]
T a[254:255],v220,51200
v_accvgpr_write_b32 a149,v9
M v[136:139],a[224:227],a[116:119],v[136:139]
T a[216:217],v221,49152
v_accvgpr_write_b32 a150,v10
M v[136:139],a[220:223],a[112:115],v[136:139]
T a[218:219],v221,51200
D v247,s[24:27],0
M v[144:147],a[192:195],a[0:3],0
s_add_u32 m0,s45,131072
T a[220:221],v222,49152
v_accvgpr_write_b32 a151,v11
M v[144:147],a[196:199],a[4:7],v[144:147]
s_add_u32 s24,s75,138240
T a[222:223],v222,51200
v_mul_f32 v16,v251,v16
M v[144:147],a[200:203],a[8:11],v[144:147]
T a[224:225],v223,49152
v_mul_f32 v17,v251,v17
M v[144:147],a[204:207],a[12:15],v[144:147]
T a[226:227],v223,51200
v_mul_f32 v18,v251,v18
M v[160:163],a[204:207],a[28:31],0
T a[228:229],v224,49152
v_mul_f32 v19,v251,v19
M v[160:163],a[200:203],a[24:27],v[160:163]
T a[230:231],v224,51200
v_mul_f32 v20,v251,v20
M v[160:163],a[196:199],a[20:23],v[160:163]
T a[232:233],v225,49152
v_mul_f32 v21,v251,v21
M v[160:163],a[192:195],a[16:19],v[160:163]
T a[234:235],v225,51200
v_mul_f32 v22,v251,v22
M v[176:179],a[192:195],a[32:35],0
T a[192:193],v214,32768
v_mul_f32 v23,v251,v23
M v[176:179],a[196:199],a[36:39],v[176:179]
T a[194:195],v214,34816
C v16,v16,v17
M v[176:179],a[200:203],a[40:43],v[176:179]
T a[196:197],v215,32768
C v17,v18,v19
M v[176:179],a[204:207],a[44:47],v[176:179]
s_waitcnt lgkmcnt(8)
T a[198:199],v215,34816
D v247,s[24:27],1024
M v[148:151],a[208:211],a[0:3],0
s_add_u32 m0,s45,131072
R a[180:183],v254,0
C v18,v20,v21
M v[148:151],a[212:215],a[4:7],v[148:151]
s_add_u32 s24,s75,145408
R a[184:187],v255,0
C v19,v22,v23
M v[148:151],a[236:239],a[8:11],v[148:151]
R a[188:191],v209,0
v_accvgpr_write_b32 a152,v16
M v[148:151],a[240:243],a[12:15],v[148:151]
R v[180:183],v243,0
v_accvgpr_write_b32 a153,v17
M v[164:167],a[240:243],a[28:31],0
T a[200:201],v216,32768
v_accvgpr_write_b32 a154,v18
M v[164:167],a[236:239],a[24:27],v[164:167]
T a[202:203],v216,34816
v_accvgpr_write_b32 a155,v19
M v[164:167],a[212:215],a[20:23],v[164:167]
T a[204:205],v217,32768
v_mul_f32 v24,v251,v24
M v[164:167],a[208:211],a[16:19],v[164:167]
T a[206:207],v217,34816
D v247,s[24:27],2048
M v[168:171],a[244:247],a[16:19],0
s_add_u32 m0,s45,131072
T a[208:209],v218,32768
v_mul_f32 v25,v251,v25
M v[168:171],a[248:251],a[20:23],v[168:171]
s_waitcnt vmcnt(19) lgkmcnt(5)
s_barrier
T a[210:211],v218,34816
v_mul_f32 v26,v251,v26
M v[168:171],a[252:255],a[24:27],v[168:171]
s_add_u32 s24,s75,152576
T a[212:213],v219,32768
v_mul_f32 v27,v251,v27
M v[168:171],a[216:219],a[28:31],v[168:171]
T a[214:215],v219,34816
v_mul_f32 v28,v251,v28
M v[152:155],a[216:219],a[12:15],0
T a[236:237],v220,32768
v_mul_f32 v29,v251,v29
M v[152:155],a[252:255],a[8:11],v[152:155]
T a[238:239],v220,34816
v_mul_f32 v30,v251,v30
M v[152:155],a[248:251],a[4:7],v[152:155]
T a[240:241],v221,32768
v_mul_f32 v31,v251,v31
M v[152:155],a[244:247],a[0:3],v[152:155]
D v247,s[24:27],3072
C v24,v24,v25
M v[156:159],a[220:223],a[0:3],0
s_add_u32 m0,s45,49152
C v25,v26,v27
v_accvgpr_write_b32 a156,v24
M v[156:159],a[224:227],a[4:7],v[156:159]
s_add_u32 s24,s75,262144
C v26,v28,v29
C v27,v30,v31
M v[156:159],a[228:231],a[8:11],v[156:159]
v_accvgpr_write_b32 a157,v25
v_accvgpr_write_b32 a158,v26
M v[156:159],a[232:235],a[12:15],v[156:159]
v_accvgpr_write_b32 a159,v27
v_mul_f32 v56,v252,v56
M v[172:175],a[232:235],a[28:31],0
v_mul_f32 v57,v252,v57
v_mul_f32 v58,v252,v58
M v[172:175],a[228:231],a[24:27],v[172:175]
v_mul_f32 v59,v252,v59
v_mul_f32 v60,v252,v60
M v[172:175],a[224:227],a[20:23],v[172:175]
v_mul_f32 v61,v252,v61
v_mul_f32 v62,v252,v62
M v[172:175],a[220:223],a[16:19],v[172:175]
D v247,s[24:27],0
v_mul_f32 v63,v252,v63
M v[76:79],a[192:195],a[144:147],v[76:79]
s_add_u32 m0,s45,49152
T a[242:243],v221,34816
C v56,v56,v57
M v[76:79],a[196:199],a[148:151],v[76:79]
s_waitcnt lgkmcnt(1)
C v57,v58,v59
v_mul_f32 v48,v252,v48
M v[76:79],a[200:203],a[152:155],v[76:79]
s_add_u32 s24,s75,269312
C v58,v60,v61
C v59,v62,v63
M v[76:79],a[204:207],a[156:159],v[76:79]
v_mul_f32 v49,v252,v49
v_mul_f32 v50,v252,v50
v_mul_f32 v51,v252,v51
v_mul_f32 v52,v252,v52
v_mul_f32 v53,v252,v53
v_mul_f32 v54,v252,v54
v_mul_f32 v55,v252,v55
v_accvgpr_write_b32 a172,v56
v_accvgpr_write_b32 a173,v57
v_accvgpr_write_b32 a174,v58
v_accvgpr_write_b32 a175,v59
s_nop 1
M v[92:95],a[204:207],a[172:175],v[92:95]
C v48,v48,v49
v_mul_f32 v40,v252,v40
v_mul_f32 v41,v252,v41
v_mul_f32 v42,v252,v42
v_mul_f32 v43,v252,v43
v_mul_f32 v44,v252,v44
v_mul_f32 v45,v252,v45
v_mul_f32 v46,v252,v46
v_mul_f32 v47,v252,v47
C v49,v50,v51
C v50,v52,v53
C v51,v54,v55
v_accvgpr_write_b32 a168,v48
v_accvgpr_write_b32 a169,v49
v_accvgpr_write_b32 a170,v50
v_accvgpr_write_b32 a171,v51
s_nop 1
M v[92:95],a[200:203],a[168:171],v[92:95]
T a[244:245],v222,32768
T a[246:247],v222,34816
C v40,v40,v41
v_mul_f32 v32,v252,v32
v_mul_f32 v33,v252,v33
v_mul_f32 v34,v252,v34
v_mul_f32 v35,v252,v35
v_mul_f32 v36,v252,v36
v_mul_f32 v37,v252,v37
v_mul_f32 v38,v252,v38
v_mul_f32 v39,v252,v39
C v41,v42,v43
C v42,v44,v45
C v43,v46,v47
v_accvgpr_write_b32 a164,v40
v_accvgpr_write_b32 a165,v41
v_accvgpr_write_b32 a166,v42
v_accvgpr_write_b32 a167,v43
s_nop 1
M v[92:95],a[196:199],a[164:167],v[92:95]
T a[248:249],v223,32768
C v32,v32,v33
C v33,v34,v35
C v34,v36,v37
C v35,v38,v39
v_accvgpr_write_b32 a160,v32
v_accvgpr_write_b32 a161,v33
v_accvgpr_write_b32 a162,v34
v_accvgpr_write_b32 a163,v35
s_nop 1
M v[92:95],a[192:195],a[160:163],v[92:95]
T a[250:251],v223,34816
D v247,s[24:27],1024
M v[96:99],a[208:211],a[160:163],v[96:99]
s_add_u32 m0,s45,49152
T a[252:253],v224,32768
T a[254:255],v224,34816
M v[96:99],a[212:215],a[164:167],v[96:99]
s_add_u32 s24,s75,276480
T a[216:217],v225,32768
T a[218:219],v225,34816
M v[96:99],a[236:239],a[168:171],v[96:99]
s_waitcnt lgkmcnt(6)
T a[220:221],v210,32768
v_add_f32 v180,v180,v181
M v[96:99],a[240:243],a[172:175],v[96:99]
T a[222:223],v210,34816
T a[224:225],v211,32768
M v[80:83],a[240:243],a[156:159],v[80:83]
T a[226:227],v211,34816
v_add_f32 v182,v182,v183
M v[80:83],a[236:239],a[152:155],v[80:83]
T a[228:229],v212,32768
T a[230:231],v212,34816
M v[80:83],a[212:215],a[148:151],v[80:83]
T a[232:233],v213,32768
v_add_f32 v180,v180,v182
M v[80:83],a[208:211],a[144:147],v[80:83]
T a[234:235],v213,34816
D v247,s[24:27],2048
M v[84:87],a[244:247],a[144:147],v[84:87]
s_waitcnt lgkmcnt(12)
T v[20:21],v210,0
C v96,v96,v97
M v[84:87],a[248:251],a[148:151],v[84:87]
s_waitcnt lgkmcnt(11)
T v[22:23],v210,2048
C v97,v98,v99
M v[84:87],a[252:255],a[152:155],v[84:87]
s_waitcnt lgkmcnt(10)
T v[24:25],v211,0
C v80,v80,v81
M v[84:87],a[216:219],a[156:159],v[84:87]
s_add_u32 m0,s45,49152
T v[26:27],v211,2048
C v81,v82,v83
M v[100:103],a[216:219],a[172:175],v[100:103]
s_add_u32 s24,s75,283648
T v[28:29],v212,0
v_lshrrev_b32 v209,9,v207
M v[100:103],a[252:255],a[168:171],v[100:103]
s_waitcnt vmcnt(19) lgkmcnt(5)
s_barrier
T v[30:31],v212,2048
C v82,v84,v85
M v[100:103],a[248:251],a[164:167],v[100:103]
s_add_u32 s3,s5,1
T v[32:33],v213,0
T v[34:35],v213,2048
M v[100:103],a[244:247],a[160:163],v[100:103]
s_and_b32 s3,s3,7
T a[192:193],v214,0
D v247,s[24:27],3072
M v[88:91],a[220:223],a[160:163],v[88:91]
s_mul_i32 s3,s3,147456
v_cmp_nge_f32 vcc,0x53800000,v180
s_cbranch_vccnz L_redo
L_ok:
M v[88:91],a[224:227],a[164:167],v[88:91]
s_add_u32 s28,s3,s48
T a[194:195],v214,2048
C v83,v86,v87
M v[88:91],a[228:231],a[168:171],v[88:91]
s_add_u32 m0,s45,32768
T a[196:197],v215,0
C v98,v100,v101
M v[88:91],a[232:235],a[172:175],v[88:91]
s_add_u32 s24,s75,393216
T a[198:199],v215,2048
C v99,v102,v103
M v[72:75],a[232:235],a[156:159],v[72:75]
T a[200:201],v216,0
v_lshl_add_u32 v209,s44,1,v209
M v[72:75],a[228:231],a[152:155],v[72:75]
T a[202:203],v216,2048
M v[72:75],a[224:227],a[148:151],v[72:75]
T a[204:205],v217,0
C v88,v88,v89
M v[72:75],a[220:223],a[144:147],v[72:75]
T a[206:207],v217,2048
C v89,v90,v91
M v[104:107],a[220:223],a[176:179],v[104:107]
C v90,v92,v93
C v91,v94,v95
M v[104:107],a[224:227],a[180:183],v[104:107]
T a[208:209],v218,0
M v[104:107],a[228:231],a[184:187],v[104:107]
T a[210:211],v218,2048
C v72,v72,v73
M v[104:107],a[232:235],a[188:191],v[104:107]
s_waitcnt lgkmcnt(7)
T a[212:213],v219,0
C v73,v74,v75
M v[108:111],v[20:23],a[144:147],v[108:111]
C v74,v76,v77
C v75,v78,v79
M v[108:111],v[24:27],a[148:151],v[108:111]
buffer_store_dwordx4 v[72:75],v200,s[28:31],0 offen offset:0 sc1
M v[108:111],v[28:31],a[152:155],v[108:111]
T a[214:215],v219,2048
C v104,v104,v105
M v[108:111],v[32:35],a[156:159],v[108:111]
T a[236:237],v220,0
C v105,v106,v107
M v[124:127],v[32:35],a[172:175],v[124:127]
buffer_store_dwordx4 v[80:83],v200,s[28:31],0 offen offset:1024 sc1
M v[124:127],v[28:31],a[168:171],v[124:127]
T a[238:239],v220,2048
M v[124:127],v[24:27],a[164:167],v[124:127]
T a[240:241],v221,0
T a[242:243],v221,2048
M v[124:127],v[20:23],a[160:163],v[124:127]
buffer_store_dwordx4 v[88:91],v200,s[28:31],0 offen offset:2048 sc1
M v[140:143],v[20:23],a[176:179],v[140:143]
T a[244:245],v222,0
C v108,v108,v109
M v[140:143],v[24:27],a[180:183],v[140:143]
T a[246:247],v222,2048
C v109,v110,v111
M v[140:143],v[28:31],a[184:187],v[140:143]
buffer_store_dwordx4 v[96:99],v200,s[28:31],0 offen offset:3072 sc1
M v[140:143],v[32:35],a[188:191],v[140:143]
T a[248:249],v223,0
T a[250:251],v223,2048
M v[112:115],a[192:195],a[144:147],v[112:115]
s_waitcnt lgkmcnt(6)
T a[252:253],v224,0
C v124,v124,v125
M v[112:115],a[196:199],a[148:151],v[112:115]
buffer_store_dwordx2 v[104:105],v201,s[28:31],0 offen offset:0 sc1
M v[112:115],a[200:203],a[152:155],v[112:115]
T a[254:255],v224,2048
T a[216:217],v225,0
M v[112:115],a[204:207],a[156:159],v[112:115]
T a[218:219],v225,2048
C v125,v126,v127
M v[128:131],a[204:207],a[172:175],v[128:131]
T a[220:221],v210,16384
D v247,s[24:27],0
M v[128:131],a[200:203],a[168:171],v[128:131]
s_add_u32 m0,s45,32768
T a[222:223],v210,18432
C v140,v140,v141
M v[128:131],a[196:199],a[164:167],v[128:131]
s_add_u32 s24,s75,400384
T a[224:225],v211,16384
C v110,v112,v113
M v[128:131],a[192:195],a[160:163],v[128:131]
T a[226:227],v211,18432
C v111,v114,v115
M v[132:135],a[208:211],a[160:163],v[132:135]
T a[228:229],v212,16384
D v247,s[24:27],1024
M v[132:135],a[212:215],a[164:167],v[132:135]
s_waitcnt vmcnt(23) lgkmcnt(5)
s_barrier
T a[230:231],v212,18432
C v126,v128,v129
M v[132:135],a[236:239],a[168:171],v[132:135]
s_add_u32 m0,s45,32768
T a[232:233],v213,16384
T a[234:235],v213,18432
M v[132:135],a[240:243],a[172:175],v[132:135]
s_add_u32 s24,s75,407552
T v[20:21],v214,16384
C v127,v130,v131
M v[116:119],a[240:243],a[156:159],v[116:119]
T v[22:23],v214,18432
D v247,s[24:27],2048
M v[116:119],a[236:239],a[152:155],v[116:119]
s_add_u32 m0,s45,32768
T v[24:25],v215,16384
C v141,v142,v143
M v[116:119],a[212:215],a[148:151],v[116:119]
s_add_u32 s24,s75,414720
T v[26:27],v215,18432
C v132,v132,v133
M v[116:119],a[208:211],a[144:147],v[116:119]
s_add_u32 s3,s5,2
T v[28:29],v216,16384
C v133,v134,v135
M v[120:123],a[244:247],a[144:147],v[120:123]
s_and_b32 s3,s3,7
T v[30:31],v216,18432
D v247,s[24:27],3072
M v[120:123],a[248:251],a[148:151],v[120:123]
s_mul_i32 s3,s3,147456
T v[32:33],v217,16384
M v[120:123],a[252:255],a[152:155],v[120:123]
s_add_u32 s28,s3,s48
T v[34:35],v217,18432
C v116,v116,v117
M v[120:123],a[216:219],a[156:159],v[120:123]
s_add_u32 m0,s45,0
T a[192:193],v218,16384
C v117,v118,v119
M v[136:139],a[216:219],a[172:175],v[136:139]
s_add_u32 s24,s76,0
T a[194:195],v218,18432
M v[136:139],a[252:255],a[168:171],v[136:139]
T a[196:197],v219,16384
M v[136:139],a[248:251],a[164:167],v[136:139]
C v118,v120,v121
C v119,v122,v123
M v[136:139],a[244:247],a[160:163],v[136:139]
s_waitcnt lgkmcnt(7)
buffer_store_dwordx4 v[108:111],v200,s[28:31],0 offen offset:0 sc1
M v[144:147],a[220:223],a[48:51],v[144:147]
T a[198:199],v219,18432
M v[144:147],a[224:227],a[52:55],v[144:147]
T a[200:201],v220,16384
M v[144:147],a[228:231],a[56:59],v[144:147]
buffer_store_dwordx4 v[116:119],v200,s[28:31],0 offen offset:1024 sc1
M v[144:147],a[232:235],a[60:63],v[144:147]
C v134,v136,v137
C v135,v138,v139
M v[160:163],a[232:235],a[76:79],v[160:163]
T a[202:203],v220,18432
M v[160:163],a[228:231],a[72:75],v[160:163]
buffer_store_dwordx4 v[124:127],v200,s[28:31],0 offen offset:2048 sc1
M v[160:163],a[224:227],a[68:71],v[160:163]
T a[204:205],v221,16384
T a[206:207],v221,18432
M v[160:163],a[220:223],a[64:67],v[160:163]
T a[208:209],v222,16384
M v[176:179],a[220:223],a[80:83],v[176:179]
buffer_store_dwordx4 v[132:135],v200,s[28:31],0 offen offset:3072 sc1
M v[176:179],a[224:227],a[84:87],v[176:179]
T a[210:211],v222,18432
M v[176:179],a[228:231],a[88:91],v[176:179]
T a[212:213],v223,16384
M v[176:179],a[232:235],a[92:95],v[176:179]
buffer_store_dwordx2 v[140:141],v201,s[28:31],0 offen offset:0 sc1
M v[148:151],v[20:23],a[48:51],v[148:151]
T a[214:215],v223,18432
T a[236:237],v224,16384
M v[148:151],v[24:27],a[52:55],v[148:151]
s_waitcnt lgkmcnt(7)
T a[238:239],v224,18432
M v[148:151],v[28:31],a[56:59],v[148:151]
T a[240:241],v225,16384
D v247,s[24:27],0
M v[148:151],v[32:35],a[60:63],v[148:151]
s_add_u32 m0,s45,0
T a[242:243],v225,18432
M v[164:167],v[32:35],a[76:79],v[164:167]
s_add_u32 s24,s76,7168
T a[244:245],v226,0
M v[164:167],v[28:31],a[72:75],v[164:167]
T a[246:247],v226,2048
M v[164:167],v[24:27],a[68:71],v[164:167]
T a[248:249],v227,0
D v247,s[24:27],1024
M v[164:167],v[20:23],a[64:67],v[164:167]
s_add_u32 m0,s45,0
T a[250:251],v227,2048
M v[168:171],a[192:195],a[64:67],v[168:171]
s_add_u32 s24,s76,14336
T a[252:253],v228,0
M v[168:171],a[196:199],a[68:71],v[168:171]
s_waitcnt vmcnt(28) lgkmcnt(5)
s_barrier
T a[254:255],v228,2048
D v247,s[24:27],2048
M v[168:171],a[200:203],a[72:75],v[168:171]
s_add_u32 m0,s45,0
T a[216:217],v229,0
T a[218:219],v229,2048
M v[168:171],a[204:207],a[76:79],v[168:171]
s_add_u32 s24,s76,21504
T a[220:221],v230,0
M v[152:155],a[204:207],a[60:63],v[152:155]
T a[222:223],v230,2048
M v[152:155],a[200:203],a[56:59],v[152:155]
T a[224:225],v231,0
M v[152:155],a[196:199],a[52:55],v[152:155]
T a[226:227],v231,2048
M v[152:155],a[192:195],a[48:51],v[152:155]
T a[228:229],v232,0
D v247,s[24:27],3072
M v[156:159],a[208:211],a[48:51],v[156:159]
s_add_u32 m0,s45,16384
T a[230:231],v232,2048
M v[156:159],a[212:215],a[52:55],v[156:159]
s_add_u32 s24,s76,131072
T a[232:233],v233,0
M v[156:159],a[236:239],a[56:59],v[156:159]
T a[234:235],v233,2048
M v[156:159],a[240:243],a[60:63],v[156:159]
T v[20:21],v234,0
M v[172:175],a[240:243],a[76:79],v[172:175]
T v[22:23],v234,2048
M v[172:175],a[236:239],a[72:75],v[172:175]
T v[24:25],v235,0
M v[172:175],a[212:215],a[68:71],v[172:175]
T v[26:27],v235,2048
M v[172:175],a[208:211],a[64:67],v[172:175]
L_pg21:
s_cmp_eq_u32 s47,1
s_cbranch_scc1 L_bkB20_0
s_waitcnt lgkmcnt(8)
T v[28:29],v236,0
D v247,s[24:27],0
M v[144:147],a[244:247],a[96:99],v[144:147]
s_add_u32 m0,s45,16384
T v[30:31],v236,2048
M v[144:147],a[248:251],a[100:103],v[144:147]
s_add_u32 s24,s76,138240
T v[32:33],v237,0
M v[144:147],a[252:255],a[104:107],v[144:147]
T v[34:35],v237,2048
M v[144:147],a[216:219],a[108:111],v[144:147]
T a[192:193],v238,0
M v[160:163],a[216:219],a[124:127],v[160:163]
T a[194:195],v238,2048
M v[160:163],a[252:255],a[120:123],v[160:163]
T a[196:197],v239,0
M v[160:163],a[248:251],a[116:119],v[160:163]
T a[198:199],v239,2048
M v[160:163],a[244:247],a[112:115],v[160:163]
T a[200:201],v240,0
M v[176:179],a[244:247],a[128:131],v[176:179]
T a[202:203],v240,2048
M v[176:179],a[248:251],a[132:135],v[176:179]
T a[204:205],v241,0
M v[176:179],a[252:255],a[136:139],v[176:179]
T a[206:207],v241,2048
M v[176:179],a[216:219],a[140:143],v[176:179]
T a[208:209],v226,16384
D v247,s[24:27],1024
M v[148:151],a[220:223],a[96:99],v[148:151]
s_add_u32 m0,s45,16384
T a[210:211],v226,18432
M v[148:151],a[224:227],a[100:103],v[148:151]
s_waitcnt lgkmcnt(8)
s_add_u32 s24,s76,145408
T a[212:213],v227,16384
M v[148:151],a[228:231],a[104:107],v[148:151]
T a[214:215],v227,18432
M v[148:151],a[232:235],a[108:111],v[148:151]
T a[236:237],v228,16384
M v[164:167],a[232:235],a[124:127],v[164:167]
s_waitcnt vmcnt(24) lgkmcnt(5)
s_barrier
T a[238:239],v228,18432
M v[164:167],a[228:231],a[120:123],v[164:167]
T a[240:241],v229,16384
M v[164:167],a[224:227],a[116:119],v[164:167]
T a[242:243],v229,18432
M v[164:167],a[220:223],a[112:115],v[164:167]
s_waitcnt vmcnt(15)
buffer_store_dword v206,v205,s[80:83],s101 offen offset:0 sc1
M v[168:171],v[20:23],a[112:115],v[168:171]
T a[244:245],v230,16384
M v[168:171],v[24:27],a[116:119],v[168:171]
T a[246:247],v230,18432
M v[168:171],v[28:31],a[120:123],v[168:171]
T a[248:249],v231,16384
M v[168:171],v[32:35],a[124:127],v[168:171]
T a[250:251],v231,18432
D v247,s[24:27],2048
M v[152:155],v[32:35],a[108:111],v[152:155]
s_add_u32 m0,s45,16384
T a[252:253],v232,16384
M v[152:155],v[28:31],a[104:107],v[152:155]
s_add_u32 s24,s76,152576
T a[254:255],v232,18432
M v[152:155],v[24:27],a[100:103],v[152:155]
T a[216:217],v233,16384
M v[152:155],v[20:23],a[96:99],v[152:155]
T a[218:219],v233,18432
D v247,s[24:27],3072
M v[156:159],a[192:195],a[96:99],v[156:159]
s_add_u32 m0,s45,81920
T a[220:221],v234,16384
M v[156:159],a[196:199],a[100:103],v[156:159]
s_add_u32 s24,s76,262144
T a[222:223],v234,18432
M v[156:159],a[200:203],a[104:107],v[156:159]
T a[224:225],v235,16384
M v[156:159],a[204:207],a[108:111],v[156:159]
T a[226:227],v235,18432
M v[172:175],a[204:207],a[124:127],v[172:175]
T a[228:229],v236,16384
M v[172:175],a[200:203],a[120:123],v[172:175]
T a[230:231],v236,18432
M v[172:175],a[196:199],a[116:119],v[172:175]
T a[232:233],v237,16384
M v[172:175],a[192:195],a[112:115],v[172:175]
s_waitcnt lgkmcnt(8)
T a[234:235],v237,18432
D v247,s[24:27],0
M v[144:147],a[208:211],a[144:147],v[144:147]
s_add_u32 m0,s45,81920
T v[20:21],v238,16384
M v[144:147],a[212:215],a[148:151],v[144:147]
s_add_u32 s24,s76,269312
T v[22:23],v238,18432
M v[144:147],a[236:239],a[152:155],v[144:147]
T v[24:25],v239,16384
M v[144:147],a[240:243],a[156:159],v[144:147]
T v[26:27],v239,18432
M v[160:163],a[240:243],a[172:175],v[160:163]
T v[28:29],v240,16384
M v[160:163],a[236:239],a[168:171],v[160:163]
T v[30:31],v240,18432
M v[160:163],a[212:215],a[164:167],v[160:163]
T v[32:33],v241,16384
M v[160:163],a[208:211],a[160:163],v[160:163]
T v[34:35],v241,18432
C v144,v144,v145
M v[176:179],a[208:211],a[176:179],v[176:179]
T a[192:193],v226,32768
C v145,v146,v147
M v[176:179],a[212:215],a[180:183],v[176:179]
T a[194:195],v226,34816
M v[176:179],a[236:239],a[184:187],v[176:179]
T a[196:197],v227,32768
C v160,v160,v161
M v[176:179],a[240:243],a[188:191],v[176:179]
T a[198:199],v227,34816
D v247,s[24:27],1024
M v[148:151],a[244:247],a[144:147],v[148:151]
s_add_u32 m0,s45,81920
T a[200:201],v228,32768
C v161,v162,v163
M v[148:151],a[248:251],a[148:151],v[148:151]
s_waitcnt vmcnt(16) lgkmcnt(5)
s_barrier
T a[202:203],v228,34816
C v176,v176,v177
M v[148:151],a[252:255],a[152:155],v[148:151]
s_add_u32 s24,s76,276480
T a[204:205],v229,32768
C v177,v178,v179
M v[148:151],a[216:219],a[156:159],v[148:151]
T a[206:207],v229,34816
M v[164:167],a[216:219],a[172:175],v[164:167]
T a[208:209],v230,32768
M v[164:167],a[252:255],a[168:171],v[164:167]
T a[210:211],v230,34816
M v[164:167],a[248:251],a[164:167],v[164:167]
T a[212:213],v231,32768
M v[164:167],a[244:247],a[160:163],v[164:167]
s_waitcnt vmcnt(11)
buffer_store_dword v206,v205,s[80:83],s101 offen offset:128 sc1
M v[168:171],a[220:223],a[160:163],v[168:171]
C v146,v148,v149
C v147,v150,v151
M v[168:171],a[224:227],a[164:167],v[168:171]
T a[214:215],v231,34816
M v[168:171],a[228:231],a[168:171],v[168:171]
C v162,v164,v165
C v163,v166,v167
M v[168:171],a[232:235],a[172:175],v[168:171]
T a[236:237],v232,32768
D v247,s[24:27],2048
M v[152:155],a[232:235],a[156:159],v[152:155]
s_add_u32 m0,s45,81920
T a[238:239],v232,34816
v_and_b32 v164,7,v208
M v[152:155],a[228:231],a[152:155],v[152:155]
s_add_u32 s24,s76,283648
T a[240:241],v233,32768
v_xor_b32 v209,v209,v164
M v[152:155],a[224:227],a[148:151],v[152:155]
s_add_u32 s3,s5,3
T a[242:243],v233,34816
C v168,v168,v169
M v[152:155],a[220:223],a[144:147],v[152:155]
s_and_b32 s3,s3,7
D v247,s[24:27],3072
C v169,v170,v171
M v[156:159],v[20:23],a[144:147],v[156:159]
s_mul_i32 s3,s3,147456
T a[244:245],v234,32768
v_lshlrev_b32 v209,4,v209
M v[156:159],v[24:27],a[148:151],v[156:159]
s_add_u32 s28,s3,s48
T a[246:247],v234,34816
v_lshl_add_u32 v209,v208,7,v209
M v[156:159],v[28:31],a[152:155],v[156:159]
s_add_u32 m0,s45,98304
T a[248:249],v235,32768
C v152,v152,v153
M v[156:159],v[32:35],a[156:159],v[156:159]
s_add_u32 s24,s76,393216
T a[250:251],v235,34816
C v153,v154,v155
M v[172:175],v[32:35],a[172:175],v[172:175]
T a[252:253],v236,32768
v_bfe_u32 v208,v207,8,1
M v[172:175],v[28:31],a[168:171],v[172:175]
T a[254:255],v236,34816
v_lshl_add_u32 v209,v208,3,v209
M v[172:175],v[24:27],a[164:167],v[172:175]
C v154,v156,v157
C v155,v158,v159
M v[172:175],v[20:23],a[160:163],v[172:175]
s_waitcnt lgkmcnt(6)
buffer_store_dwordx4 v[144:147],v200,s[28:31],0 offen offset:0 sc1
M v[72:75],a[192:195],a[0:3],0
T a[216:217],v237,32768
v_add_u32 v209,s45,v209
M v[72:75],a[196:199],a[4:7],v[72:75]
T a[218:219],v237,34816
v_add_u32 v164,81920,v209
M v[72:75],a[200:203],a[8:11],v[72:75]
buffer_store_dwordx4 v[152:155],v200,s[28:31],0 offen offset:1024 sc1
M v[72:75],a[204:207],a[12:15],v[72:75]
C v170,v172,v173
C v171,v174,v175
M v[88:91],a[204:207],a[28:31],0
T a[220:221],v238,32768
v_xor_b32 v165,32,v164
M v[88:91],a[200:203],a[24:27],v[88:91]
buffer_store_dwordx4 v[160:163],v200,s[28:31],0 offen offset:2048 sc1
M v[88:91],a[196:199],a[20:23],v[88:91]
T a[222:223],v238,34816
v_lshrrev_b32 v208,7,v207
M v[88:91],a[192:195],a[16:19],v[88:91]
T a[224:225],v239,32768
v_xor_b32 v166,64,v164
M v[104:107],a[192:195],a[32:35],0
buffer_store_dwordx4 v[168:171],v200,s[28:31],0 offen offset:3072 sc1
M v[104:107],a[196:199],a[36:39],v[104:107]
T a[226:227],v239,34816
v_lshlrev_b32 v209,4,v208
M v[104:107],a[200:203],a[40:43],v[104:107]
T a[228:229],v240,32768
v_xor_b32 v209,v209,v207
M v[104:107],a[204:207],a[44:47],v[104:107]
buffer_store_dwordx2 v[176:177],v201,s[28:31],0 offen offset:0 sc1
M v[76:79],a[208:211],a[0:3],0
T a[230:231],v240,34816
v_xor_b32 v167,96,v164
M v[76:79],a[212:215],a[4:7],v[76:79]
T a[232:233],v241,32768
v_add_u32 v209,s45,v209
M v[76:79],a[236:239],a[8:11],v[76:79]
T a[234:235],v241,34816
D v247,s[24:27],0
M v[76:79],a[240:243],a[12:15],v[76:79]
s_add_u32 m0,s45,98304
T v[20:21],v226,49152
v_add_u32 v202,81920,v209
M v[92:95],a[240:243],a[28:31],0
s_add_u32 s24,s76,400384
T v[22:23],v226,51200
v_and_b32 v209,0x70,v207
M v[92:95],a[236:239],a[24:27],v[92:95]
s_sub_u32 s3,s5,1
T v[24:25],v227,49152
v_lshl_add_u32 v209,v208,11,v209
M v[92:95],a[212:215],a[20:23],v[92:95]
s_and_b32 s3,s3,7
T v[26:27],v227,51200
D v247,s[24:27],1024
M v[92:95],a[208:211],a[16:19],v[92:95]
s_waitcnt lgkmcnt(7)
T v[28:29],v228,49152
v_lshl_add_u32 v168,s44,16,v209
M v[96:99],a[244:247],a[16:19],0
s_lshl_b32 s3,s3,12
T v[30:31],v228,51200
v_add_u32 v169,16384,v168
M v[96:99],a[248:251],a[20:23],v[96:99]
s_add_u32 s90,s3,s46
T v[32:33],v229,49152
v_add_u32 v170,32768,v168
M v[96:99],a[252:255],a[24:27],v[96:99]
s_add_u32 m0,s45,98304
buffer_load_dword v254,off,s[80:83],s90 offset:0 sc1
M v[96:99],a[216:219],a[28:31],v[96:99]
s_add_u32 s24,s76,407552
T v[34:35],v229,51200
v_add_u32 v171,49152,v168
M v[80:83],a[216:219],a[12:15],0
T a[192:193],v230,49152
M v[80:83],a[252:255],a[8:11],v[80:83]
T a[194:195],v230,51200
M v[80:83],a[248:251],a[4:7],v[80:83]
T a[196:197],v231,49152
D v247,s[24:27],2048
M v[80:83],a[244:247],a[0:3],v[80:83]
s_add_u32 m0,s45,98304
T a[198:199],v231,51200
M v[84:87],a[220:223],a[0:3],0
s_add_u32 s24,s76,414720
T a[200:201],v232,49152
M v[84:87],a[224:227],a[4:7],v[84:87]
s_waitcnt lgkmcnt(7)
s_sub_u32 s3,s5,2
T a[202:203],v232,51200
M v[84:87],a[228:231],a[8:11],v[84:87]
s_and_b32 s3,s3,7
T a[204:205],v233,49152
D v247,s[24:27],3072
M v[84:87],a[232:235],a[12:15],v[84:87]
s_lshl_b32 s3,s3,12
T a[206:207],v233,51200
M v[100:103],a[232:235],a[28:31],0
s_add_u32 s91,s3,s46
T a[208:209],v234,49152
M v[100:103],a[228:231],a[24:27],v[100:103]
s_add_u32 m0,s45,114688
T a[210:211],v234,51200
M v[100:103],a[224:227],a[20:23],v[100:103]
s_add_u32 s24,s77,0
T a[212:213],v235,49152
M v[100:103],a[220:223],a[16:19],v[100:103]
T a[214:215],v235,51200
M v[72:75],v[20:23],a[48:51],v[72:75]
T a[236:237],v236,49152
M v[72:75],v[24:27],a[52:55],v[72:75]
T a[238:239],v236,51200
M v[72:75],v[28:31],a[56:59],v[72:75]
s_waitcnt lgkmcnt(8)
T a[240:241],v237,49152
M v[72:75],v[32:35],a[60:63],v[72:75]
T a[242:243],v237,51200
M v[88:91],v[32:35],a[76:79],v[88:91]
T a[244:245],v238,49152
M v[88:91],v[28:31],a[72:75],v[88:91]
T a[246:247],v238,51200
M v[88:91],v[24:27],a[68:71],v[88:91]
T a[248:249],v239,49152
M v[88:91],v[20:23],a[64:67],v[88:91]
T a[250:251],v239,51200
M v[104:107],v[20:23],a[80:83],v[104:107]
T a[252:253],v240,49152
M v[104:107],v[24:27],a[84:87],v[104:107]
T a[254:255],v240,51200
M v[104:107],v[28:31],a[88:91],v[104:107]
T a[216:217],v241,49152
M v[104:107],v[32:35],a[92:95],v[104:107]
T a[218:219],v241,51200
M v[76:79],a[192:195],a[48:51],v[76:79]
T a[220:221],v210,49152
M v[76:79],a[196:199],a[52:55],v[76:79]
T a[222:223],v210,51200
M v[76:79],a[200:203],a[56:59],v[76:79]
s_waitcnt lgkmcnt(8)
T a[224:225],v211,49152
M v[76:79],a[204:207],a[60:63],v[76:79]
T a[226:227],v211,51200
M v[92:95],a[204:207],a[76:79],v[92:95]
T a[228:229],v212,49152
M v[92:95],a[200:203],a[72:75],v[92:95]
s_waitcnt vmcnt(15) lgkmcnt(5)
s_barrier
T a[230:231],v212,51200
M v[92:95],a[196:199],a[68:71],v[92:95]
T a[232:233],v213,49152
M v[92:95],a[192:195],a[64:67],v[92:95]
T a[234:235],v213,51200
M v[96:99],a[208:211],a[64:67],v[96:99]
T v[20:21],v214,49152
M v[96:99],a[212:215],a[68:71],v[96:99]
T v[22:23],v214,51200
M v[96:99],a[236:239],a[72:75],v[96:99]
T v[24:25],v215,49152
M v[96:99],a[240:243],a[76:79],v[96:99]
T v[26:27],v215,51200
M v[80:83],a[240:243],a[60:63],v[80:83]
T v[28:29],v216,49152
M v[80:83],a[236:239],a[56:59],v[80:83]
T v[30:31],v216,51200
M v[80:83],a[212:215],a[52:55],v[80:83]
T v[32:33],v217,49152
M v[80:83],a[208:211],a[48:51],v[80:83]
buffer_load_dword v255,off,s[80:83],s91 offset:128 sc1
M v[84:87],a[244:247],a[48:51],v[84:87]
T v[34:35],v217,51200
M v[84:87],a[248:251],a[52:55],v[84:87]
T a[192:193],v218,49152
M v[84:87],a[252:255],a[56:59],v[84:87]
T a[194:195],v218,51200
M v[84:87],a[216:219],a[60:63],v[84:87]
T a[196:197],v219,49152
M v[100:103],a[216:219],a[76:79],v[100:103]
T a[198:199],v219,51200
M v[100:103],a[252:255],a[72:75],v[100:103]
T a[200:201],v220,49152
M v[100:103],a[248:251],a[68:71],v[100:103]
T a[202:203],v220,51200
M v[100:103],a[244:247],a[64:67],v[100:103]
s_waitcnt lgkmcnt(7)
T a[204:205],v221,49152
D v247,s[24:27],0
M v[72:75],a[220:223],a[96:99],v[72:75]
s_add_u32 m0,s45,114688
T a[206:207],v221,51200
M v[72:75],a[224:227],a[100:103],v[72:75]
s_add_u32 s24,s77,7168
T a[208:209],v222,49152
M v[72:75],a[228:231],a[104:107],v[72:75]
s_sub_u32 s3,s5,1
T a[210:211],v222,51200
M v[72:75],a[232:235],a[108:111],v[72:75]
s_and_b32 s3,s3,7
T a[212:213],v223,49152
M v[88:91],a[232:235],a[124:127],v[88:91]
s_mul_i32 s3,s3,18432
T a[214:215],v223,51200
M v[88:91],a[228:231],a[120:123],v[88:91]
s_add_u32 s8,s3,s49
T a[236:237],v224,49152
M v[88:91],a[224:227],a[116:119],v[88:91]
T a[238:239],v224,51200
M v[88:91],a[220:223],a[112:115],v[88:91]
T a[240:241],v225,49152
M v[104:107],a[220:223],a[128:131],v[104:107]
T a[242:243],v225,51200
M v[104:107],a[224:227],a[132:135],v[104:107]
T a[244:245],v210,32768
M v[104:107],a[228:231],a[136:139],v[104:107]
T a[246:247],v210,34816
M v[104:107],a[232:235],a[140:143],v[104:107]
T a[248:249],v211,32768
D v247,s[24:27],1024
M v[76:79],v[20:23],a[96:99],v[76:79]
s_add_u32 m0,s45,114688
T a[250:251],v211,34816
M v[76:79],v[24:27],a[100:103],v[76:79]
s_add_u32 s24,s77,14336
T a[252:253],v212,32768
M v[76:79],v[28:31],a[104:107],v[76:79]
s_waitcnt lgkmcnt(8)
T a[254:255],v212,34816
M v[76:79],v[32:35],a[108:111],v[76:79]
T a[216:217],v213,32768
M v[92:95],v[32:35],a[124:127],v[92:95]
T a[218:219],v213,34816
M v[92:95],v[28:31],a[120:123],v[92:95]
T a[220:221],v214,32768
M v[92:95],v[24:27],a[116:119],v[92:95]
T a[222:223],v214,34816
M v[92:95],v[20:23],a[112:115],v[92:95]
s_waitcnt vmcnt(8)
buffer_store_dword v206,v205,s[80:83],s101 offen offset:256 sc1
M v[96:99],a[192:195],a[112:115],v[96:99]
s_waitcnt vmcnt(6)
v_cmp_eq_u32 vcc,1,v254
s_cbranch_vccz L_sp0
L_rt0:
M v[96:99],a[196:199],a[116:119],v[96:99]
T a[224:225],v215,32768
M v[96:99],a[200:203],a[120:123],v[96:99]
T a[226:227],v215,34816
M v[96:99],a[204:207],a[124:127],v[96:99]
T a[228:229],v216,32768
buffer_load_dwordx2 v[16:17],v201,s[8:11],0 offen offset:0 sc1
M v[80:83],a[204:207],a[108:111],v[80:83]
T a[230:231],v216,34816
M v[80:83],a[200:203],a[104:107],v[80:83]
T a[232:233],v217,32768
M v[80:83],a[196:199],a[100:103],v[80:83]
T a[234:235],v217,34816
M v[80:83],a[192:195],a[96:99],v[80:83]
T v[20:21],v218,32768
D v247,s[24:27],2048
M v[84:87],a[208:211],a[96:99],v[84:87]
s_add_u32 m0,s45,114688
T v[22:23],v218,34816
M v[84:87],a[212:215],a[100:103],v[84:87]
s_waitcnt lgkmcnt(8)
s_add_u32 s24,s77,21504
T v[24:25],v219,32768
M v[84:87],a[236:239],a[104:107],v[84:87]
T v[26:27],v219,34816
M v[84:87],a[240:243],a[108:111],v[84:87]
T v[28:29],v220,32768
buffer_load_dwordx4 v[0:3],v200,s[8:11],0 offen offset:0 sc1
M v[100:103],a[240:243],a[124:127],v[100:103]
T v[30:31],v220,34816
M v[100:103],a[236:239],a[120:123],v[100:103]
T v[32:33],v221,32768
M v[100:103],a[212:215],a[116:119],v[100:103]
T v[34:35],v221,34816
M v[100:103],a[208:211],a[112:115],v[100:103]
T a[192:193],v222,32768
D v247,s[24:27],3072
M v[72:75],a[244:247],a[144:147],v[72:75]
s_add_u32 m0,s45,131072
T a[194:195],v222,34816
M v[72:75],a[248:251],a[148:151],v[72:75]
s_add_u32 s24,s77,131072
T a[196:197],v223,32768
M v[72:75],a[252:255],a[152:155],v[72:75]
T a[198:199],v223,34816
M v[72:75],a[216:219],a[156:159],v[72:75]
T a[200:201],v224,32768
buffer_load_dwordx4 v[4:7],v200,s[8:11],0 offen offset:1024 sc1
M v[88:91],a[216:219],a[172:175],v[88:91]
T a[202:203],v224,34816
M v[88:91],a[252:255],a[168:171],v[88:91]
T a[204:205],v225,32768
M v[88:91],a[248:251],a[164:167],v[88:91]
T a[206:207],v225,34816
M v[88:91],a[244:247],a[160:163],v[88:91]
T a[208:209],v210,0
D v247,s[24:27],0
M v[104:107],a[244:247],a[176:179],v[104:107]
s_add_u32 m0,s45,131072
T a[210:211],v210,2048
C v72,v72,v73
M v[104:107],a[248:251],a[180:183],v[104:107]
s_add_u32 s24,s77,138240
T a[212:213],v211,0
C v73,v74,v75
M v[104:107],a[252:255],a[184:187],v[104:107]
T a[214:215],v211,2048
C v88,v88,v89
M v[104:107],a[216:219],a[188:191],v[104:107]
T a[236:237],v212,0
buffer_load_dwordx4 v[8:11],v200,s[8:11],0 offen offset:2048 sc1
M v[76:79],a[220:223],a[144:147],v[76:79]
s_waitcnt vmcnt(11) lgkmcnt(5)
s_barrier
T a[238:239],v212,2048
C v89,v90,v91
M v[76:79],a[224:227],a[148:151],v[76:79]
T a[240:241],v213,0
C v104,v104,v105
M v[76:79],a[228:231],a[152:155],v[76:79]
T a[242:243],v213,2048
D v247,s[24:27],1024
M v[76:79],a[232:235],a[156:159],v[76:79]
s_add_u32 m0,s45,131072
T a[244:245],v214,0
C v105,v106,v107
M v[92:95],a[232:235],a[172:175],v[92:95]
s_add_u32 s24,s77,145408
T a[246:247],v214,2048
M v[92:95],a[228:231],a[168:171],v[92:95]
s_sub_u32 s3,s5,2
T a[248:249],v215,0
M v[92:95],a[224:227],a[164:167],v[92:95]
L_pg22:
s_cmp_eq_u32 s47,1
s_cbranch_scc1 L_bkB20_0
s_and_b32 s3,s3,7
C v74,v76,v77
C v75,v78,v79
M v[92:95],a[220:223],a[160:163],v[92:95]
s_mul_i32 s3,s3,18432
T a[250:251],v215,2048
buffer_load_dwordx4 v[12:15],v200,s[8:11],0 offen offset:3072 sc1
M v[96:99],v[20:23],a[160:163],v[96:99]
s_add_u32 s8,s3,s49
T a[252:253],v216,0
M v[96:99],v[24:27],a[164:167],v[96:99]
T a[254:255],v216,2048
M v[96:99],v[28:31],a[168:171],v[96:99]
C v90,v92,v93
C v91,v94,v95
M v[96:99],v[32:35],a[172:175],v[96:99]
T a[216:217],v217,0
D v247,s[24:27],2048
M v[80:83],v[32:35],a[156:159],v[80:83]
s_add_u32 m0,s45,131072
T a[218:219],v217,2048
M v[80:83],v[28:31],a[152:155],v[80:83]
s_add_u32 s24,s77,152576
T a[220:221],v218,0
M v[80:83],v[24:27],a[148:151],v[80:83]
s_add_u32 s3,s5,4
T a[222:223],v218,2048
C v96,v96,v97
M v[80:83],v[20:23],a[144:147],v[80:83]
s_waitcnt vmcnt(13)
v_cmp_eq_u32 vcc,1,v255
s_cbranch_vccz L_sp1
L_rt1:
M v[84:87],a[192:195],a[144:147],v[84:87]
s_and_b32 s3,s3,7
buffer_load_dwordx2 v[196:197],v201,s[8:11],0 offen offset:0 sc1
C v97,v98,v99
M v[84:87],a[196:199],a[148:151],v[84:87]
s_mul_i32 s3,s3,147456
T a[224:225],v219,0
M v[84:87],a[200:203],a[152:155],v[84:87]
s_add_u32 s28,s3,s48
T a[226:227],v219,2048
C v80,v80,v81
M v[84:87],a[204:207],a[156:159],v[84:87]
T a[228:229],v220,0
C v81,v82,v83
M v[100:103],a[204:207],a[172:175],v[100:103]
T a[230:231],v220,2048
D v247,s[24:27],3072
M v[100:103],a[200:203],a[168:171],v[100:103]
s_add_u32 m0,s45,49152
T a[232:233],v221,0
M v[100:103],a[196:199],a[164:167],v[100:103]
s_add_u32 s24,s77,262144
C v82,v84,v85
C v83,v86,v87
M v[100:103],a[192:195],a[160:163],v[100:103]
s_waitcnt lgkmcnt(5)
T a[234:235],v221,2048
M v[108:111],a[208:211],a[0:3],0
T v[20:21],v222,0
buffer_load_dwordx4 v[180:183],v200,s[8:11],0 offen offset:0 sc1
M v[108:111],a[212:215],a[4:7],v[108:111]
T v[22:23],v222,2048
M v[108:111],a[236:239],a[8:11],v[108:111]
C v98,v100,v101
C v99,v102,v103
M v[108:111],a[240:243],a[12:15],v[108:111]
T v[24:25],v223,0
M v[124:127],a[240:243],a[28:31],0
buffer_store_dwordx4 v[72:75],v200,s[28:31],0 offen offset:0 sc1
M v[124:127],a[236:239],a[24:27],v[124:127]
T v[26:27],v223,2048
M v[124:127],a[212:215],a[20:23],v[124:127]
T v[28:29],v224,0
M v[124:127],a[208:211],a[16:19],v[124:127]
buffer_store_dwordx4 v[80:83],v200,s[28:31],0 offen offset:1024 sc1
M v[140:143],a[208:211],a[32:35],0
T v[30:31],v224,2048
M v[140:143],a[212:215],a[36:39],v[140:143]
T v[32:33],v225,0
M v[140:143],a[236:239],a[40:43],v[140:143]
buffer_store_dwordx4 v[88:91],v200,s[28:31],0 offen offset:2048 sc1
M v[140:143],a[240:243],a[44:47],v[140:143]
T v[34:35],v225,2048
M v[112:115],a[244:247],a[0:3],0
T a[192:193],v210,16384
M v[112:115],a[248:251],a[4:7],v[112:115]
buffer_store_dwordx4 v[96:99],v200,s[28:31],0 offen offset:3072 sc1
M v[112:115],a[252:255],a[8:11],v[112:115]
T a[194:195],v210,18432
M v[112:115],a[216:219],a[12:15],v[112:115]
T a[196:197],v211,16384
M v[128:131],a[216:219],a[28:31],0
buffer_store_dwordx2 v[104:105],v201,s[28:31],0 offen offset:0 sc1
M v[128:131],a[252:255],a[24:27],v[128:131]
T a[198:199],v211,18432
M v[128:131],a[248:251],a[20:23],v[128:131]
T a[200:201],v212,16384
M v[128:131],a[244:247],a[16:19],v[128:131]
T a[202:203],v212,18432
D v247,s[24:27],0
M v[132:135],a[220:223],a[16:19],0
s_waitcnt lgkmcnt(5)
s_add_u32 m0,s45,49152
T a[204:205],v213,16384
M v[132:135],a[224:227],a[20:23],v[132:135]
s_add_u32 s24,s77,269312
T a[206:207],v213,18432
M v[132:135],a[228:231],a[24:27],v[132:135]
s_sub_u32 s3,s5,3
T a[208:209],v214,16384
M v[132:135],a[232:235],a[28:31],v[132:135]
s_and_b32 s3,s3,7
T a[210:211],v214,18432
buffer_load_dwordx4 v[184:187],v200,s[8:11],0 offen offset:1024 sc1
M v[116:119],a[232:235],a[12:15],0
s_lshl_b32 s3,s3,12
T a[212:213],v215,16384
M v[116:119],a[228:231],a[8:11],v[116:119]
s_add_u32 s90,s3,s46
T a[214:215],v215,18432
M v[116:119],a[224:227],a[4:7],v[116:119]
T a[236:237],v216,16384
M v[116:119],a[220:223],a[0:3],v[116:119]
T a[238:239],v216,18432
D v247,s[24:27],1024
M v[120:123],v[20:23],a[0:3],0
s_add_u32 m0,s45,49152
T a[240:241],v217,16384
M v[120:123],v[24:27],a[4:7],v[120:123]
s_add_u32 s24,s77,276480
T a[242:243],v217,18432
M v[120:123],v[28:31],a[8:11],v[120:123]
T a[244:245],v218,16384
M v[120:123],v[32:35],a[12:15],v[120:123]
T a[246:247],v218,18432
buffer_load_dwordx4 v[188:191],v200,s[8:11],0 offen offset:2048 sc1
M v[136:139],v[32:35],a[28:31],0
T a[248:249],v219,16384
M v[136:139],v[28:31],a[24:27],v[136:139]
T a[250:251],v219,18432
M v[136:139],v[24:27],a[20:23],v[136:139]
T a[252:253],v220,16384
M v[136:139],v[20:23],a[16:19],v[136:139]
s_waitcnt lgkmcnt(8)
buffer_load_dword v254,off,s[80:83],s90 offset:256 sc1
M v[108:111],a[192:195],a[48:51],v[108:111]
T a[254:255],v220,18432
M v[108:111],a[196:199],a[52:55],v[108:111]
T a[216:217],v221,16384
M v[108:111],a[200:203],a[56:59],v[108:111]
T a[218:219],v221,18432
M v[108:111],a[204:207],a[60:63],v[108:111]
T a[220:221],v222,16384
D v247,s[24:27],2048
M v[124:127],a[204:207],a[76:79],v[124:127]
s_add_u32 m0,s45,49152
T a[222:223],v222,18432
M v[124:127],a[200:203],a[72:75],v[124:127]
s_add_u32 s24,s77,283648
T a[224:225],v223,16384
M v[124:127],a[196:199],a[68:71],v[124:127]
T a[226:227],v223,18432
M v[124:127],a[192:195],a[64:67],v[124:127]
T a[228:229],v224,16384
buffer_load_dwordx4 v[192:195],v200,s[8:11],0 offen offset:3072 sc1
M v[140:143],a[192:195],a[80:83],v[140:143]
T a[230:231],v224,18432
M v[140:143],a[196:199],a[84:87],v[140:143]
T a[232:233],v225,16384
M v[140:143],a[200:203],a[88:91],v[140:143]
T a[234:235],v225,18432
M v[140:143],a[204:207],a[92:95],v[140:143]
T v[20:21],v226,0
D v247,s[24:27],3072
M v[112:115],a[208:211],a[48:51],v[112:115]
s_add_u32 m0,s45,32768
T v[22:23],v226,2048
M v[112:115],a[212:215],a[52:55],v[112:115]
s_waitcnt lgkmcnt(8)
s_add_u32 s24,s77,393216
T v[24:25],v227,0
M v[112:115],a[236:239],a[56:59],v[112:115]
T v[26:27],v227,2048
M v[112:115],a[240:243],a[60:63],v[112:115]
T v[28:29],v228,0
D v247,s[24:27],0
M v[128:131],a[240:243],a[76:79],v[128:131]
s_waitcnt vmcnt(15) lgkmcnt(5)
s_barrier
s_add_u32 m0,s45,32768
T v[30:31],v228,2048
M v[128:131],a[236:239],a[72:75],v[128:131]
s_add_u32 s24,s77,400384
T v[32:33],v229,0
M v[128:131],a[212:215],a[68:71],v[128:131]
T v[34:35],v229,2048
D v247,s[24:27],1024
M v[128:131],a[208:211],a[64:67],v[128:131]
s_add_u32 m0,s45,32768
T a[192:193],v230,0
M v[132:135],a[244:247],a[64:67],v[132:135]
s_add_u32 s24,s77,407552
T a[194:195],v230,2048
M v[132:135],a[248:251],a[68:71],v[132:135]
T a[196:197],v231,0
M v[132:135],a[252:255],a[72:75],v[132:135]
T a[198:199],v231,2048
D v247,s[24:27],2048
M v[132:135],a[216:219],a[76:79],v[132:135]
s_add_u32 m0,s45,32768
T a[200:201],v232,0
M v[116:119],a[216:219],a[60:63],v[116:119]
s_add_u32 s24,s77,414720
T a[202:203],v232,2048
M v[116:119],a[252:255],a[56:59],v[116:119]
T a[204:205],v233,0
M v[116:119],a[248:251],a[52:55],v[116:119]
T a[206:207],v233,2048
M v[116:119],a[244:247],a[48:51],v[116:119]
T a[208:209],v234,0
D v247,s[24:27],3072
M v[120:123],a[220:223],a[48:51],v[120:123]
s_add_u32 m0,s45,0
T a[210:211],v234,2048
M v[120:123],a[224:227],a[52:55],v[120:123]
s_add_u32 s24,s78,0
T a[212:213],v235,0
M v[120:123],a[228:231],a[56:59],v[120:123]
T a[214:215],v235,2048
M v[120:123],a[232:235],a[60:63],v[120:123]
T a[236:237],v236,0
M v[136:139],a[232:235],a[76:79],v[136:139]
T a[238:239],v236,2048
M v[136:139],a[228:231],a[72:75],v[136:139]
T a[240:241],v237,0
M v[136:139],a[224:227],a[68:71],v[136:139]
T a[242:243],v237,2048
M v[136:139],a[220:223],a[64:67],v[136:139]
s_waitcnt lgkmcnt(8)
T a[244:245],v238,0
D v247,s[24:27],0
M v[108:111],v[20:23],a[96:99],v[108:111]
s_add_u32 m0,s45,0
T a[246:247],v238,2048
v_lshlrev_b32 v68,16,v16
M v[108:111],v[24:27],a[100:103],v[108:111]
s_add_u32 s24,s78,7168
T a[248:249],v239,0
v_and_b32 v69,0xffff0000,v16
M v[108:111],v[28:31],a[104:107],v[108:111]
s_sub_u32 s3,s5,3
T a[250:251],v239,2048
v_lshlrev_b32 v70,16,v17
M v[108:111],v[32:35],a[108:111],v[108:111]
s_and_b32 s3,s3,7
T a[252:253],v240,0
v_and_b32 v71,0xffff0000,v17
M v[124:127],v[32:35],a[124:127],v[124:127]
s_mul_i32 s3,s3,18432
T a[254:255],v240,2048
v_lshlrev_b32 v36,16,v0
M v[124:127],v[28:31],a[120:123],v[124:127]
s_add_u32 s8,s3,s49
T a[216:217],v241,0
v_and_b32 v37,0xffff0000,v0
M v[124:127],v[24:27],a[116:119],v[124:127]
T a[218:219],v241,2048
v_lshlrev_b32 v38,16,v1
M v[124:127],v[20:23],a[112:115],v[124:127]
T a[220:221],v226,16384
v_and_b32 v39,0xffff0000,v1
M v[140:143],v[20:23],a[128:131],v[140:143]
T a[222:223],v226,18432
v_lshlrev_b32 v40,16,v2
M v[140:143],v[24:27],a[132:135],v[140:143]
T a[224:225],v227,16384
v_and_b32 v41,0xffff0000,v2
M v[140:143],v[28:31],a[136:139],v[140:143]
T a[226:227],v227,18432
v_lshlrev_b32 v42,16,v3
M v[140:143],v[32:35],a[140:143],v[140:143]
T a[228:229],v228,16384
D v247,s[24:27],1024
M v[112:115],a[192:195],a[96:99],v[112:115]
s_add_u32 m0,s45,0
T a[230:231],v228,18432
v_and_b32 v43,0xffff0000,v3
M v[112:115],a[196:199],a[100:103],v[112:115]
s_add_u32 s24,s78,14336
T a[232:233],v229,16384
v_lshlrev_b32 v44,16,v4
M v[112:115],a[200:203],a[104:107],v[112:115]
T a[234:235],v229,18432
v_and_b32 v45,0xffff0000,v4
M v[112:115],a[204:207],a[108:111],v[112:115]
T v[20:21],v230,16384
v_lshlrev_b32 v46,16,v5
M v[128:131],a[204:207],a[124:127],v[128:131]
T v[22:23],v230,18432
v_and_b32 v47,0xffff0000,v5
M v[128:131],a[200:203],a[120:123],v[128:131]
T v[24:25],v231,16384
v_lshlrev_b32 v48,16,v6
M v[128:131],a[196:199],a[116:119],v[128:131]
T v[26:27],v231,18432
v_and_b32 v49,0xffff0000,v6
M v[128:131],a[192:195],a[112:115],v[128:131]
s_waitcnt vmcnt(14) lgkmcnt(8)
buffer_store_dword v206,v205,s[80:83],s101 offen offset:384 sc1
M v[132:135],a[208:211],a[112:115],v[132:135]
s_waitcnt vmcnt(10)
v_cmp_eq_u32 vcc,1,v254
s_cbranch_vccz L_sp2
L_rt2:
M v[132:135],a[212:215],a[116:119],v[132:135]
T v[28:29],v232,16384
v_lshlrev_b32 v50,16,v7
M v[132:135],a[236:239],a[120:123],v[132:135]
T v[30:31],v232,18432
v_and_b32 v51,0xffff0000,v7
M v[132:135],a[240:243],a[124:127],v[132:135]
T v[32:33],v233,16384
buffer_load_dwordx2 v[160:161],v201,s[8:11],0 offen offset:0 sc1
M v[116:119],a[240:243],a[108:111],v[116:119]
T v[34:35],v233,18432
v_lshlrev_b32 v52,16,v8
M v[116:119],a[236:239],a[104:107],v[116:119]
T a[192:193],v234,16384
v_and_b32 v53,0xffff0000,v8
M v[116:119],a[212:215],a[100:103],v[116:119]
T a[194:195],v234,18432
v_lshlrev_b32 v54,16,v9
M v[116:119],a[208:211],a[96:99],v[116:119]
T a[196:197],v235,16384
D v247,s[24:27],2048
M v[120:123],a[244:247],a[96:99],v[120:123]
s_add_u32 m0,s45,0
T a[198:199],v235,18432
v_and_b32 v55,0xffff0000,v9
M v[120:123],a[248:251],a[100:103],v[120:123]
s_add_u32 s24,s78,21504
T a[200:201],v236,16384
v_lshlrev_b32 v56,16,v10
M v[120:123],a[252:255],a[104:107],v[120:123]
T a[202:203],v236,18432
v_and_b32 v57,0xffff0000,v10
M v[120:123],a[216:219],a[108:111],v[120:123]
T a[204:205],v237,16384
buffer_load_dwordx4 v[144:147],v200,s[8:11],0 offen offset:0 sc1
M v[136:139],a[216:219],a[124:127],v[136:139]
T a[206:207],v237,18432
v_lshlrev_b32 v58,16,v11
M v[136:139],a[252:255],a[120:123],v[136:139]
T a[208:209],v238,16384
v_and_b32 v59,0xffff0000,v11
M v[136:139],a[248:251],a[116:119],v[136:139]
T a[210:211],v238,18432
v_lshlrev_b32 v60,16,v12
M v[136:139],a[244:247],a[112:115],v[136:139]
T a[212:213],v239,16384
D v247,s[24:27],3072
M v[108:111],a[220:223],a[144:147],v[108:111]
s_add_u32 m0,s45,16384
T a[214:215],v239,18432
v_and_b32 v61,0xffff0000,v12
M v[108:111],a[224:227],a[148:151],v[108:111]
s_waitcnt lgkmcnt(8)
T a[236:237],v240,16384
v_lshlrev_b32 v62,16,v13
M v[108:111],a[228:231],a[152:155],v[108:111]
s_add_u32 s24,s78,131072
T a[238:239],v240,18432
v_and_b32 v63,0xffff0000,v13
M v[108:111],a[232:235],a[156:159],v[108:111]
T a[240:241],v241,16384
buffer_load_dwordx4 v[148:151],v200,s[8:11],0 offen offset:1024 sc1
M v[124:127],a[232:235],a[172:175],v[124:127]
T a[242:243],v241,18432
v_lshlrev_b32 v64,16,v14
M v[124:127],a[228:231],a[168:171],v[124:127]
T a[244:245],v226,32768
v_and_b32 v65,0xffff0000,v14
M v[124:127],a[224:227],a[164:167],v[124:127]
T a[246:247],v226,34816
C v108,v108,v109
M v[124:127],a[220:223],a[160:163],v[124:127]
T a[248:249],v227,32768
D v247,s[24:27],0
M v[140:143],a[220:223],a[176:179],v[140:143]
s_add_u32 m0,s45,16384
T a[250:251],v227,34816
C v109,v110,v111
M v[140:143],a[224:227],a[180:183],v[140:143]
s_add_u32 s24,s78,138240
T a[252:253],v228,32768
v_lshlrev_b32 v66,16,v15
M v[140:143],a[228:231],a[184:187],v[140:143]
s_waitcnt vmcnt(9) lgkmcnt(5)
s_barrier
T a[254:255],v228,34816
C v124,v124,v125
M v[140:143],a[232:235],a[188:191],v[140:143]
T a[216:217],v229,32768
buffer_load_dwordx4 v[152:155],v200,s[8:11],0 offen offset:2048 sc1
M v[112:115],v[20:23],a[144:147],v[112:115]
T a[218:219],v229,34816
C v125,v126,v127
M v[112:115],v[24:27],a[148:151],v[112:115]
T a[220:221],v230,32768
v_and_b32 v67,0xffff0000,v15
M v[112:115],v[28:31],a[152:155],v[112:115]
T a[222:223],v230,34816
C v140,v140,v141
M v[112:115],v[32:35],a[156:159],v[112:115]
T a[224:225],v231,32768
D v247,s[24:27],1024
M v[128:131],v[32:35],a[172:175],v[128:131]
s_add_u32 m0,s45,16384
T a[226:227],v231,34816
C v141,v142,v143
M v[128:131],v[28:31],a[168:171],v[128:131]
s_add_u32 s24,s78,145408
T a[228:229],v232,32768
v_lshlrev_b32 v198,16,v196
M v[128:131],v[24:27],a[164:167],v[128:131]
C v110,v112,v113
C v111,v114,v115
M v[128:131],v[20:23],a[160:163],v[128:131]
T a[230:231],v232,34816
buffer_load_dwordx4 v[156:159],v200,s[8:11],0 offen offset:3072 sc1
M v[132:135],a[192:195],a[160:163],v[132:135]
T a[232:233],v233,32768
v_and_b32 v196,s58,v196
M v[132:135],a[196:199],a[164:167],v[132:135]
T a[234:235],v233,34816
v_lshlrev_b32 v199,16,v197
M v[132:135],a[200:203],a[168:171],v[132:135]
C v126,v128,v129
C v127,v130,v131
M v[132:135],a[204:207],a[172:175],v[132:135]
T v[20:21],v234,32768
D v247,s[24:27],2048
M v[116:119],a[204:207],a[156:159],v[116:119]
s_add_u32 m0,s45,16384
T v[22:23],v234,34816
v_and_b32 v197,s58,v197
M v[116:119],a[200:203],a[152:155],v[116:119]
s_add_u32 s24,s78,152576
T v[24:25],v235,32768
v_add_f32 v68,v68,v198
M v[116:119],a[196:199],a[148:151],v[116:119]
s_add_u32 s3,s5,5
T v[26:27],v235,34816
C v132,v132,v133
M v[116:119],a[192:195],a[144:147],v[116:119]
s_and_b32 s3,s3,7
D v247,s[24:27],3072
C v133,v134,v135
M v[120:123],a[208:211],a[144:147],v[120:123]
s_mul_i32 s3,s3,147456
T v[28:29],v236,32768
v_add_f32 v69,v69,v196
M v[120:123],a[212:215],a[148:151],v[120:123]
s_add_u32 s28,s3,s48
T v[30:31],v236,34816
v_add_f32 v70,v70,v199
M v[120:123],a[236:239],a[152:155],v[120:123]
s_add_u32 m0,s45,81920
T v[32:33],v237,32768
C v116,v116,v117
M v[120:123],a[240:243],a[156:159],v[120:123]
s_add_u32 s24,s78,262144
T v[34:35],v237,34816
C v117,v118,v119
M v[136:139],a[240:243],a[172:175],v[136:139]
T a[192:193],v238,32768
v_add_f32 v71,v71,v197
M v[136:139],a[236:239],a[168:171],v[136:139]
T a[194:195],v238,34816
v_lshlrev_b32 v198,16,v180
M v[136:139],a[212:215],a[164:167],v[136:139]
C v118,v120,v121
C v119,v122,v123
M v[136:139],a[208:211],a[160:163],v[136:139]
s_waitcnt lgkmcnt(6)
buffer_store_dwordx4 v[108:111],v200,s[28:31],0 offen offset:0 sc1
M v[72:75],a[244:247],a[0:3],0
T a[196:197],v239,32768
v_lshlrev_b32 v199,16,v181
M v[72:75],a[248:251],a[4:7],v[72:75]
T a[198:199],v239,34816
v_add_f32 v36,v36,v198
M v[72:75],a[252:255],a[8:11],v[72:75]
buffer_store_dwordx4 v[116:119],v200,s[28:31],0 offen offset:1024 sc1
M v[72:75],a[216:219],a[12:15],v[72:75]
C v134,v136,v137
C v135,v138,v139
M v[88:91],a[216:219],a[28:31],0
T a[200:201],v240,32768
v_and_b32 v180,s58,v180
M v[88:91],a[252:255],a[24:27],v[88:91]
buffer_store_dwordx4 v[124:127],v200,s[28:31],0 offen offset:2048 sc1
M v[88:91],a[248:251],a[20:23],v[88:91]
T a[202:203],v240,34816
v_add_f32 v38,v38,v199
M v[88:91],a[244:247],a[16:19],v[88:91]
T a[204:205],v241,32768
v_and_b32 v181,s58,v181
M v[104:107],a[244:247],a[32:35],0
buffer_store_dwordx4 v[132:135],v200,s[28:31],0 offen offset:3072 sc1
M v[104:107],a[248:251],a[36:39],v[104:107]
T a[206:207],v241,34816
v_lshlrev_b32 v198,16,v182
M v[104:107],a[252:255],a[40:43],v[104:107]
T a[208:209],v226,49152
v_and_b32 v182,s58,v182
M v[104:107],a[216:219],a[44:47],v[104:107]
buffer_store_dwordx2 v[140:141],v201,s[28:31],0 offen offset:0 sc1
M v[76:79],a[220:223],a[0:3],0
T a[210:211],v226,51200
v_lshlrev_b32 v199,16,v183
M v[76:79],a[224:227],a[4:7],v[76:79]
T a[212:213],v227,49152
v_and_b32 v183,s58,v183
M v[76:79],a[228:231],a[8:11],v[76:79]
T a[214:215],v227,51200
D v247,s[24:27],0
M v[76:79],a[232:235],a[12:15],v[76:79]
s_add_u32 m0,s45,81920
T a[236:237],v228,49152
v_add_f32 v37,v37,v180
M v[92:95],a[232:235],a[28:31],0
s_add_u32 s24,s78,269312
T a[238:239],v228,51200
v_add_f32 v39,v39,v181
M v[92:95],a[228:231],a[24:27],v[92:95]
s_sub_u32 s3,s5,4
T a[240:241],v229,49152
v_add_f32 v40,v40,v198
M v[92:95],a[224:227],a[20:23],v[92:95]
s_and_b32 s3,s3,7
T a[242:243],v229,51200
D v247,s[24:27],1024
M v[92:95],a[220:223],a[16:19],v[92:95]
s_lshl_b32 s3,s3,12
T a[244:245],v230,49152
v_add_f32 v41,v41,v182
M v[96:99],v[20:23],a[16:19],0
s_add_u32 s91,s3,s46
T a[246:247],v230,51200
v_add_f32 v42,v42,v199
M v[96:99],v[24:27],a[20:23],v[96:99]
L_pg23:
s_cmp_eq_u32 s47,1
s_cbranch_scc1 L_bkB20_0
s_waitcnt lgkmcnt(8)
T a[248:249],v231,49152
v_add_f32 v43,v43,v183
M v[96:99],v[28:31],a[24:27],v[96:99]
s_add_u32 m0,s45,81920
buffer_load_dword v255,off,s[80:83],s91 offset:384 sc1
M v[96:99],v[32:35],a[28:31],v[96:99]
s_add_u32 s24,s78,276480
T a[250:251],v231,51200
v_lshlrev_b32 v198,16,v184
M v[80:83],v[32:35],a[12:15],0
T a[252:253],v232,49152
v_lshlrev_b32 v199,16,v185
M v[80:83],v[28:31],a[8:11],v[80:83]
T a[254:255],v232,51200
v_add_f32 v44,v44,v198
M v[80:83],v[24:27],a[4:7],v[80:83]
T a[216:217],v233,49152
D v247,s[24:27],2048
M v[80:83],v[20:23],a[0:3],v[80:83]
s_add_u32 m0,s45,81920
T a[218:219],v233,51200
v_and_b32 v184,s58,v184
M v[84:87],a[192:195],a[0:3],0
s_add_u32 s24,s78,283648
T a[220:221],v234,49152
v_add_f32 v46,v46,v199
M v[84:87],a[196:199],a[4:7],v[84:87]
T a[222:223],v234,51200
v_and_b32 v185,s58,v185
M v[84:87],a[200:203],a[8:11],v[84:87]
T a[224:225],v235,49152
D v247,s[24:27],3072
M v[84:87],a[204:207],a[12:15],v[84:87]
s_add_u32 m0,s45,98304
T a[226:227],v235,51200
v_lshlrev_b32 v198,16,v186
M v[100:103],a[204:207],a[28:31],0
s_add_u32 s24,s78,393216
T a[228:229],v236,49152
v_and_b32 v186,s58,v186
M v[100:103],a[200:203],a[24:27],v[100:103]
T a[230:231],v236,51200
v_lshlrev_b32 v199,16,v187
M v[100:103],a[196:199],a[20:23],v[100:103]
T a[232:233],v237,49152
v_and_b32 v187,s58,v187
M v[100:103],a[192:195],a[16:19],v[100:103]
T a[234:235],v237,51200
D v247,s[24:27],0
M v[72:75],a[208:211],a[48:51],v[72:75]
s_waitcnt lgkmcnt(8)
T v[20:21],v238,49152
v_add_f32 v45,v45,v184
M v[72:75],a[212:215],a[52:55],v[72:75]
s_add_u32 m0,s45,98304
T v[22:23],v238,51200
v_add_f32 v47,v47,v185
M v[72:75],a[236:239],a[56:59],v[72:75]
s_add_u32 s24,s78,400384
T v[24:25],v239,49152
v_add_f32 v48,v48,v198
M v[72:75],a[240:243],a[60:63],v[72:75]
T v[26:27],v239,51200
v_add_f32 v49,v49,v186
M v[88:91],a[240:243],a[76:79],v[88:91]
T v[28:29],v240,49152
v_add_f32 v50,v50,v199
M v[88:91],a[236:239],a[72:75],v[88:91]
T v[30:31],v240,51200
v_add_f32 v51,v51,v187
M v[88:91],a[212:215],a[68:71],v[88:91]
T v[32:33],v241,49152
v_lshlrev_b32 v198,16,v188
M v[88:91],a[208:211],a[64:67],v[88:91]
T v[34:35],v241,51200
v_lshlrev_b32 v199,16,v189
M v[104:107],a[208:211],a[80:83],v[104:107]
T a[192:193],v210,49152
v_add_f32 v52,v52,v198
M v[104:107],a[212:215],a[84:87],v[104:107]
T a[194:195],v210,51200
v_and_b32 v188,s58,v188
M v[104:107],a[236:239],a[88:91],v[104:107]
T a[196:197],v211,49152
v_add_f32 v54,v54,v199
M v[104:107],a[240:243],a[92:95],v[104:107]
T a[198:199],v211,51200
D v247,s[24:27],1024
M v[76:79],a[244:247],a[48:51],v[76:79]
s_add_u32 m0,s45,98304
T a[200:201],v212,49152
v_and_b32 v189,s58,v189
M v[76:79],a[248:251],a[52:55],v[76:79]
s_waitcnt vmcnt(12) lgkmcnt(5)
s_barrier
T a[202:203],v212,51200
v_lshlrev_b32 v198,16,v190
M v[76:79],a[252:255],a[56:59],v[76:79]
s_add_u32 s24,s78,407552
T a[204:205],v213,49152
v_and_b32 v190,s58,v190
M v[76:79],a[216:219],a[60:63],v[76:79]
T a[206:207],v213,51200
v_lshlrev_b32 v199,16,v191
M v[92:95],a[216:219],a[76:79],v[92:95]
T a[208:209],v214,49152
v_and_b32 v191,s58,v191
M v[92:95],a[252:255],a[72:75],v[92:95]
T a[210:211],v214,51200
v_add_f32 v53,v53,v188
M v[92:95],a[248:251],a[68:71],v[92:95]
T a[212:213],v215,49152
v_add_f32 v55,v55,v189
M v[92:95],a[244:247],a[64:67],v[92:95]
T a[214:215],v215,51200
D v247,s[24:27],2048
M v[96:99],a[220:223],a[64:67],v[96:99]
s_add_u32 m0,s45,98304
T a[236:237],v216,49152
v_add_f32 v56,v56,v198
M v[96:99],a[224:227],a[68:71],v[96:99]
s_add_u32 s24,s78,414720
T a[238:239],v216,51200
v_add_f32 v57,v57,v190
M v[96:99],a[228:231],a[72:75],v[96:99]
T a[240:241],v217,49152
v_add_f32 v58,v58,v199
M v[96:99],a[232:235],a[76:79],v[96:99]
T a[242:243],v217,51200
v_add_f32 v59,v59,v191
M v[80:83],a[232:235],a[60:63],v[80:83]
T a[244:245],v218,49152
v_lshlrev_b32 v198,16,v192
M v[80:83],a[228:231],a[56:59],v[80:83]
T a[246:247],v218,51200
v_lshlrev_b32 v199,16,v193
M v[80:83],a[224:227],a[52:55],v[80:83]
T a[248:249],v219,49152
v_add_f32 v60,v60,v198
M v[80:83],a[220:223],a[48:51],v[80:83]
T a[250:251],v219,51200
D v247,s[24:27],3072
M v[84:87],v[20:23],a[48:51],v[84:87]
s_add_u32 m0,s45,114688
T a[252:253],v220,49152
v_and_b32 v192,s58,v192
M v[84:87],v[24:27],a[52:55],v[84:87]
s_add_u32 s24,s79,0
T a[254:255],v220,51200
v_add_f32 v62,v62,v199
M v[84:87],v[28:31],a[56:59],v[84:87]
T a[216:217],v221,49152
v_and_b32 v193,s58,v193
M v[84:87],v[32:35],a[60:63],v[84:87]
T a[218:219],v221,51200
v_lshlrev_b32 v198,16,v194
M v[100:103],v[32:35],a[76:79],v[100:103]
T a[220:221],v222,49152
v_and_b32 v194,s58,v194
M v[100:103],v[28:31],a[72:75],v[100:103]
T a[222:223],v222,51200
v_lshlrev_b32 v199,16,v195
M v[100:103],v[24:27],a[68:71],v[100:103]
T a[224:225],v223,49152
v_and_b32 v195,s58,v195
M v[100:103],v[20:23],a[64:67],v[100:103]
s_waitcnt lgkmcnt(8)
T a[226:227],v223,51200
D v247,s[24:27],0
M v[72:75],a[192:195],a[96:99],v[72:75]
s_add_u32 m0,s45,114688
T a[228:229],v224,49152
v_lshlrev_b32 v162,16,v160
M v[72:75],a[196:199],a[100:103],v[72:75]
s_add_u32 s24,s79,7168
T a[230:231],v224,51200
v_lshlrev_b32 v163,16,v161
M v[72:75],a[200:203],a[104:107],v[72:75]
s_sub_u32 s3,s5,4
T a[232:233],v225,49152
v_add_f32 v68,v68,v162
M v[72:75],a[204:207],a[108:111],v[72:75]
s_and_b32 s3,s3,7
T a[234:235],v225,51200
v_add_f32 v70,v70,v163
M v[88:91],a[204:207],a[124:127],v[88:91]
s_mul_i32 s3,s3,18432
T v[20:21],v210,32768
v_lshlrev_b32 v162,16,v144
M v[88:91],a[200:203],a[120:123],v[88:91]
s_add_u32 s8,s3,s49
T v[22:23],v210,34816
v_and_b32 v144,s58,v144
M v[88:91],a[196:199],a[116:119],v[88:91]
T v[24:25],v211,32768
v_lshlrev_b32 v163,16,v145
M v[88:91],a[192:195],a[112:115],v[88:91]
T v[26:27],v211,34816
v_and_b32 v145,s58,v145
M v[104:107],a[192:195],a[128:131],v[104:107]
T v[28:29],v212,32768
v_add_f32 v36,v36,v162
M v[104:107],a[196:199],a[132:135],v[104:107]
T v[30:31],v212,34816
v_add_f32 v37,v37,v144
M v[104:107],a[200:203],a[136:139],v[104:107]
T v[32:33],v213,32768
v_add_f32 v38,v38,v163
M v[104:107],a[204:207],a[140:143],v[104:107]
T v[34:35],v213,34816
D v247,s[24:27],1024
M v[76:79],a[208:211],a[96:99],v[76:79]
s_add_u32 m0,s45,114688
T a[192:193],v214,32768
v_add_f32 v39,v39,v145
M v[76:79],a[212:215],a[100:103],v[76:79]
s_add_u32 s24,s79,14336
T a[194:195],v214,34816
v_add_f32 v61,v61,v192
M v[76:79],a[236:239],a[104:107],v[76:79]
T a[196:197],v215,32768
v_add_f32 v63,v63,v193
M v[76:79],a[240:243],a[108:111],v[76:79]
T a[198:199],v215,34816
v_add_f32 v65,v65,v194
M v[92:95],a[240:243],a[124:127],v[92:95]
T a[200:201],v216,32768
v_add_f32 v67,v67,v195
M v[92:95],a[236:239],a[120:123],v[92:95]
T a[202:203],v216,34816
v_lshlrev_b32 v162,16,v146
M v[92:95],a[212:215],a[116:119],v[92:95]
T a[204:205],v217,32768
v_lshlrev_b32 v163,16,v147
M v[92:95],a[208:211],a[112:115],v[92:95]
s_waitcnt vmcnt(11)
buffer_store_dword v206,v205,s[80:83],s101 offen offset:512 sc1
M v[96:99],a[244:247],a[112:115],v[96:99]
s_waitcnt vmcnt(9) lgkmcnt(7)
v_cmp_eq_u32 vcc,1,v255
s_cbranch_vccz L_sp3
L_rt3:
M v[96:99],a[248:251],a[116:119],v[96:99]
T a[206:207],v217,34816
v_add_f32 v40,v40,v162
M v[96:99],a[252:255],a[120:123],v[96:99]
T a[208:209],v218,32768
v_add_f32 v42,v42,v163
M v[96:99],a[216:219],a[124:127],v[96:99]
T a[210:211],v218,34816
buffer_load_dwordx2 v[16:17],v201,s[8:11],0 offen offset:0 sc1
M v[80:83],a[216:219],a[108:111],v[80:83]
T a[212:213],v219,32768
v_lshlrev_b32 v162,16,v148
M v[80:83],a[252:255],a[104:107],v[80:83]
T a[214:215],v219,34816
v_lshlrev_b32 v163,16,v149
M v[80:83],a[248:251],a[100:103],v[80:83]
T a[236:237],v220,32768
v_add_f32 v44,v44,v162
M v[80:83],a[244:247],a[96:99],v[80:83]
T a[238:239],v220,34816
D v247,s[24:27],2048
M v[84:87],a[220:223],a[96:99],v[84:87]
s_add_u32 m0,s45,114688
T a[240:241],v221,32768
v_add_f32 v46,v46,v163
M v[84:87],a[224:227],a[100:103],v[84:87]
s_add_u32 s24,s79,21504
T a[242:243],v221,34816
v_lshlrev_b32 v162,16,v150
M v[84:87],a[228:231],a[104:107],v[84:87]
T a[244:245],v222,32768
v_lshlrev_b32 v163,16,v151
M v[84:87],a[232:235],a[108:111],v[84:87]
T a[246:247],v222,34816
buffer_load_dwordx4 v[0:3],v200,s[8:11],0 offen offset:0 sc1
M v[100:103],a[232:235],a[124:127],v[100:103]
T a[248:249],v223,32768
v_add_f32 v48,v48,v162
M v[100:103],a[228:231],a[120:123],v[100:103]
T a[250:251],v223,34816
v_add_f32 v50,v50,v163
M v[100:103],a[224:227],a[116:119],v[100:103]
T a[252:253],v224,32768
v_lshlrev_b32 v162,16,v152
M v[100:103],a[220:223],a[112:115],v[100:103]
T a[254:255],v224,34816
D v247,s[24:27],3072
M v[72:75],v[20:23],a[144:147],v[72:75]
s_add_u32 m0,s45,131072
T a[216:217],v225,32768
v_and_b32 v152,s58,v152
M v[72:75],v[24:27],a[148:151],v[72:75]
s_add_u32 s24,s79,131072
T a[218:219],v225,34816
v_lshlrev_b32 v163,16,v153
M v[72:75],v[28:31],a[152:155],v[72:75]
T a[220:221],v210,0
v_and_b32 v153,s58,v153
M v[72:75],v[32:35],a[156:159],v[72:75]
T a[222:223],v210,2048
buffer_load_dwordx4 v[4:7],v200,s[8:11],0 offen offset:1024 sc1
M v[88:91],v[32:35],a[172:175],v[88:91]
T a[224:225],v211,0
v_add_f32 v52,v52,v162
M v[88:91],v[28:31],a[168:171],v[88:91]
T a[226:227],v211,2048
v_add_f32 v53,v53,v152
M v[88:91],v[24:27],a[164:167],v[88:91]
T a[228:229],v212,0
C v72,v72,v73
M v[88:91],v[20:23],a[160:163],v[88:91]
s_waitcnt vmcnt(8) lgkmcnt(5)
s_barrier
T a[230:231],v212,2048
D v247,s[24:27],0
M v[104:107],v[20:23],a[176:179],v[104:107]
s_add_u32 m0,s45,131072
T a[232:233],v213,0
C v73,v74,v75
M v[104:107],v[24:27],a[180:183],v[104:107]
s_add_u32 s24,s79,138240
T a[234:235],v213,2048
C v88,v88,v89
M v[104:107],v[28:31],a[184:187],v[104:107]
T v[20:21],v214,0
C v89,v90,v91
M v[104:107],v[32:35],a[188:191],v[104:107]
T v[22:23],v214,2048
buffer_load_dwordx4 v[8:11],v200,s[8:11],0 offen offset:2048 sc1
M v[76:79],a[192:195],a[144:147],v[76:79]
T v[24:25],v215,0
v_add_f32 v54,v54,v163
M v[76:79],a[196:199],a[148:151],v[76:79]
T v[26:27],v215,2048
v_add_f32 v55,v55,v153
M v[76:79],a[200:203],a[152:155],v[76:79]
T v[28:29],v216,0
C v104,v104,v105
M v[76:79],a[204:207],a[156:159],v[76:79]
D v247,s[24:27],1024
C v105,v106,v107
M v[92:95],a[204:207],a[172:175],v[92:95]
s_add_u32 m0,s45,131072
T v[30:31],v216,2048
v_and_b32 v160,s58,v160
M v[92:95],a[200:203],a[168:171],v[92:95]
s_add_u32 s24,s79,145408
T v[32:33],v217,0
v_and_b32 v161,s58,v161
M v[92:95],a[196:199],a[164:167],v[92:95]
C v74,v76,v77
C v75,v78,v79
M v[92:95],a[192:195],a[160:163],v[92:95]
T v[34:35],v217,2048
buffer_load_dwordx4 v[12:15],v200,s[8:11],0 offen offset:3072 sc1
M v[96:99],a[208:211],a[160:163],v[96:99]
T a[192:193],v218,0
v_add_f32 v69,v69,v160
M v[96:99],a[212:215],a[164:167],v[96:99]
T a[194:195],v218,2048
v_add_f32 v71,v71,v161
M v[96:99],a[236:239],a[168:171],v[96:99]
C v90,v92,v93
C v91,v94,v95
M v[96:99],a[240:243],a[172:175],v[96:99]
T a[196:197],v219,0
D v247,s[24:27],2048
M v[80:83],a[240:243],a[156:159],v[80:83]
s_add_u32 m0,s45,131072
T a[198:199],v219,2048
v_and_b32 v146,s58,v146
M v[80:83],a[236:239],a[152:155],v[80:83]
s_add_u32 s24,s79,152576
T a[200:201],v220,0
v_and_b32 v147,s58,v147
M v[80:83],a[212:215],a[148:151],v[80:83]
s_add_u32 s3,s5,6
T a[202:203],v220,2048
C v96,v96,v97
M v[80:83],a[208:211],a[144:147],v[80:83]
s_and_b32 s3,s3,7
D v247,s[24:27],3072
C v97,v98,v99
M v[84:87],a[244:247],a[144:147],v[84:87]
s_mul_i32 s3,s3,147456
T a[204:205],v221,0
v_add_f32 v41,v41,v146
M v[84:87],a[248:251],a[148:151],v[84:87]
s_add_u32 s28,s3,s48
T a[206:207],v221,2048
v_add_f32 v43,v43,v147
M v[84:87],a[252:255],a[152:155],v[84:87]
s_add_u32 m0,s45,49152
T a[208:209],v222,0
C v80,v80,v81
M v[84:87],a[216:219],a[156:159],v[84:87]
s_add_u32 s24,s79,262144
T a[210:211],v222,2048
C v81,v82,v83
M v[100:103],a[216:219],a[172:175],v[100:103]
T a[212:213],v223,0
v_lshlrev_b32 v162,16,v154
M v[100:103],a[252:255],a[168:171],v[100:103]
T a[214:215],v223,2048
v_and_b32 v154,s58,v154
M v[100:103],a[248:251],a[164:167],v[100:103]
C v82,v84,v85
C v83,v86,v87
M v[100:103],a[244:247],a[160:163],v[100:103]
s_waitcnt lgkmcnt(6)
buffer_store_dwordx4 v[72:75],v200,s[28:31],0 offen offset:0 sc1
M v[108:111],a[220:223],a[0:3],0
T a[236:237],v224,0
v_lshlrev_b32 v163,16,v155
M v[108:111],a[224:227],a[4:7],v[108:111]
T a[238:239],v224,2048
v_and_b32 v155,s58,v155
M v[108:111],a[228:231],a[8:11],v[108:111]
buffer_store_dwordx4 v[80:83],v200,s[28:31],0 offen offset:1024 sc1
M v[108:111],a[232:235],a[12:15],v[108:111]
C v98,v100,v101
C v99,v102,v103
M v[124:127],a[232:235],a[28:31],0
T a[240:241],v225,0
v_add_f32 v56,v56,v162
M v[124:127],a[228:231],a[24:27],v[124:127]
buffer_store_dwordx4 v[88:91],v200,s[28:31],0 offen offset:2048 sc1
M v[124:127],a[224:227],a[20:23],v[124:127]
T a[242:243],v225,2048
v_add_f32 v57,v57,v154
M v[124:127],a[220:223],a[16:19],v[124:127]
T a[244:245],v210,16384
v_add_f32 v58,v58,v163
M v[140:143],a[220:223],a[32:35],0
buffer_store_dwordx4 v[96:99],v200,s[28:31],0 offen offset:3072 sc1
M v[140:143],a[224:227],a[36:39],v[140:143]
T a[246:247],v210,18432
v_add_f32 v59,v59,v155
M v[140:143],a[228:231],a[40:43],v[140:143]
T a[248:249],v211,16384
v_lshlrev_b32 v162,16,v156
M v[140:143],a[232:235],a[44:47],v[140:143]
buffer_store_dwordx2 v[104:105],v201,s[28:31],0 offen offset:0 sc1
M v[112:115],v[20:23],a[0:3],0
T a[250:251],v211,18432
v_and_b32 v156,s58,v156
M v[112:115],v[24:27],a[4:7],v[112:115]
T a[252:253],v212,16384
v_lshlrev_b32 v163,16,v157
M v[112:115],v[28:31],a[8:11],v[112:115]
T a[254:255],v212,18432
D v247,s[24:27],0
M v[112:115],v[32:35],a[12:15],v[112:115]
s_add_u32 m0,s45,49152
T a[216:217],v213,16384
v_and_b32 v157,s58,v157
M v[128:131],v[32:35],a[28:31],0
s_add_u32 s24,s79,269312
T a[218:219],v213,18432
v_add_f32 v60,v60,v162
M v[128:131],v[28:31],a[24:27],v[128:131]
s_sub_u32 s3,s5,5
T a[220:221],v214,16384
v_add_f32 v61,v61,v156
M v[128:131],v[24:27],a[20:23],v[128:131]
s_and_b32 s3,s3,7
T a[222:223],v214,18432
D v247,s[24:27],1024
M v[128:131],v[20:23],a[16:19],v[128:131]
s_lshl_b32 s3,s3,12
T a[224:225],v215,16384
v_add_f32 v62,v62,v163
M v[132:135],a[192:195],a[16:19],0
s_add_u32 s90,s3,s46
T a[226:227],v215,18432
v_add_f32 v63,v63,v157
M v[132:135],a[196:199],a[20:23],v[132:135]
s_add_u32 m0,s45,49152
T a[228:229],v216,16384
v_and_b32 v148,s58,v148
M v[132:135],a[200:203],a[24:27],v[132:135]
s_waitcnt lgkmcnt(8)
buffer_load_dword v254,off,s[80:83],s90 offset:512 sc1
M v[132:135],a[204:207],a[28:31],v[132:135]
s_add_u32 s24,s79,276480
T a[230:231],v216,18432
v_and_b32 v149,s58,v149
M v[116:119],a[204:207],a[12:15],0
T a[232:233],v217,16384
v_add_f32 v45,v45,v148
M v[116:119],a[200:203],a[8:11],v[116:119]
T a[234:235],v217,18432
v_add_f32 v47,v47,v149
M v[116:119],a[196:199],a[4:7],v[116:119]
T v[20:21],v218,16384
D v247,s[24:27],2048
M v[116:119],a[192:195],a[0:3],v[116:119]
s_add_u32 m0,s45,49152
T v[22:23],v218,18432
v_and_b32 v150,s58,v150
M v[120:123],a[208:211],a[0:3],0
s_add_u32 s24,s79,283648
T v[24:25],v219,16384
v_and_b32 v151,s58,v151
M v[120:123],a[212:215],a[4:7],v[120:123]
T v[26:27],v219,18432
v_add_f32 v49,v49,v150
M v[120:123],a[236:239],a[8:11],v[120:123]
T v[28:29],v220,16384
D v247,s[24:27],3072
M v[120:123],a[240:243],a[12:15],v[120:123]
s_add_u32 m0,s45,32768
T v[30:31],v220,18432
v_add_f32 v51,v51,v151
M v[136:139],a[240:243],a[28:31],0
s_add_u32 s24,s79,393216
T v[32:33],v221,16384
v_add_f32 v64,v64,v198
M v[136:139],a[236:239],a[24:27],v[136:139]
T v[34:35],v221,18432
v_add_f32 v66,v66,v199
M v[136:139],a[212:215],a[20:23],v[136:139]
T a[192:193],v222,16384
v_lshlrev_b32 v162,16,v158
M v[136:139],a[208:211],a[16:19],v[136:139]
T a[194:195],v222,18432
D v247,s[24:27],0
M v[108:111],a[244:247],a[48:51],v[108:111]
s_add_u32 m0,s45,32768
T a[196:197],v223,16384
v_and_b32 v158,s58,v158
M v[108:111],a[248:251],a[52:55],v[108:111]
s_waitcnt lgkmcnt(8)
T a[198:199],v223,18432
v_lshlrev_b32 v163,16,v159
M v[108:111],a[252:255],a[56:59],v[108:111]
s_add_u32 s24,s79,400384
T a[200:201],v224,16384
v_and_b32 v159,s58,v159
M v[108:111],a[216:219],a[60:63],v[108:111]
T a[202:203],v224,18432
v_add_f32 v64,v64,v162
M v[124:127],a[216:219],a[76:79],v[124:127]
T a[204:205],v225,16384
v_add_f32 v65,v65,v158
M v[124:127],a[252:255],a[72:75],v[124:127]
T a[206:207],v225,18432
v_add_f32 v66,v66,v163
M v[124:127],a[248:251],a[68:71],v[124:127]
T a[208:209],v226,0
v_add_f32 v67,v67,v159
M v[124:127],a[244:247],a[64:67],v[124:127]
T a[210:211],v226,2048
M v[140:143],a[244:247],a[80:83],v[140:143]
T a[212:213],v227,0
M v[140:143],a[248:251],a[84:87],v[140:143]
T a[214:215],v227,2048
M v[140:143],a[252:255],a[88:91],v[140:143]
T a[236:237],v228,0
M v[140:143],a[216:219],a[92:95],v[140:143]
s_waitcnt vmcnt(11) lgkmcnt(5)
s_barrier
T a[238:239],v228,2048
D v247,s[24:27],1024
M v[112:115],a[220:223],a[48:51],v[112:115]
s_add_u32 m0,s45,32768
T a[240:241],v229,0
M v[112:115],a[224:227],a[52:55],v[112:115]
s_add_u32 s24,s79,407552
T a[242:243],v229,2048
M v[112:115],a[228:231],a[56:59],v[112:115]
T a[244:245],v230,0
M v[112:115],a[232:235],a[60:63],v[112:115]
T a[246:247],v230,2048
M v[128:131],a[232:235],a[76:79],v[128:131]
T a[248:249],v231,0
M v[128:131],a[228:231],a[72:75],v[128:131]
T a[250:251],v231,2048
M v[128:131],a[224:227],a[68:71],v[128:131]
T a[252:253],v232,0
M v[128:131],a[220:223],a[64:67],v[128:131]
L_pg24:
s_cmp_eq_u32 s47,1
s_cbranch_scc1 L_bkB27_0
T a[254:255],v232,2048
D v247,s[24:27],2048
M v[132:135],v[20:23],a[64:67],v[132:135]
s_add_u32 m0,s45,32768
T a[216:217],v233,0
M v[132:135],v[24:27],a[68:71],v[132:135]
s_add_u32 s24,s79,414720
T a[218:219],v233,2048
M v[132:135],v[28:31],a[72:75],v[132:135]
s_sub_u32 s3,s5,5
T a[220:221],v234,0
M v[132:135],v[32:35],a[76:79],v[132:135]
s_and_b32 s3,s3,7
T a[222:223],v234,2048
M v[116:119],v[32:35],a[60:63],v[116:119]
s_mul_i32 s3,s3,18432
T a[224:225],v235,0
M v[116:119],v[28:31],a[56:59],v[116:119]
s_add_u32 s8,s3,s49
T a[226:227],v235,2048
M v[116:119],v[24:27],a[52:55],v[116:119]
s_sub_u32 s3,s5,6
T a[228:229],v236,0
M v[116:119],v[20:23],a[48:51],v[116:119]
s_and_b32 s3,s3,7
T a[230:231],v236,2048
D v247,s[24:27],3072
M v[120:123],a[192:195],a[48:51],v[120:123]
s_lshl_b32 s3,s3,12
T a[232:233],v237,0
M v[120:123],a[196:199],a[52:55],v[120:123]
s_add_u32 s91,s3,s46
T a[234:235],v237,2048
M v[120:123],a[200:203],a[56:59],v[120:123]
s_add_u32 s3,s5,7
T v[20:21],v238,0
M v[120:123],a[204:207],a[60:63],v[120:123]
s_and_b32 s3,s3,7
T v[22:23],v238,2048
M v[136:139],a[204:207],a[76:79],v[136:139]
s_mul_i32 s3,s3,147456
T v[24:25],v239,0
M v[136:139],a[200:203],a[72:75],v[136:139]
s_add_u32 s28,s3,s48
T v[26:27],v239,2048
M v[136:139],a[196:199],a[68:71],v[136:139]
s_sub_u32 s3,s5,6
T v[28:29],v240,0
M v[136:139],a[192:195],a[64:67],v[136:139]
s_waitcnt lgkmcnt(8)
T v[30:31],v240,2048
v_lshlrev_b32 v18,16,v16
M v[108:111],a[208:211],a[96:99],v[108:111]
s_and_b32 s3,s3,7
T v[32:33],v241,0
v_lshlrev_b32 v19,16,v17
M v[108:111],a[212:215],a[100:103],v[108:111]
s_mul_i32 s3,s3,18432
T v[34:35],v241,2048
v_add_f32 v68,v68,v18
M v[108:111],a[236:239],a[104:107],v[108:111]
T a[192:193],v226,16384
v_add_f32 v70,v70,v19
M v[108:111],a[240:243],a[108:111],v[108:111]
T a[194:195],v226,18432
v_lshlrev_b32 v18,16,v0
M v[124:127],a[240:243],a[124:127],v[124:127]
T a[196:197],v227,16384
v_and_b32 v0,s58,v0
M v[124:127],a[236:239],a[120:123],v[124:127]
T a[198:199],v227,18432
v_lshlrev_b32 v19,16,v1
M v[124:127],a[212:215],a[116:119],v[124:127]
T a[200:201],v228,16384
v_and_b32 v1,s58,v1
M v[124:127],a[208:211],a[112:115],v[124:127]
T a[202:203],v228,18432
v_add_f32 v36,v36,v18
M v[140:143],a[208:211],a[128:131],v[140:143]
T a[204:205],v229,16384
v_add_f32 v37,v37,v0
M v[140:143],a[212:215],a[132:135],v[140:143]
T a[206:207],v229,18432
v_add_f32 v38,v38,v19
M v[140:143],a[236:239],a[136:139],v[140:143]
T a[208:209],v230,16384
v_add_f32 v39,v39,v1
M v[140:143],a[240:243],a[140:143],v[140:143]
T a[210:211],v230,18432
v_lshlrev_b32 v18,16,v2
M v[112:115],a[244:247],a[96:99],v[112:115]
T a[212:213],v231,16384
v_lshlrev_b32 v19,16,v3
M v[112:115],a[248:251],a[100:103],v[112:115]
T a[214:215],v231,18432
v_add_f32 v40,v40,v18
M v[112:115],a[252:255],a[104:107],v[112:115]
T a[236:237],v232,16384
v_add_f32 v42,v42,v19
M v[112:115],a[216:219],a[108:111],v[112:115]
T a[238:239],v232,18432
v_lshlrev_b32 v18,16,v4
M v[128:131],a[216:219],a[124:127],v[128:131]
T a[240:241],v233,16384
v_lshlrev_b32 v19,16,v5
M v[128:131],a[252:255],a[120:123],v[128:131]
T a[242:243],v233,18432
v_add_f32 v44,v44,v18
M v[128:131],a[248:251],a[116:119],v[128:131]
T a[248:249],v235,16384
v_add_f32 v46,v46,v19
M v[128:131],a[244:247],a[112:115],v[128:131]
s_waitcnt vmcnt(9)
buffer_store_dword v206,v205,s[80:83],s101 offen offset:640 sc1
M v[132:135],a[220:223],a[112:115],v[132:135]
s_waitcnt vmcnt(7)
v_cmp_eq_u32 vcc,1,v254
s_cbranch_vccz L_sp4
L_rt4:
M v[132:135],a[224:227],a[116:119],v[132:135]
s_waitcnt lgkmcnt(6)
T a[244:245],v234,16384
buffer_load_dwordx2 v[196:197],v201,s[8:11],0 offen offset:0 sc1
M v[132:135],a[228:231],a[120:123],v[132:135]
T a[246:247],v234,18432
v_lshlrev_b32 v18,16,v6
M v[132:135],a[232:235],a[124:127],v[132:135]
T a[250:251],v235,18432
v_lshlrev_b32 v19,16,v7
M v[116:119],a[232:235],a[108:111],v[116:119]
T a[252:253],v236,16384
buffer_load_dwordx4 v[180:183],v200,s[8:11],0 offen offset:0 sc1
M v[116:119],a[228:231],a[104:107],v[116:119]
T a[254:255],v236,18432
v_add_f32 v48,v48,v18
M v[116:119],a[224:227],a[100:103],v[116:119]
T a[216:217],v237,16384
v_add_f32 v50,v50,v19
M v[116:119],a[220:223],a[96:99],v[116:119]
T a[218:219],v237,18432
buffer_load_dwordx4 v[184:187],v200,s[8:11],0 offen offset:1024 sc1
M v[120:123],v[20:23],a[96:99],v[120:123]
T a[220:221],v238,16384
v_lshlrev_b32 v18,16,v8
M v[120:123],v[24:27],a[100:103],v[120:123]
T a[222:223],v238,18432
v_and_b32 v8,s58,v8
M v[120:123],v[28:31],a[104:107],v[120:123]
T a[224:225],v239,16384
buffer_load_dwordx4 v[188:191],v200,s[8:11],0 offen offset:2048 sc1
M v[120:123],v[32:35],a[108:111],v[120:123]
T a[226:227],v239,18432
v_lshlrev_b32 v19,16,v9
M v[136:139],v[32:35],a[124:127],v[136:139]
T a[228:229],v240,16384
v_and_b32 v9,s58,v9
M v[136:139],v[28:31],a[120:123],v[136:139]
T a[230:231],v240,18432
buffer_load_dwordx4 v[192:195],v200,s[8:11],0 offen offset:3072 sc1
M v[136:139],v[24:27],a[116:119],v[136:139]
s_add_u32 s8,s3,s49
T a[232:233],v241,16384
v_add_f32 v52,v52,v18
M v[136:139],v[20:23],a[112:115],v[136:139]
s_sub_u32 s3,s5,7
T a[234:235],v241,18432
v_add_f32 v53,v53,v8
M v[108:111],a[192:195],a[144:147],v[108:111]
s_and_b32 s3,s3,7
T v[20:21],v226,32768
v_add_f32 v54,v54,v19
M v[108:111],a[196:199],a[148:151],v[108:111]
s_lshl_b32 s3,s3,12
T v[22:23],v226,34816
v_add_f32 v55,v55,v9
M v[108:111],a[200:203],a[152:155],v[108:111]
s_add_u32 s90,s3,s46
T v[24:25],v227,32768
v_and_b32 v16,s58,v16
M v[108:111],a[204:207],a[156:159],v[108:111]
s_sub_u32 s3,s5,7
T v[26:27],v227,34816
v_and_b32 v17,s58,v17
M v[124:127],a[204:207],a[172:175],v[124:127]
s_and_b32 s3,s3,7
T v[28:29],v228,32768
v_add_f32 v69,v69,v16
M v[124:127],a[200:203],a[168:171],v[124:127]
s_waitcnt vmcnt(6) lgkmcnt(5)
s_barrier
T v[30:31],v228,34816
C v108,v108,v109
M v[124:127],a[196:199],a[164:167],v[124:127]
s_mul_i32 s3,s3,18432
T v[32:33],v229,32768
C v109,v110,v111
M v[124:127],a[192:195],a[160:163],v[124:127]
T v[34:35],v229,34816
v_add_f32 v71,v71,v17
M v[140:143],a[192:195],a[176:179],v[140:143]
T a[192:193],v230,32768
v_and_b32 v2,s58,v2
M v[140:143],a[196:199],a[180:183],v[140:143]
T a[194:195],v230,34816
v_and_b32 v3,s58,v3
M v[140:143],a[200:203],a[184:187],v[140:143]
T a[196:197],v231,32768
C v124,v124,v125
M v[140:143],a[204:207],a[188:191],v[140:143]
T a[198:199],v231,34816
C v125,v126,v127
M v[112:115],a[208:211],a[144:147],v[112:115]
T a[200:201],v232,32768
v_add_f32 v41,v41,v2
M v[112:115],a[212:215],a[148:151],v[112:115]
T a[202:203],v232,34816
v_add_f32 v43,v43,v3
M v[112:115],a[236:239],a[152:155],v[112:115]
T a[204:205],v233,32768
C v140,v140,v141
M v[112:115],a[240:243],a[156:159],v[112:115]
T a[206:207],v233,34816
C v141,v142,v143
M v[128:131],a[240:243],a[172:175],v[128:131]
T a[240:241],v237,32768
v_lshlrev_b32 v18,16,v10
M v[128:131],a[236:239],a[168:171],v[128:131]
T a[236:237],v236,32768
v_and_b32 v10,s58,v10
M v[128:131],a[212:215],a[164:167],v[128:131]
C v110,v112,v113
C v111,v114,v115
M v[128:131],a[208:211],a[160:163],v[128:131]
buffer_load_dword v255,off,s[80:83],s91 offset:640 sc1
M v[132:135],a[244:247],a[160:163],v[132:135]
T a[208:209],v234,32768
v_lshlrev_b32 v19,16,v11
M v[132:135],a[248:251],a[164:167],v[132:135]
T a[210:211],v234,34816
v_and_b32 v11,s58,v11
M v[132:135],a[252:255],a[168:171],v[132:135]
C v126,v128,v129
C v127,v130,v131
M v[132:135],a[216:219],a[172:175],v[132:135]
T a[212:213],v235,32768
v_add_f32 v56,v56,v18
M v[116:119],a[216:219],a[156:159],v[116:119]
T a[214:215],v235,34816
v_add_f32 v57,v57,v10
M v[116:119],a[252:255],a[152:155],v[116:119]
T a[238:239],v236,34816
v_add_f32 v58,v58,v19
M v[116:119],a[248:251],a[148:151],v[116:119]
T a[242:243],v237,34816
C v132,v132,v133
M v[116:119],a[244:247],a[144:147],v[116:119]
C v133,v134,v135
v_add_f32 v59,v59,v11
M v[120:123],a[220:223],a[144:147],v[120:123]
T a[244:245],v238,32768
v_lshlrev_b32 v18,16,v12
M v[120:123],a[224:227],a[148:151],v[120:123]
T a[246:247],v238,34816
v_and_b32 v12,s58,v12
M v[120:123],a[228:231],a[152:155],v[120:123]
T a[248:249],v239,32768
C v116,v116,v117
M v[120:123],a[232:235],a[156:159],v[120:123]
C v117,v118,v119
v_lshlrev_b32 v19,16,v13
M v[136:139],a[232:235],a[172:175],v[136:139]
T a[250:251],v239,34816
v_and_b32 v13,s58,v13
M v[136:139],a[228:231],a[168:171],v[136:139]
v_add_f32 v60,v60,v18
v_add_f32 v61,v61,v12
M v[136:139],a[224:227],a[164:167],v[136:139]
C v118,v120,v121
C v119,v122,v123
M v[136:139],a[220:223],a[160:163],v[136:139]
s_waitcnt lgkmcnt(4)
buffer_store_dwordx4 v[108:111],v200,s[28:31],0 offen offset:0 sc1
M v[36:39],v[20:23],a[0:3],v[36:39]
v_add_f32 v62,v62,v19
v_add_f32 v63,v63,v13
M v[36:39],v[24:27],a[4:7],v[36:39]
buffer_store_dwordx4 v[116:119],v200,s[28:31],0 offen offset:1024 sc1
M v[36:39],v[28:31],a[8:11],v[36:39]
C v134,v136,v137
C v135,v138,v139
M v[36:39],v[32:35],a[12:15],v[36:39]
buffer_store_dwordx4 v[124:127],v200,s[28:31],0 offen offset:2048 sc1
M v[52:55],v[32:35],a[28:31],v[52:55]
T a[252:253],v240,32768
v_and_b32 v4,s58,v4
M v[52:55],v[28:31],a[24:27],v[52:55]
buffer_store_dwordx4 v[132:135],v200,s[28:31],0 offen offset:3072 sc1
M v[52:55],v[24:27],a[20:23],v[52:55]
T a[254:255],v240,34816
v_and_b32 v5,s58,v5
M v[52:55],v[20:23],a[16:19],v[52:55]
buffer_store_dwordx2 v[140:141],v201,s[28:31],0 offen offset:0 sc1
M v[68:71],v[20:23],a[32:35],v[68:71]
T a[216:217],v241,32768
v_add_f32 v45,v45,v4
M v[68:71],v[24:27],a[36:39],v[68:71]
T a[218:219],v241,34816
v_add_f32 v47,v47,v5
M v[68:71],v[28:31],a[40:43],v[68:71]
T a[220:221],v226,49152
v_and_b32 v6,s58,v6
M v[68:71],v[32:35],a[44:47],v[68:71]
T a[222:223],v226,51200
v_and_b32 v7,s58,v7
M v[40:43],a[192:195],a[0:3],v[40:43]
T a[224:225],v227,49152
v_add_f32 v49,v49,v6
M v[40:43],a[196:199],a[4:7],v[40:43]
T a[226:227],v227,51200
v_add_f32 v51,v51,v7
M v[40:43],a[200:203],a[8:11],v[40:43]
T a[228:229],v228,49152
v_lshlrev_b32 v18,16,v14
M v[40:43],a[204:207],a[12:15],v[40:43]
T a[230:231],v228,51200
v_and_b32 v14,s58,v14
M v[56:59],a[204:207],a[28:31],v[56:59]
T a[232:233],v229,49152
v_lshlrev_b32 v19,16,v15
M v[56:59],a[200:203],a[24:27],v[56:59]
T a[234:235],v229,51200
v_and_b32 v15,s58,v15
M v[56:59],a[196:199],a[20:23],v[56:59]
v_add_f32 v64,v64,v18
v_add_f32 v65,v65,v14
M v[56:59],a[192:195],a[16:19],v[56:59]
v_add_f32 v66,v66,v19
v_add_f32 v67,v67,v15
M v[60:63],a[208:211],a[16:19],v[60:63]
T v[20:21],v230,49152
M v[60:63],a[212:215],a[20:23],v[60:63]
T v[22:23],v230,51200
M v[60:63],a[236:239],a[24:27],v[60:63]
T v[24:25],v231,49152
M v[60:63],a[240:243],a[28:31],v[60:63]
T v[26:27],v231,51200
M v[44:47],a[240:243],a[12:15],v[44:47]
T v[28:29],v232,49152
M v[44:47],a[236:239],a[8:11],v[44:47]
T v[30:31],v232,51200
M v[44:47],a[212:215],a[4:7],v[44:47]
T v[32:33],v233,49152
M v[44:47],a[208:211],a[0:3],v[44:47]
s_waitcnt vmcnt(5) lgkmcnt(7)
v_cmp_eq_u32 vcc,1,v255
s_cbranch_vccz L_sp5
L_rt5:
M v[48:51],a[244:247],a[0:3],v[48:51]
T v[34:35],v233,51200
buffer_load_dwordx2 v[160:161],v201,s[8:11],0 offen offset:0 sc1
M v[48:51],a[248:251],a[4:7],v[48:51]
T a[192:193],v234,49152
M v[48:51],a[252:255],a[8:11],v[48:51]
T a[194:195],v234,51200
M v[48:51],a[216:219],a[12:15],v[48:51]
T a[196:197],v235,49152
buffer_load_dwordx4 v[144:147],v200,s[8:11],0 offen offset:0 sc1
M v[64:67],a[216:219],a[28:31],v[64:67]
T a[198:199],v235,51200
M v[64:67],a[252:255],a[24:27],v[64:67]
T a[200:201],v236,49152
M v[64:67],a[248:251],a[20:23],v[64:67]
T a[202:203],v236,51200
buffer_load_dwordx4 v[148:151],v200,s[8:11],0 offen offset:1024 sc1
M v[64:67],a[244:247],a[16:19],v[64:67]
T a[204:205],v237,49152
v_lshlrev_b32 v104,16,v196
M v[36:39],a[220:223],a[48:51],v[36:39]
T a[206:207],v237,51200
v_lshlrev_b32 v106,16,v197
M v[36:39],a[224:227],a[52:55],v[36:39]
T a[208:209],v238,49152
buffer_load_dwordx4 v[152:155],v200,s[8:11],0 offen offset:2048 sc1
M v[36:39],a[228:231],a[56:59],v[36:39]
T a[210:211],v238,51200
v_lshlrev_b32 v72,16,v180
M v[36:39],a[232:235],a[60:63],v[36:39]
T a[212:213],v239,49152
v_and_b32 v73,0xffff0000,v180
M v[52:55],a[232:235],a[76:79],v[52:55]
T a[214:215],v239,51200
buffer_load_dwordx4 v[156:159],v200,s[8:11],0 offen offset:3072 sc1
M v[52:55],a[228:231],a[72:75],v[52:55]
s_add_u32 s8,s3,s49
T a[236:237],v240,49152
v_lshlrev_b32 v74,16,v181
M v[52:55],a[224:227],a[68:71],v[52:55]
T a[238:239],v240,51200
v_and_b32 v75,0xffff0000,v181
M v[52:55],a[220:223],a[64:67],v[52:55]
T a[240:241],v241,49152
v_lshlrev_b32 v76,16,v182
M v[68:71],a[220:223],a[80:83],v[68:71]
T a[242:243],v241,51200
v_and_b32 v77,0xffff0000,v182
M v[68:71],a[224:227],a[84:87],v[68:71]
T a[244:245],v210,49152
v_lshlrev_b32 v78,16,v183
M v[68:71],a[228:231],a[88:91],v[68:71]
T a[246:247],v210,51200
v_and_b32 v79,0xffff0000,v183
M v[68:71],a[232:235],a[92:95],v[68:71]
s_waitcnt vmcnt(5) lgkmcnt(8)
buffer_store_dword v206,v205,s[80:83],s101 offen offset:768 sc1
M v[40:43],v[20:23],a[48:51],v[40:43]
T a[248:249],v211,49152
v_lshlrev_b32 v80,16,v184
M v[40:43],v[24:27],a[52:55],v[40:43]
T a[250:251],v211,51200
v_and_b32 v81,0xffff0000,v184
M v[40:43],v[28:31],a[56:59],v[40:43]
T a[252:253],v212,49152
v_lshlrev_b32 v82,16,v185
M v[40:43],v[32:35],a[60:63],v[40:43]
T a[254:255],v212,51200
v_and_b32 v83,0xffff0000,v185
M v[56:59],v[32:35],a[76:79],v[56:59]
T a[216:217],v213,49152
v_lshlrev_b32 v84,16,v186
M v[56:59],v[28:31],a[72:75],v[56:59]
T a[218:219],v213,51200
v_and_b32 v85,0xffff0000,v186
M v[56:59],v[24:27],a[68:71],v[56:59]
T a[220:221],v214,49152
v_lshlrev_b32 v86,16,v187
M v[56:59],v[20:23],a[64:67],v[56:59]
T a[222:223],v214,51200
v_and_b32 v87,0xffff0000,v187
M v[60:63],a[192:195],a[64:67],v[60:63]
T a[224:225],v215,49152
v_and_b32 v105,0xffff0000,v196
M v[60:63],a[196:199],a[68:71],v[60:63]
T a[226:227],v215,51200
v_and_b32 v107,0xffff0000,v197
M v[60:63],a[200:203],a[72:75],v[60:63]
T a[228:229],v216,49152
v_lshlrev_b32 v88,16,v188
M v[60:63],a[204:207],a[76:79],v[60:63]
T a[230:231],v216,51200
v_and_b32 v89,0xffff0000,v188
M v[44:47],a[204:207],a[60:63],v[44:47]
T a[232:233],v217,49152
v_lshlrev_b32 v90,16,v189
M v[44:47],a[200:203],a[56:59],v[44:47]
T a[234:235],v217,51200
v_and_b32 v91,0xffff0000,v189
M v[44:47],a[196:199],a[52:55],v[44:47]
T v[20:21],v218,49152
v_lshlrev_b32 v92,16,v190
M v[44:47],a[192:195],a[48:51],v[44:47]
T v[22:23],v218,51200
v_and_b32 v93,0xffff0000,v190
M v[48:51],a[208:211],a[48:51],v[48:51]
s_waitcnt lgkmcnt(8)
T v[24:25],v219,49152
v_lshlrev_b32 v94,16,v191
M v[48:51],a[212:215],a[52:55],v[48:51]
T v[26:27],v219,51200
v_and_b32 v95,0xffff0000,v191
M v[48:51],a[236:239],a[56:59],v[48:51]
T v[28:29],v220,49152
v_lshlrev_b32 v96,16,v192
M v[48:51],a[240:243],a[60:63],v[48:51]
T v[30:31],v220,51200
v_and_b32 v97,0xffff0000,v192
M v[64:67],a[240:243],a[76:79],v[64:67]
T v[32:33],v221,49152
v_lshlrev_b32 v98,16,v193
M v[64:67],a[236:239],a[72:75],v[64:67]
T v[34:35],v221,51200
v_and_b32 v99,0xffff0000,v193
M v[64:67],a[212:215],a[68:71],v[64:67]
T a[192:193],v222,49152
v_lshlrev_b32 v100,16,v194
M v[64:67],a[208:211],a[64:67],v[64:67]
T a[194:195],v222,51200
v_and_b32 v101,0xffff0000,v194
M v[36:39],a[244:247],a[96:99],v[36:39]
T a[196:197],v223,49152
v_lshlrev_b32 v102,16,v195
M v[36:39],a[248:251],a[100:103],v[36:39]
T a[198:199],v223,51200
v_and_b32 v103,0xffff0000,v195
M v[36:39],a[252:255],a[104:107],v[36:39]
T a[200:201],v224,49152
M v[36:39],a[216:219],a[108:111],v[36:39]
T a[202:203],v224,51200
M v[52:55],a[216:219],a[124:127],v[52:55]
T a[204:205],v225,49152
M v[52:55],a[252:255],a[120:123],v[52:55]
T a[206:207],v225,51200
M v[52:55],a[248:251],a[116:119],v[52:55]
T a[208:209],v210,32768
M v[52:55],a[244:247],a[112:115],v[52:55]
T a[210:211],v210,34816
M v[68:71],a[244:247],a[128:131],v[68:71]
T a[212:213],v211,32768
M v[68:71],a[248:251],a[132:135],v[68:71]
T a[214:215],v211,34816
M v[68:71],a[252:255],a[136:139],v[68:71]
T a[236:237],v212,32768
M v[68:71],a[216:219],a[140:143],v[68:71]
buffer_load_dword v254,off,s[80:83],s90 offset:768 sc1
M v[40:43],a[220:223],a[96:99],v[40:43]
s_waitcnt lgkmcnt(7)
T a[238:239],v212,34816
M v[40:43],a[224:227],a[100:103],v[40:43]
T a[240:241],v213,32768
M v[40:43],a[228:231],a[104:107],v[40:43]
T a[242:243],v213,34816
M v[40:43],a[232:235],a[108:111],v[40:43]
T a[244:245],v214,32768
M v[56:59],a[232:235],a[124:127],v[56:59]
T a[246:247],v214,34816
M v[56:59],a[228:231],a[120:123],v[56:59]
T a[248:249],v215,32768
M v[56:59],a[224:227],a[116:119],v[56:59]
T a[250:251],v215,34816
M v[56:59],a[220:223],a[112:115],v[56:59]
s_waitcnt vmcnt(6)
T a[252:253],v216,32768
v_lshlrev_b32 v162,16,v160
M v[60:63],v[20:23],a[112:115],v[60:63]
T a[254:255],v216,34816
v_lshlrev_b32 v163,16,v161
M v[60:63],v[24:27],a[116:119],v[60:63]
T a[216:217],v217,32768
v_add_f32 v104,v104,v162
M v[60:63],v[28:31],a[120:123],v[60:63]
T a[218:219],v217,34816
v_add_f32 v106,v106,v163
M v[60:63],v[32:35],a[124:127],v[60:63]
s_waitcnt vmcnt(5)
T a[220:221],v218,32768
v_lshlrev_b32 v162,16,v144
M v[44:47],v[32:35],a[108:111],v[44:47]
T a[222:223],v218,34816
v_and_b32 v144,s58,v144
M v[44:47],v[28:31],a[104:107],v[44:47]
T a[224:225],v219,32768
v_lshlrev_b32 v163,16,v145
M v[44:47],v[24:27],a[100:103],v[44:47]
T a[226:227],v219,34816
v_and_b32 v145,s58,v145
M v[44:47],v[20:23],a[96:99],v[44:47]
T a[228:229],v220,32768
v_add_f32 v72,v72,v162
M v[48:51],a[192:195],a[96:99],v[48:51]
T a[230:231],v220,34816
v_add_f32 v73,v73,v144
M v[48:51],a[196:199],a[100:103],v[48:51]
T a[232:233],v221,32768
v_add_f32 v74,v74,v163
M v[48:51],a[200:203],a[104:107],v[48:51]
s_waitcnt lgkmcnt(8)
T a[234:235],v221,34816
v_add_f32 v75,v75,v145
M v[48:51],a[204:207],a[108:111],v[48:51]
T v[20:21],v222,32768
v_lshlrev_b32 v162,16,v146
M v[64:67],a[204:207],a[124:127],v[64:67]
T v[22:23],v222,34816
v_and_b32 v146,s58,v146
M v[64:67],a[200:203],a[120:123],v[64:67]
T v[24:25],v223,32768
v_lshlrev_b32 v163,16,v147
M v[64:67],a[196:199],a[116:119],v[64:67]
T v[26:27],v223,34816
v_and_b32 v147,s58,v147
M v[64:67],a[192:195],a[112:115],v[64:67]
T v[28:29],v224,32768
v_add_f32 v76,v76,v162
M v[36:39],a[208:211],a[144:147],v[36:39]
T v[30:31],v224,34816
v_add_f32 v77,v77,v146
M v[36:39],a[212:215],a[148:151],v[36:39]
L_pg25:
s_cmp_eq_u32 s47,1
s_cbranch_scc1 L_bkB27_0
T v[32:33],v225,32768
v_add_f32 v78,v78,v163
M v[36:39],a[236:239],a[152:155],v[36:39]
T v[34:35],v225,34816
v_add_f32 v79,v79,v147
M v[36:39],a[240:243],a[156:159],v[36:39]
s_waitcnt vmcnt(4)
v_lshlrev_b32 v162,16,v148
v_lshlrev_b32 v163,16,v149
M v[52:55],a[240:243],a[172:175],v[52:55]
v_and_b32 v148,s58,v148
v_and_b32 v149,s58,v149
M v[52:55],a[236:239],a[168:171],v[52:55]
v_add_f32 v80,v80,v162
v_add_f32 v81,v81,v148
M v[52:55],a[212:215],a[164:167],v[52:55]
v_add_f32 v82,v82,v163
v_add_f32 v83,v83,v149
M v[52:55],a[208:211],a[160:163],v[52:55]
v_lshlrev_b32 v162,16,v150
v_lshlrev_b32 v163,16,v151
M v[68:71],a[208:211],a[176:179],v[68:71]
v_and_b32 v150,s58,v150
v_and_b32 v151,s58,v151
M v[68:71],a[212:215],a[180:183],v[68:71]
v_add_f32 v84,v84,v162
v_add_f32 v85,v85,v150
M v[68:71],a[236:239],a[184:187],v[68:71]
v_add_f32 v86,v86,v163
v_add_f32 v87,v87,v151
M v[68:71],a[240:243],a[188:191],v[68:71]
s_waitcnt vmcnt(0)
v_cmp_eq_u32 vcc,1,v254
s_cbranch_vccz L_sp6
L_rt6:
M v[40:43],a[244:247],a[144:147],v[40:43]
buffer_load_dwordx2 v[16:17],v201,s[8:11],0 offen offset:0 sc1
v_and_b32 v160,s58,v160
M v[40:43],a[248:251],a[148:151],v[40:43]
v_and_b32 v161,s58,v161
v_add_f32 v105,v105,v160
M v[40:43],a[252:255],a[152:155],v[40:43]
s_waitcnt lgkmcnt(0)
buffer_load_dwordx4 v[0:3],v200,s[8:11],0 offen offset:0 sc1
v_add_f32 v107,v107,v161
M v[40:43],a[216:219],a[156:159],v[40:43]
v_lshlrev_b32 v162,16,v152
v_lshlrev_b32 v163,16,v153
M v[56:59],a[216:219],a[172:175],v[56:59]
buffer_load_dwordx4 v[4:7],v200,s[8:11],0 offen offset:1024 sc1
v_and_b32 v152,s58,v152
M v[56:59],a[252:255],a[168:171],v[56:59]
v_and_b32 v153,s58,v153
v_add_f32 v88,v88,v162
M v[56:59],a[248:251],a[164:167],v[56:59]
buffer_load_dwordx4 v[8:11],v200,s[8:11],0 offen offset:2048 sc1
v_add_f32 v89,v89,v152
M v[56:59],a[244:247],a[160:163],v[56:59]
v_add_f32 v90,v90,v163
v_add_f32 v91,v91,v153
M v[60:63],a[220:223],a[160:163],v[60:63]
buffer_load_dwordx4 v[12:15],v200,s[8:11],0 offen offset:3072 sc1
v_lshlrev_b32 v162,16,v154
M v[60:63],a[224:227],a[164:167],v[60:63]
v_and_b32 v154,s58,v154
v_lshlrev_b32 v163,16,v155
M v[60:63],a[228:231],a[168:171],v[60:63]
v_and_b32 v155,s58,v155
v_add_f32 v92,v92,v162
M v[60:63],a[232:235],a[172:175],v[60:63]
v_add_f32 v93,v93,v154
v_add_f32 v94,v94,v163
M v[44:47],a[232:235],a[156:159],v[44:47]
v_add_f32 v95,v95,v155
v_lshlrev_b32 v162,16,v156
M v[44:47],a[228:231],a[152:155],v[44:47]
v_and_b32 v156,s58,v156
v_lshlrev_b32 v163,16,v157
M v[44:47],a[224:227],a[148:151],v[44:47]
v_and_b32 v157,s58,v157
v_add_f32 v96,v96,v162
M v[44:47],a[220:223],a[144:147],v[44:47]
v_add_f32 v97,v97,v156
v_add_f32 v98,v98,v163
M v[48:51],v[20:23],a[144:147],v[48:51]
v_add_f32 v99,v99,v157
v_lshlrev_b32 v162,16,v158
M v[48:51],v[24:27],a[148:151],v[48:51]
v_and_b32 v158,s58,v158
v_lshlrev_b32 v163,16,v159
M v[48:51],v[28:31],a[152:155],v[48:51]
v_and_b32 v159,s58,v159
v_add_f32 v100,v100,v162
M v[48:51],v[32:35],a[156:159],v[48:51]
v_add_f32 v101,v101,v158
v_add_f32 v102,v102,v163
M v[64:67],v[32:35],a[172:175],v[64:67]
v_add_f32 v103,v103,v159
M v[64:67],v[28:31],a[168:171],v[64:67]
M v[64:67],v[24:27],a[164:167],v[64:67]
M v[64:67],v[20:23],a[160:163],v[64:67]
v_pk_add_f32 v[36:37],v[36:37],v[72:73]
v_pk_add_f32 v[38:39],v[38:39],v[74:75]
v_pk_add_f32 v[40:41],v[40:41],v[76:77]
v_pk_add_f32 v[42:43],v[42:43],v[78:79]
v_pk_add_f32 v[44:45],v[44:45],v[80:81]
v_pk_add_f32 v[46:47],v[46:47],v[82:83]
v_pk_add_f32 v[48:49],v[48:49],v[84:85]
v_pk_add_f32 v[50:51],v[50:51],v[86:87]
v_pk_add_f32 v[68:69],v[68:69],v[104:105]
v_pk_add_f32 v[70:71],v[70:71],v[106:107]
v_pk_add_f32 v[52:53],v[52:53],v[88:89]
v_pk_add_f32 v[54:55],v[54:55],v[90:91]
v_pk_add_f32 v[56:57],v[56:57],v[92:93]
v_pk_add_f32 v[58:59],v[58:59],v[94:95]
v_pk_add_f32 v[60:61],v[60:61],v[96:97]
v_pk_add_f32 v[62:63],v[62:63],v[98:99]
v_pk_add_f32 v[64:65],v[64:65],v[100:101]
v_pk_add_f32 v[66:67],v[66:67],v[102:103]
s_waitcnt vmcnt(4)
v_lshlrev_b32 v124,16,v16
v_and_b32 v125,s58,v16
v_lshlrev_b32 v126,16,v17
v_and_b32 v127,s58,v17
v_pk_add_f32 v[68:69],v[68:69],v[124:125]
v_pk_add_f32 v[70:71],v[70:71],v[126:127]
C v68,v68,v69
C v69,v70,v71
s_waitcnt vmcnt(3)
v_lshlrev_b32 v128,16,v0
v_and_b32 v129,s58,v0
v_lshlrev_b32 v130,16,v1
v_and_b32 v131,s58,v1
v_pk_add_f32 v[36:37],v[36:37],v[128:129]
v_pk_add_f32 v[38:39],v[38:39],v[130:131]
v_lshlrev_b32 v132,16,v2
v_and_b32 v133,s58,v2
v_lshlrev_b32 v134,16,v3
v_and_b32 v135,s58,v3
C v36,v36,v37
C v37,v38,v39
v_pk_add_f32 v[40:41],v[40:41],v[132:133]
v_pk_add_f32 v[42:43],v[42:43],v[134:135]
s_waitcnt vmcnt(2)
v_lshlrev_b32 v136,16,v4
v_and_b32 v137,s58,v4
v_lshlrev_b32 v138,16,v5
v_and_b32 v139,s58,v5
C v40,v40,v41
C v41,v42,v43
ds_write_b64 v164,v[36:37] offset:0
v_pk_add_f32 v[44:45],v[44:45],v[136:137]
v_pk_add_f32 v[46:47],v[46:47],v[138:139]
v_lshlrev_b32 v140,16,v6
v_and_b32 v141,s58,v6
v_lshlrev_b32 v142,16,v7
v_and_b32 v143,s58,v7
C v44,v44,v45
C v45,v46,v47
ds_write_b64 v165,v[40:41] offset:0
v_pk_add_f32 v[48:49],v[48:49],v[140:141]
v_pk_add_f32 v[50:51],v[50:51],v[142:143]
C v48,v48,v49
C v49,v50,v51
ds_write_b64 v166,v[44:45] offset:0
ds_write_b64 v167,v[48:49] offset:0
s_waitcnt vmcnt(1)
v_lshlrev_b32 v124,16,v8
v_and_b32 v125,s58,v8
v_lshlrev_b32 v126,16,v9
v_and_b32 v127,s58,v9
R v[108:111],v202,0
v_pk_add_f32 v[52:53],v[52:53],v[124:125]
v_pk_add_f32 v[54:55],v[54:55],v[126:127]
v_lshlrev_b32 v128,16,v10
v_and_b32 v129,s58,v10
v_lshlrev_b32 v130,16,v11
v_and_b32 v131,s58,v11
C v52,v52,v53
C v53,v54,v55
R v[112:115],v202,1024
v_pk_add_f32 v[56:57],v[56:57],v[128:129]
v_pk_add_f32 v[58:59],v[58:59],v[130:131]
s_waitcnt vmcnt(0)
v_lshlrev_b32 v132,16,v12
v_and_b32 v133,s58,v12
v_lshlrev_b32 v134,16,v13
v_and_b32 v135,s58,v13
C v56,v56,v57
C v57,v58,v59
ds_write_b64 v164,v[52:53] offset:2048
v_pk_add_f32 v[60:61],v[60:61],v[132:133]
v_pk_add_f32 v[62:63],v[62:63],v[134:135]
v_lshlrev_b32 v136,16,v14
v_and_b32 v137,s58,v14
v_lshlrev_b32 v138,16,v15
v_and_b32 v139,s58,v15
C v60,v60,v61
C v61,v62,v63
ds_write_b64 v165,v[56:57] offset:2048
v_pk_add_f32 v[64:65],v[64:65],v[136:137]
v_pk_add_f32 v[66:67],v[66:67],v[138:139]
C v64,v64,v65
C v65,v66,v67
ds_write_b64 v166,v[60:61] offset:2048
ds_write_b64 v167,v[64:65] offset:2048
R v[116:119],v202,2048
R v[120:123],v202,3072
buffer_store_dwordx2 v[68:69],v204,s[32:35],0 offen
s_waitcnt lgkmcnt(6)
buffer_store_dwordx4 v[108:111],v168,s[32:35],0 offen sc1
buffer_store_dwordx4 v[112:115],v169,s[32:35],0 offen sc1
s_waitcnt lgkmcnt(1)
buffer_store_dwordx4 v[116:119],v170,s[32:35],0 offen sc1
s_waitcnt lgkmcnt(0)
buffer_store_dwordx4 v[120:123],v171,s[32:35],0 offen sc1
L_end0:
s_endpgm
L_spm:
s_mov_b32 s100,0x40000
L_sqm:
buffer_load_dwordx2 v[238:239],v237,s[84:87],0 offen sc1
s_waitcnt vmcnt(0)
v_and_b32 v238,v238,v239
v_cmp_eq_u32 vcc,s55,v238
s_cbranch_vccnz L_rtm
s_sub_u32 s100,s100,1
s_cmp_lg_u32 s100,0
s_cbranch_scc1 L_sqm
s_branch L_rtm
L_sp0:
s_mov_b32 s100,0x40000
L_sq0:
buffer_load_dword v254,off,s[80:83],s90 offset:0 sc1
s_waitcnt vmcnt(0)
v_cmp_eq_u32 vcc,1,v254
s_cbranch_vccnz L_rt0
s_sub_u32 s100,s100,1
s_cmp_lg_u32 s100,0
s_cbranch_scc1 L_sq0
s_branch L_rt0
L_sp1:
s_mov_b32 s100,0x40000
L_sq1:
buffer_load_dword v255,off,s[80:83],s91 offset:128 sc1
s_waitcnt vmcnt(0)
v_cmp_eq_u32 vcc,1,v255
s_cbranch_vccnz L_rt1
s_sub_u32 s100,s100,1
s_cmp_lg_u32 s100,0
s_cbranch_scc1 L_sq1
s_branch L_rt1
L_sp2:
s_mov_b32 s100,0x40000
L_sq2:
buffer_load_dword v254,off,s[80:83],s90 offset:256 sc1
s_waitcnt vmcnt(0)
v_cmp_eq_u32 vcc,1,v254
s_cbranch_vccnz L_rt2
s_sub_u32 s100,s100,1
s_cmp_lg_u32 s100,0
s_cbranch_scc1 L_sq2
s_branch L_rt2
L_sp3:
s_mov_b32 s100,0x40000
L_sq3:
buffer_load_dword v255,off,s[80:83],s91 offset:384 sc1
s_waitcnt vmcnt(0)
v_cmp_eq_u32 vcc,1,v255
s_cbranch_vccnz L_rt3
s_sub_u32 s100,s100,1
s_cmp_lg_u32 s100,0
s_cbranch_scc1 L_sq3
s_branch L_rt3
L_sp4:
s_mov_b32 s100,0x40000
L_sq4:
buffer_load_dword v254,off,s[80:83],s90 offset:512 sc1
s_waitcnt vmcnt(0)
v_cmp_eq_u32 vcc,1,v254
s_cbranch_vccnz L_rt4
s_sub_u32 s100,s100,1
s_cmp_lg_u32 s100,0
s_cbranch_scc1 L_sq4
s_branch L_rt4
L_sp5:
s_mov_b32 s100,0x40000
L_sq5:
buffer_load_dword v255,off,s[80:83],s91 offset:640 sc1
s_waitcnt vmcnt(0)
v_cmp_eq_u32 vcc,1,v255
s_cbranch_vccnz L_rt5
s_sub_u32 s100,s100,1
s_cmp_lg_u32 s100,0
s_cbranch_scc1 L_sq5
s_branch L_rt5
L_sp6:
s_mov_b32 s100,0x40000
L_sq6:
buffer_load_dword v254,off,s[80:83],s90 offset:768 sc1
s_waitcnt vmcnt(0)
v_cmp_eq_u32 vcc,1,v254
s_cbranch_vccnz L_rt6
s_sub_u32 s100,s100,1
s_cmp_lg_u32 s100,0
s_cbranch_scc1 L_sq6
s_branch L_rt6
L_last:
L_mx0:
s_waitcnt lgkmcnt(0)
s_add_u32 s60,s50,0
s_mov_b32 s61,s9
s_add_u32 s62,s10,28672
s_mov_b32 s63,0x20000
s_sub_u32 s57,s10,102400
s_mov_b32 s56,0
v_bfe_u32 v202,v210,8,3
v_lshlrev_b32 v202,5,v202
v_xor_b32 v197,v210,v202
v_add_u32 v197,s57,v197
v_xor_b32 v198,v211,v202
v_add_u32 v198,s57,v198
v_xor_b32 v199,v212,v202
v_add_u32 v199,s57,v199
v_xor_b32 v201,v213,v202
v_add_u32 v201,s57,v201
L_my0:
buffer_load_dwordx4 a[140:143],v197,s[60:63],s56 offen
buffer_load_dwordx4 a[248:251],v198,s[60:63],s56 offen
buffer_load_dwordx4 a[252:255],v199,s[60:63],s56 offen
buffer_load_dwordx4 a[216:219],v201,s[60:63],s56 offen
s_waitcnt vmcnt(0)
M v[152:155],a[140:143],a[0:3],0
M v[152:155],a[248:251],a[4:7],v[152:155]
M v[152:155],a[252:255],a[8:11],v[152:155]
M v[152:155],a[216:219],a[12:15],v[152:155]
M v[156:159],a[140:143],a[16:19],0
M v[156:159],a[248:251],a[20:23],v[156:159]
M v[156:159],a[252:255],a[24:27],v[156:159]
M v[156:159],a[216:219],a[28:31],v[156:159]
M v[160:163],a[140:143],a[32:35],0
M v[160:163],a[248:251],a[36:39],v[160:163]
M v[160:163],a[252:255],a[40:43],v[160:163]
M v[160:163],a[216:219],a[44:47],v[160:163]
s_nop 7
v_max3_f32 v196,v196,v152,v153
v_max3_f32 v196,v196,v154,v155
v_max3_f32 v200,v200,v156,v157
v_max3_f32 v200,v200,v158,v159
v_max3_f32 v204,v204,v160,v161
v_max3_f32 v204,v204,v162,v163
s_add_u32 s56,s56,4096
s_cmp_lt_u32 s56,131072
s_cbranch_scc1 L_my0
s_nop 1
s_branch L_mr0
L_mx1:
s_waitcnt lgkmcnt(0)
s_add_u32 s60,s50,131072
s_mov_b32 s61,s9
s_add_u32 s62,s10,28672
s_mov_b32 s63,0x20000
s_sub_u32 s57,s10,102400
s_mov_b32 s56,0
v_bfe_u32 v202,v210,8,3
v_lshlrev_b32 v202,5,v202
v_xor_b32 v197,v210,v202
v_add_u32 v197,s57,v197
v_xor_b32 v198,v211,v202
v_add_u32 v198,s57,v198
v_xor_b32 v199,v212,v202
v_add_u32 v199,s57,v199
v_xor_b32 v201,v213,v202
v_add_u32 v201,s57,v201
L_my1:
buffer_load_dwordx4 a[248:251],v197,s[60:63],s56 offen
buffer_load_dwordx4 a[252:255],v198,s[60:63],s56 offen
buffer_load_dwordx4 a[216:219],v199,s[60:63],s56 offen
buffer_load_dwordx4 a[220:223],v201,s[60:63],s56 offen
s_waitcnt vmcnt(0)
M v[152:155],a[248:251],a[48:51],0
M v[152:155],a[252:255],a[52:55],v[152:155]
M v[152:155],a[216:219],a[56:59],v[152:155]
M v[152:155],a[220:223],a[60:63],v[152:155]
M v[156:159],a[248:251],a[64:67],0
M v[156:159],a[252:255],a[68:71],v[156:159]
M v[156:159],a[216:219],a[72:75],v[156:159]
M v[156:159],a[220:223],a[76:79],v[156:159]
M v[160:163],a[248:251],a[80:83],0
M v[160:163],a[252:255],a[84:87],v[160:163]
M v[160:163],a[216:219],a[88:91],v[160:163]
M v[160:163],a[220:223],a[92:95],v[160:163]
s_nop 7
v_max3_f32 v196,v196,v152,v153
v_max3_f32 v196,v196,v154,v155
v_max3_f32 v200,v200,v156,v157
v_max3_f32 v200,v200,v158,v159
v_max3_f32 v204,v204,v160,v161
v_max3_f32 v204,v204,v162,v163
s_add_u32 s56,s56,4096
s_cmp_lt_u32 s56,131072
s_cbranch_scc1 L_my1
s_nop 1
s_branch L_mr1
L_mx2:
s_waitcnt lgkmcnt(0)
s_add_u32 s60,s50,262144
s_mov_b32 s61,s9
s_add_u32 s62,s10,28672
s_mov_b32 s63,0x20000
s_sub_u32 s57,s10,102400
s_mov_b32 s56,0
v_bfe_u32 v202,v210,8,3
v_lshlrev_b32 v202,5,v202
v_xor_b32 v197,v210,v202
v_add_u32 v197,s57,v197
v_xor_b32 v198,v211,v202
v_add_u32 v198,s57,v198
v_xor_b32 v199,v212,v202
v_add_u32 v199,s57,v199
v_xor_b32 v201,v213,v202
v_add_u32 v201,s57,v201
L_my2:
buffer_load_dwordx4 a[84:87],v197,s[60:63],s56 offen
buffer_load_dwordx4 a[88:91],v198,s[60:63],s56 offen
buffer_load_dwordx4 a[92:95],v199,s[60:63],s56 offen
buffer_load_dwordx4 a[36:39],v201,s[60:63],s56 offen
s_waitcnt vmcnt(0)
M v[152:155],a[84:87],a[96:99],0
M v[152:155],a[88:91],a[100:103],v[152:155]
M v[152:155],a[92:95],a[104:107],v[152:155]
M v[152:155],a[36:39],a[108:111],v[152:155]
M v[156:159],a[84:87],a[112:115],0
M v[156:159],a[88:91],a[116:119],v[156:159]
M v[156:159],a[92:95],a[120:123],v[156:159]
M v[156:159],a[36:39],a[124:127],v[156:159]
M v[160:163],a[84:87],a[128:131],0
M v[160:163],a[88:91],a[132:135],v[160:163]
M v[160:163],a[92:95],a[136:139],v[160:163]
M v[160:163],a[36:39],a[140:143],v[160:163]
s_nop 7
v_max3_f32 v196,v196,v152,v153
v_max3_f32 v196,v196,v154,v155
v_max3_f32 v200,v200,v156,v157
v_max3_f32 v200,v200,v158,v159
v_max3_f32 v204,v204,v160,v161
v_max3_f32 v204,v204,v162,v163
s_add_u32 s56,s56,4096
s_cmp_lt_u32 s56,131072
s_cbranch_scc1 L_my2
s_nop 1
s_branch L_mr2
L_mx3:
s_waitcnt lgkmcnt(0)
s_add_u32 s60,s50,393216
s_mov_b32 s61,s9
s_add_u32 s62,s10,28672
s_mov_b32 s63,0x20000
s_sub_u32 s57,s10,102400
s_mov_b32 s56,0
v_bfe_u32 v202,v210,8,3
v_lshlrev_b32 v202,5,v202
v_xor_b32 v197,v210,v202
v_add_u32 v197,s57,v197
v_xor_b32 v198,v211,v202
v_add_u32 v198,s57,v198
v_xor_b32 v199,v212,v202
v_add_u32 v199,s57,v199
v_xor_b32 v201,v213,v202
v_add_u32 v201,s57,v201
L_my3:
buffer_load_dwordx4 v[112:115],v197,s[60:63],s56 offen
buffer_load_dwordx4 v[116:119],v198,s[60:63],s56 offen
buffer_load_dwordx4 v[120:123],v199,s[60:63],s56 offen
buffer_load_dwordx4 v[124:127],v201,s[60:63],s56 offen
s_waitcnt vmcnt(0)
M v[152:155],v[112:115],a[144:147],0
M v[152:155],v[116:119],a[148:151],v[152:155]
M v[152:155],v[120:123],a[152:155],v[152:155]
M v[152:155],v[124:127],a[156:159],v[152:155]
M v[156:159],v[112:115],a[160:163],0
M v[156:159],v[116:119],a[164:167],v[156:159]
M v[156:159],v[120:123],a[168:171],v[156:159]
M v[156:159],v[124:127],a[172:175],v[156:159]
M v[160:163],v[112:115],a[176:179],0
M v[160:163],v[116:119],a[180:183],v[160:163]
M v[160:163],v[120:123],a[184:187],v[160:163]
M v[160:163],v[124:127],a[188:191],v[160:163]
s_nop 7
v_max3_f32 v196,v196,v152,v153
v_max3_f32 v196,v196,v154,v155
v_max3_f32 v200,v200,v156,v157
v_max3_f32 v200,v200,v158,v159
v_max3_f32 v204,v204,v160,v161
v_max3_f32 v204,v204,v162,v163
s_add_u32 s56,s56,4096
s_cmp_lt_u32 s56,131072
s_cbranch_scc1 L_my3
s_nop 1
s_branch L_mr3
L_redo:
s_cmp_lg_u32 s59,0
s_cbranch_scc1 L_ok
s_mov_b32 s59,1
s_waitcnt vmcnt(0) lgkmcnt(0)
s_nop 7
s_nop 7
v_subrev_u32 v0,147456,v244
v_lshrrev_b32 v0,4,v0
s_barrier
s_branch L_go
.section .rodata,"a"
.p2align 6
.amdhsa_kernel concat_heads__mha_block_cached__gqa_block_cached__near_ridge_kernel
  .amdhsa_next_free_vgpr 512
  .amdhsa_next_free_sgpr 102
  .amdhsa_accum_offset 256
  .amdhsa_group_segment_fixed_size 0
  .amdhsa_kernarg_size 104
  .amdhsa_user_sgpr_count 2
  .amdhsa_user_sgpr_kernarg_segment_ptr 1
  .amdhsa_system_sgpr_workgroup_id_x 1
.end_amdhsa_kernel
```
